```python
import torch

def _softmax(x, axis=-1):
    return torch.softmax(x, dim=axis)

def _gelu(x):
    return torch.nn.functional.gelu(x, approximate='tanh')

def _silu(x):
    return torch.nn.functional.silu(x)

def _sigmoid(x):
    return torch.sigmoid(x)

def _layernorm(x, axis=-1, eps=1e-05):
    m = x.mean(dim=axis, keepdim=True)
    v = x.var(dim=axis, keepdim=True, unbiased=False)
    return (x - m) / torch.sqrt(v + eps)

def _scatter_add(tgt, idx, src, axis=0):
    return tgt.clone().index_add_(axis, idx, src)

def _segment_sum(src, seg, n):
    out = torch.zeros((n,) + src.shape[1:], dtype=src.dtype)
    return out.index_add_(0, seg, src)

def _pad(x, pw):
    flat = tuple((v for pair in reversed(pw) for v in pair))
    return torch.nn.functional.pad(x, flat)
kernel_name = 'sequential_preLN__memory_aug_recurrent_mem_tr__glu_gated_glu__prompt'

def setup_inputs():

    _w = lambda a: (lambda t: t.to(torch.bfloat16) if t.is_floating_point() else t)(torch.as_tensor(a))

    def _A_setup():
        B, S, Dm = (1, 2048, 640)
        H, Dh = (32, 128)
        M, seg = (8, 32)
        seg = min(seg, S)
        S = S // seg * seg
        return {'x': _w((lambda *s: torch.randn(*s, dtype=torch.bfloat16) * 0.05)(B, S, Dm)), 'mem0': _w((lambda *s: torch.randn(*s, dtype=torch.bfloat16) * 0.2)(B, M, Dm)), 'Wq': _w((lambda *s: torch.randn(*s, dtype=torch.bfloat16) * 1.6)(Dm, H, Dh) * Dm ** (-0.5)), 'Wk': _w((lambda *s: torch.randn(*s, dtype=torch.bfloat16) * 1.6)(Dm, H, Dh) * Dm ** (-0.5)), 'Wv': _w((lambda *s: torch.randn(*s, dtype=torch.bfloat16) * 0.2)(Dm, H, Dh) * Dm ** (-0.5)), 'Wo': _w((lambda *s: torch.randn(*s, dtype=torch.bfloat16) * 0.2)(H, Dh, Dm) * (H * Dh) ** (-0.5)), 'seg_len': seg}
    _A_in = _A_setup()

    def _B_setup():
        B, S, D, F = (1, 2048, 640, 1728)
        return {'x': _w((lambda *s: torch.randn(*s, dtype=torch.bfloat16) * 0.05)(B, S, D)), 'w_gate': _w((lambda *s: torch.randn(*s, dtype=torch.bfloat16) * 0.05)(D, F)), 'w_up': _w((lambda *s: torch.randn(*s, dtype=torch.bfloat16) * 0.05)(D, F)), 'w_down': _w((lambda *s: torch.randn(*s, dtype=torch.bfloat16) * 0.05)(F, D))}
    _B_in = _B_setup()
    return {'A_x': _A_in['x'], 'A_mem0': _A_in['mem0'], 'A_Wq': _A_in['Wq'], 'A_Wk': _A_in['Wk'], 'A_Wv': _A_in['Wv'], 'A_Wo': _A_in['Wo'], 'A_seg_len': _A_in['seg_len'], 'B_x': _B_in['x'], 'B_w_gate': _B_in['w_gate'], 'B_w_up': _B_in['w_up'], 'B_w_down': _B_in['w_down']}

def reference(A_x, A_mem0, A_Wq, A_Wk, A_Wv, A_Wo, A_seg_len, B_x, B_w_gate, B_w_up, B_w_down):

    def _A_ref(x, mem0, Wq, Wk, Wv, Wo, seg_len):
        B, S, Dm = x.shape
        H, Dh = (Wq.shape[1], Wq.shape[2])
        M = mem0.shape[1]
        scale = Dh ** (-0.5)
        n_seg = S // seg_len
        L = M + seg_len
        idx = torch.arange(L)
        mask = (idx[:, None] < M) | (idx[:, None] >= idx[None, :])
        mem = mem0
        outs = []
        for s in range(n_seg):
            xs = x[:, s * seg_len:(s + 1) * seg_len, :].clone()
            h = torch.concatenate([mem, xs], axis=1)
            q = torch.einsum('btd,dhe->bhte', h, Wq)
            k = torch.einsum('btd,dhe->bhte', h, Wk)
            v = torch.einsum('btd,dhe->bhte', h, Wv)
            scores = torch.einsum('bhqe,bhke->bhqk', q, k) * scale
            scores = torch.where(mask[None, None], scores, -1000000000.0)
            p = _softmax(scores, axis=-1)
            o = torch.einsum('bhqk,bhke->bhqe', p, v)
            o = torch.einsum('bhte,hed->btd', o, Wo)
            mem = o[:, :M, :].clone()
            outs.append(o[:, M:, :])
        return torch.concatenate(outs, axis=1)

    def _B_ref(x, w_gate, w_up, w_down):
        g = torch.einsum('bsd,df->bsf', x, w_gate)
        u = torch.einsum('bsd,df->bsf', x, w_up)
        h = _sigmoid(g) * u
        return torch.einsum('bsf,fd->bsd', h, w_down)
    x = A_x
    h = x + _A_ref(_layernorm(x, axis=-1), A_mem0, A_Wq, A_Wk, A_Wv, A_Wo, A_seg_len)
    h2 = h + _B_ref(_layernorm(h, axis=-1), B_w_gate, B_w_up, B_w_down)
    return h2
```

```asm
; @launch grid=(256,1,1) block=(256,1,1) lds=163840
.amdgcn_target "amdgcn-amd-amdhsa--gfx950"
.text
.globl sequential_preLN__memory_aug_recurrent_mem_tr__glu_gated_glu__prompt_kernel
.p2align 8
.type sequential_preLN__memory_aug_recurrent_mem_tr__glu_gated_glu__prompt_kernel,@function
sequential_preLN__memory_aug_recurrent_mem_tr__glu_gated_glu__prompt_kernel:
    s_cmp_ge_u32 s2, 256
    s_cbranch_scc1 L_end
    s_load_dwordx16 s[16:31], s[0:1], 0
    s_load_dwordx8 s[32:39], s[0:1], 64
    s_load_dwordx4 s[40:43], s[0:1], 96
    s_getreg_b32 s4, hwreg(HW_REG_XCC_ID, 0, 4)
    v_lshrrev_b32 v1, 6, v0
    s_nop 0
    v_readfirstlane_b32 s3, v1
    s_waitcnt lgkmcnt(0)
    s_mov_b32 s44, s42
    s_mov_b32 s45, s43
    s_mov_b32 s46, 0x10000000
    s_mov_b32 s47, 0x20000
    s_mov_b32 s11, 0
    s_cmp_lg_u32 s3, 0
    s_cbranch_scc1 L_tick_skip
    s_lshl_b32 s6, s4, 2
    v_mov_b32 v2, s6
    v_mov_b32 v3, 1
    s_mov_b64 exec, 1
    global_atomic_add v4, v2, v3, s[40:41] sc0 sc1
    s_mov_b64 exec, -1
L_tick_skip:
    s_cmp_lg_u32 s3, 0
    s_cbranch_scc1 L_tick_b
    s_waitcnt vmcnt(0)
    v_mov_b32 v2, 0
    s_mov_b64 exec, 1
    ds_write_b32 v2, v4
    s_mov_b64 exec, -1
    s_waitcnt lgkmcnt(0)
L_tick_b:
    s_barrier
    v_mov_b32 v2, 0
    ds_read_b32 v4, v2
    s_waitcnt lgkmcnt(0)
    s_nop 0
    v_readfirstlane_b32 s5, v4
    s_nop 1
    s_barrier
    s_cmp_lt_u32 s5, 32
    s_cbranch_scc0 L_norole
    s_cmp_lt_u32 s4, 8
    s_cbranch_scc0 L_norole
L_dispatch:
    s_cmp_eq_u32 s4, 0
    s_cbranch_scc1 L_chain
    s_cmp_ge_u32 s4, 5
    s_cbranch_scc1 L_bulk
L_post:
    s_sub_u32 s60, s4, 1
    s_lshl_b32 s60, s60, 5
    s_add_u32 s60, s60, s5
    v_lshlrev_b32 v5, 4, v0
    v_mov_b32 v8, -1
    v_mov_b32 v9, -1
    v_mov_b32 v10, -1
    v_mov_b32 v11, -1
    v_mov_b32 v12, 0
    v_mov_b32 v13, 0
    v_mov_b32 v14, 0
    v_mov_b32 v15, 0
    v_mov_b32 v6, 0x7fffff00
    v_cmp_gt_u32 vcc, 8, v0
    s_lshl_b32 s6, s60, 7
    s_nop 0
    v_cndmask_b32 v7, v6, v5, vcc
    buffer_store_dwordx4 v[12:15], v7, s[44:47], s6 offen sc1
    s_mul_i32 s6, s60, 5120
    s_add_u32 s6, s6, 0x20000
    buffer_store_dwordx4 v[12:15], v5, s[44:47], s6 offen sc1
    v_cmp_gt_u32 vcc, 64, v0
    s_add_u32 s6, s6, 4096
    s_nop 0
    v_cndmask_b32 v7, v6, v5, vcc
    buffer_store_dwordx4 v[12:15], v7, s[44:47], s6 offen sc1
    s_cmp_ge_u32 s60, 20
    s_cbranch_scc1 L_init_d_done
    s_lshl_b32 s6, s60, 10
    s_add_u32 s6, s6, 0xc0000
    buffer_store_dwordx4 v[12:15], v7, s[44:47], s6 offen sc1
L_init_d_done:
    s_sub_u32 s6, s60, 20
    s_cmp_ge_u32 s6, 3
    s_cbranch_scc1 L_init_e_done
    s_mov_b32 s48, s18
    s_mov_b32 s49, s19
    s_mov_b32 s50, 0x2800
    s_mov_b32 s51, 0x20000
    s_lshl_b32 s6, s6, 8
    v_add_u32 v16, s6, v0
    v_and_b32 v17, 7, v16
    v_bfe_u32 v18, v16, 3, 2
    v_lshrrev_b32 v19, 5, v16
    v_mul_u32_u24 v17, 1280, v17
    v_lshlrev_b32 v19, 6, v19
    v_lshlrev_b32 v18, 3, v18
    v_add3_u32 v17, v17, v18, v19
    v_cmp_gt_u32 vcc, 640, v16
    v_lshlrev_b32 v16, 4, v16
    s_nop 0
    v_cndmask_b32 v17, v6, v17, vcc
    v_cndmask_b32 v16, v6, v16, vcc
    buffer_load_dwordx2 v[20:21], v17, s[48:51], 0 offen
    buffer_load_dwordx2 v[22:23], v17, s[48:51], 0 offen offset:32
    s_mov_b32 s6, 0xc5000
    s_waitcnt vmcnt(0)
    buffer_store_dwordx4 v[20:23], v16, s[44:47], s6 offen sc1
L_init_e_done:
    s_waitcnt vmcnt(0)
    s_barrier
    s_cmp_lg_u32 s3, 0
    s_cbranch_scc1 L_cnt_1
    s_lshl_b32 s6, s11, 2
    s_add_u32 s6, s6, 128
    v_mov_b32 v2, s6
    v_mov_b32 v3, 1
    s_mov_b64 exec, 1
    global_atomic_add v2, v3, s[40:41] sc1
    s_mov_b64 exec, -1
L_cnt_1:
    s_sub_u32 s60, s4, 1
    s_lshl_b32 s60, s60, 5
    s_add_u32 s60, s60, s5
    s_mov_b32 s48, s16
    s_mov_b32 s49, s17
    s_mov_b32 s50, 0x280000
    s_mov_b32 s51, 0x20000
    v_lshrrev_b32 v1, 4, v0
    v_and_b32 v2, 15, v0
    v_mul_u32_u24 v3, 1280, v1
    v_lshl_add_u32 v3, v2, 4, v3
    s_mul_i32 s6, s60, 20480
    buffer_load_dwordx4 v[8:11], v3, s[48:51], s6 offen offset:0
    buffer_load_dwordx4 v[12:15], v3, s[48:51], s6 offen offset:256
    buffer_load_dwordx4 v[16:19], v3, s[48:51], s6 offen offset:512
    buffer_load_dwordx4 v[20:23], v3, s[48:51], s6 offen offset:768
    buffer_load_dwordx4 v[24:27], v3, s[48:51], s6 offen offset:1024
    v_lshrrev_b32 v4, 1, v2
    v_lshlrev_b32 v4, 10, v4
    v_and_b32 v5, 1, v2
    v_lshl_add_u32 v4, v5, 9, v4
    v_lshl_add_u32 v4, v1, 4, v4
    s_and_b32 s7, s60, 1
    s_lshl_b32 s7, s7, 8
    v_add_u32 v4, s7, v4
    s_lshr_b32 s7, s60, 1
    s_mul_i32 s7, s7, 40960
    s_add_u32 s7, s7, 0x300000
    s_waitcnt vmcnt(0)
    v_lshlrev_b32 v32, 16, v8
    v_and_b32 v33, 0xffff0000, v8
    v_lshlrev_b32 v34, 16, v9
    v_and_b32 v35, 0xffff0000, v9
    v_lshlrev_b32 v36, 16, v10
    v_and_b32 v37, 0xffff0000, v10
    v_lshlrev_b32 v38, 16, v11
    v_and_b32 v39, 0xffff0000, v11
    v_lshlrev_b32 v40, 16, v12
    v_and_b32 v41, 0xffff0000, v12
    v_lshlrev_b32 v42, 16, v13
    v_and_b32 v43, 0xffff0000, v13
    v_lshlrev_b32 v44, 16, v14
    v_and_b32 v45, 0xffff0000, v14
    v_lshlrev_b32 v46, 16, v15
    v_and_b32 v47, 0xffff0000, v15
    v_lshlrev_b32 v48, 16, v16
    v_and_b32 v49, 0xffff0000, v16
    v_lshlrev_b32 v50, 16, v17
    v_and_b32 v51, 0xffff0000, v17
    v_lshlrev_b32 v52, 16, v18
    v_and_b32 v53, 0xffff0000, v18
    v_lshlrev_b32 v54, 16, v19
    v_and_b32 v55, 0xffff0000, v19
    v_lshlrev_b32 v56, 16, v20
    v_and_b32 v57, 0xffff0000, v20
    v_lshlrev_b32 v58, 16, v21
    v_and_b32 v59, 0xffff0000, v21
    v_lshlrev_b32 v60, 16, v22
    v_and_b32 v61, 0xffff0000, v22
    v_lshlrev_b32 v62, 16, v23
    v_and_b32 v63, 0xffff0000, v23
    v_lshlrev_b32 v64, 16, v24
    v_and_b32 v65, 0xffff0000, v24
    v_lshlrev_b32 v66, 16, v25
    v_and_b32 v67, 0xffff0000, v25
    v_lshlrev_b32 v68, 16, v26
    v_and_b32 v69, 0xffff0000, v26
    v_lshlrev_b32 v70, 16, v27
    v_and_b32 v71, 0xffff0000, v27
    v_add_f32 v5, v32, v33
    v_add_f32 v6, v34, v35
    v_add_f32 v5, v5, v36
    v_add_f32 v6, v6, v37
    v_add_f32 v5, v5, v38
    v_add_f32 v6, v6, v39
    v_add_f32 v5, v5, v40
    v_add_f32 v6, v6, v41
    v_add_f32 v5, v5, v42
    v_add_f32 v6, v6, v43
    v_add_f32 v5, v5, v44
    v_add_f32 v6, v6, v45
    v_add_f32 v5, v5, v46
    v_add_f32 v6, v6, v47
    v_add_f32 v5, v5, v48
    v_add_f32 v6, v6, v49
    v_add_f32 v5, v5, v50
    v_add_f32 v6, v6, v51
    v_add_f32 v5, v5, v52
    v_add_f32 v6, v6, v53
    v_add_f32 v5, v5, v54
    v_add_f32 v6, v6, v55
    v_add_f32 v5, v5, v56
    v_add_f32 v6, v6, v57
    v_add_f32 v5, v5, v58
    v_add_f32 v6, v6, v59
    v_add_f32 v5, v5, v60
    v_add_f32 v6, v6, v61
    v_add_f32 v5, v5, v62
    v_add_f32 v6, v6, v63
    v_add_f32 v5, v5, v64
    v_add_f32 v6, v6, v65
    v_add_f32 v5, v5, v66
    v_add_f32 v6, v6, v67
    v_add_f32 v5, v5, v68
    v_add_f32 v6, v6, v69
    v_add_f32 v5, v5, v70
    v_add_f32 v6, v6, v71
    v_add_f32 v5, v5, v6
    s_nop 1
    v_add_f32_dpp v5, v5, v5 row_ror:8 row_mask:0xf bank_mask:0xf
    s_nop 1
    v_add_f32_dpp v5, v5, v5 row_ror:4 row_mask:0xf bank_mask:0xf
    s_nop 1
    v_add_f32_dpp v5, v5, v5 row_ror:2 row_mask:0xf bank_mask:0xf
    s_nop 1
    v_add_f32_dpp v5, v5, v5 row_ror:1 row_mask:0xf bank_mask:0xf
    v_mul_f32 v5, 0x3acccccd, v5
    v_sub_f32 v32, v32, v5
    v_sub_f32 v33, v33, v5
    v_sub_f32 v34, v34, v5
    v_sub_f32 v35, v35, v5
    v_sub_f32 v36, v36, v5
    v_sub_f32 v37, v37, v5
    v_sub_f32 v38, v38, v5
    v_sub_f32 v39, v39, v5
    v_sub_f32 v40, v40, v5
    v_sub_f32 v41, v41, v5
    v_sub_f32 v42, v42, v5
    v_sub_f32 v43, v43, v5
    v_sub_f32 v44, v44, v5
    v_sub_f32 v45, v45, v5
    v_sub_f32 v46, v46, v5
    v_sub_f32 v47, v47, v5
    v_sub_f32 v48, v48, v5
    v_sub_f32 v49, v49, v5
    v_sub_f32 v50, v50, v5
    v_sub_f32 v51, v51, v5
    v_sub_f32 v52, v52, v5
    v_sub_f32 v53, v53, v5
    v_sub_f32 v54, v54, v5
    v_sub_f32 v55, v55, v5
    v_sub_f32 v56, v56, v5
    v_sub_f32 v57, v57, v5
    v_sub_f32 v58, v58, v5
    v_sub_f32 v59, v59, v5
    v_sub_f32 v60, v60, v5
    v_sub_f32 v61, v61, v5
    v_sub_f32 v62, v62, v5
    v_sub_f32 v63, v63, v5
    v_sub_f32 v64, v64, v5
    v_sub_f32 v65, v65, v5
    v_sub_f32 v66, v66, v5
    v_sub_f32 v67, v67, v5
    v_sub_f32 v68, v68, v5
    v_sub_f32 v69, v69, v5
    v_sub_f32 v70, v70, v5
    v_sub_f32 v71, v71, v5
    v_mul_f32 v6, v32, v32
    v_mul_f32 v7, v33, v33
    v_fmac_f32 v6, v34, v34
    v_fmac_f32 v7, v35, v35
    v_fmac_f32 v6, v36, v36
    v_fmac_f32 v7, v37, v37
    v_fmac_f32 v6, v38, v38
    v_fmac_f32 v7, v39, v39
    v_fmac_f32 v6, v40, v40
    v_fmac_f32 v7, v41, v41
    v_fmac_f32 v6, v42, v42
    v_fmac_f32 v7, v43, v43
    v_fmac_f32 v6, v44, v44
    v_fmac_f32 v7, v45, v45
    v_fmac_f32 v6, v46, v46
    v_fmac_f32 v7, v47, v47
    v_fmac_f32 v6, v48, v48
    v_fmac_f32 v7, v49, v49
    v_fmac_f32 v6, v50, v50
    v_fmac_f32 v7, v51, v51
    v_fmac_f32 v6, v52, v52
    v_fmac_f32 v7, v53, v53
    v_fmac_f32 v6, v54, v54
    v_fmac_f32 v7, v55, v55
    v_fmac_f32 v6, v56, v56
    v_fmac_f32 v7, v57, v57
    v_fmac_f32 v6, v58, v58
    v_fmac_f32 v7, v59, v59
    v_fmac_f32 v6, v60, v60
    v_fmac_f32 v7, v61, v61
    v_fmac_f32 v6, v62, v62
    v_fmac_f32 v7, v63, v63
    v_fmac_f32 v6, v64, v64
    v_fmac_f32 v7, v65, v65
    v_fmac_f32 v6, v66, v66
    v_fmac_f32 v7, v67, v67
    v_fmac_f32 v6, v68, v68
    v_fmac_f32 v7, v69, v69
    v_fmac_f32 v6, v70, v70
    v_fmac_f32 v7, v71, v71
    v_add_f32 v6, v6, v7
    s_nop 1
    v_add_f32_dpp v6, v6, v6 row_ror:8 row_mask:0xf bank_mask:0xf
    s_nop 1
    v_add_f32_dpp v6, v6, v6 row_ror:4 row_mask:0xf bank_mask:0xf
    s_nop 1
    v_add_f32_dpp v6, v6, v6 row_ror:2 row_mask:0xf bank_mask:0xf
    s_nop 1
    v_add_f32_dpp v6, v6, v6 row_ror:1 row_mask:0xf bank_mask:0xf
    v_mov_b32 v7, 0x3727c5ac
    v_fmac_f32 v7, 0x3acccccd, v6
    v_rsq_f32 v7, v7
    s_nop 0
    v_mul_f32 v32, v32, v7
    v_mul_f32 v33, v33, v7
    v_mul_f32 v34, v34, v7
    v_mul_f32 v35, v35, v7
    v_mul_f32 v36, v36, v7
    v_mul_f32 v37, v37, v7
    v_mul_f32 v38, v38, v7
    v_mul_f32 v39, v39, v7
    v_mul_f32 v40, v40, v7
    v_mul_f32 v41, v41, v7
    v_mul_f32 v42, v42, v7
    v_mul_f32 v43, v43, v7
    v_mul_f32 v44, v44, v7
    v_mul_f32 v45, v45, v7
    v_mul_f32 v46, v46, v7
    v_mul_f32 v47, v47, v7
    v_mul_f32 v48, v48, v7
    v_mul_f32 v49, v49, v7
    v_mul_f32 v50, v50, v7
    v_mul_f32 v51, v51, v7
    v_mul_f32 v52, v52, v7
    v_mul_f32 v53, v53, v7
    v_mul_f32 v54, v54, v7
    v_mul_f32 v55, v55, v7
    v_mul_f32 v56, v56, v7
    v_mul_f32 v57, v57, v7
    v_mul_f32 v58, v58, v7
    v_mul_f32 v59, v59, v7
    v_mul_f32 v60, v60, v7
    v_mul_f32 v61, v61, v7
    v_mul_f32 v62, v62, v7
    v_mul_f32 v63, v63, v7
    v_mul_f32 v64, v64, v7
    v_mul_f32 v65, v65, v7
    v_mul_f32 v66, v66, v7
    v_mul_f32 v67, v67, v7
    v_mul_f32 v68, v68, v7
    v_mul_f32 v69, v69, v7
    v_mul_f32 v70, v70, v7
    v_mul_f32 v71, v71, v7
    v_cvt_pk_bf16_f32 v8, v32, v33
    v_cvt_pk_bf16_f32 v9, v34, v35
    v_cvt_pk_bf16_f32 v10, v36, v37
    v_cvt_pk_bf16_f32 v11, v38, v39
    v_cvt_pk_bf16_f32 v12, v40, v41
    v_cvt_pk_bf16_f32 v13, v42, v43
    v_cvt_pk_bf16_f32 v14, v44, v45
    v_cvt_pk_bf16_f32 v15, v46, v47
    v_cvt_pk_bf16_f32 v16, v48, v49
    v_cvt_pk_bf16_f32 v17, v50, v51
    v_cvt_pk_bf16_f32 v18, v52, v53
    v_cvt_pk_bf16_f32 v19, v54, v55
    v_cvt_pk_bf16_f32 v20, v56, v57
    v_cvt_pk_bf16_f32 v21, v58, v59
    v_cvt_pk_bf16_f32 v22, v60, v61
    v_cvt_pk_bf16_f32 v23, v62, v63
    v_cvt_pk_bf16_f32 v24, v64, v65
    v_cvt_pk_bf16_f32 v25, v66, v67
    v_cvt_pk_bf16_f32 v26, v68, v69
    v_cvt_pk_bf16_f32 v27, v70, v71
    buffer_store_dwordx4 v[8:11], v4, s[44:47], s7 offen sc1
    s_add_u32 s7, s7, 8192
    buffer_store_dwordx4 v[12:15], v4, s[44:47], s7 offen sc1
    s_add_u32 s7, s7, 8192
    buffer_store_dwordx4 v[16:19], v4, s[44:47], s7 offen sc1
    s_add_u32 s7, s7, 8192
    buffer_store_dwordx4 v[20:23], v4, s[44:47], s7 offen sc1
    s_add_u32 s7, s7, 8192
    buffer_store_dwordx4 v[24:27], v4, s[44:47], s7 offen sc1
    s_waitcnt vmcnt(0)
    s_barrier
    s_lshl_b32 s6, s11, 2
    s_add_u32 s6, s6, 128
    v_mov_b32 v2, s6
    s_mov_b32 s12, 0
L_winit_2:
    global_load_dword v3, v2, s[40:41] sc1
    s_waitcnt vmcnt(0)
    v_readfirstlane_b32 s6, v3
    s_add_u32 s12, s12, 1
    s_cmp_ge_u32 s6, 256
    s_cbranch_scc1 L_winit_2_out
    s_sleep 4
    s_cmp_lt_u32 s12, 100000
    s_cbranch_scc1 L_winit_2
L_winit_2_out:
    s_cmp_lg_u32 s11, 0
    s_cbranch_scc1 L_winit_2_ok
    v_mbcnt_lo_u32_b32 v2, -1, 0
    v_mbcnt_hi_u32_b32 v2, -1, v2
    v_and_b32 v2, 7, v2
    v_lshlrev_b32 v2, 2, v2
    global_load_dword v3, v2, s[40:41] sc1
    s_waitcnt vmcnt(0)
    v_cmp_ne_u32 vcc, 32, v3
    s_nop 4
    s_cbranch_vccnz L_fallback
L_winit_2_ok:
    s_cmp_lg_u32 s3, 0
    s_cbranch_scc1 L_ln1_done
    s_lshl_b32 s6, s60, 2
    s_add_u32 s6, s6, 0x0
    v_mov_b32 v2, 0
    v_mov_b32 v3, 1
    s_mov_b64 exec, 1
    buffer_store_dword v3, v2, s[44:47], s6 offen sc1
    s_mov_b64 exec, -1
L_ln1_done:
    v_lshlrev_b32 v5, 4, v0
    v_mov_b32 v8, -1
    v_mov_b32 v9, -1
    v_mov_b32 v10, -1
    v_mov_b32 v11, -1
    s_lshl_b32 s6, s60, 16
    s_add_u32 s6, s6, 0x600000
    buffer_store_dwordx4 v[8:11], v5, s[44:47], s6 offen sc1
    s_add_u32 s6, s6, 4096
    buffer_store_dwordx4 v[8:11], v5, s[44:47], s6 offen sc1
    s_add_u32 s6, s6, 4096
    buffer_store_dwordx4 v[8:11], v5, s[44:47], s6 offen sc1
    s_add_u32 s6, s6, 4096
    buffer_store_dwordx4 v[8:11], v5, s[44:47], s6 offen sc1
    s_add_u32 s6, s6, 4096
    buffer_store_dwordx4 v[8:11], v5, s[44:47], s6 offen sc1
    s_add_u32 s6, s6, 4096
    buffer_store_dwordx4 v[8:11], v5, s[44:47], s6 offen sc1
    s_add_u32 s6, s6, 4096
    buffer_store_dwordx4 v[8:11], v5, s[44:47], s6 offen sc1
    s_add_u32 s6, s6, 4096
    buffer_store_dwordx4 v[8:11], v5, s[44:47], s6 offen sc1
    s_add_u32 s6, s6, 4096
    buffer_store_dwordx4 v[8:11], v5, s[44:47], s6 offen sc1
    s_add_u32 s6, s6, 4096
    buffer_store_dwordx4 v[8:11], v5, s[44:47], s6 offen sc1
    s_add_u32 s6, s6, 4096
    buffer_store_dwordx4 v[8:11], v5, s[44:47], s6 offen sc1
    s_add_u32 s6, s6, 4096
    buffer_store_dwordx4 v[8:11], v5, s[44:47], s6 offen sc1
    s_add_u32 s6, s6, 4096
    buffer_store_dwordx4 v[8:11], v5, s[44:47], s6 offen sc1
    s_add_u32 s6, s6, 4096
    buffer_store_dwordx4 v[8:11], v5, s[44:47], s6 offen sc1
    s_add_u32 s6, s6, 4096
    buffer_store_dwordx4 v[8:11], v5, s[44:47], s6 offen sc1
    s_add_u32 s6, s6, 4096
    buffer_store_dwordx4 v[8:11], v5, s[44:47], s6 offen sc1
    s_waitcnt vmcnt(0)
    s_barrier
    s_cmp_lg_u32 s3, 0
    s_cbranch_scc1 L_cnt_3
    v_mov_b32 v2, 144
    v_mov_b32 v3, 1
    s_mov_b64 exec, 1
    global_atomic_add v2, v3, s[40:41] sc1
    s_mov_b64 exec, -1
L_cnt_3:
    s_sub_u32 s64, s4, 1
    s_mov_b32 s65, s5
    s_lshl_b32 s68, s64, 22
    s_add_u32 s68, s68, 0x4000000
    s_lshl_b32 s69, s64, 9
    s_add_u32 s69, s69, 0x2000
    s_and_b32 s70, s3, 1
    s_lshr_b32 s71, s3, 1
    s_cmp_lt_u32 s65, 27
    s_cselect_b32 s79, 1, 0
    s_lshl_b32 s76, s65, 7
    s_add_u32 s76, s76, 0x400
    s_mov_b32 s75, 0x3e0293ee
    s_mov_b32 s13, 0xff800000
    v_lshlrev_b32 v38, 4, v0
    v_and_b32 v40, 63, v0
    v_and_b32 v41, 15, v40
    v_lshrrev_b32 v42, 4, v40
    v_lshlrev_b32 v0, 4, v40
    v_and_b32 v43, 1, v42
    v_lshrrev_b32 v44, 1, v42
    v_lshlrev_b32 v45, 4, v44
    v_lshl_add_u32 v45, v43, 2, v45
    v_lshrrev_b32 v46, 2, v41
    v_add_u32 v45, v45, v46
    v_lshlrev_b32 v45, 4, v45
    v_and_b32 v46, 1, v41
    v_lshl_add_u32 v45, v46, 3, v45
    v_add_u32 v1, 51200, v45
    s_lshl_b32 s72, s71, 10
    v_lshlrev_b32 v45, 4, v41
    v_lshl_add_u32 v45, v43, 3, v45
    v_add_u32 v45, s72, v45
    v_add_u32 v2, 49152, v45
    s_lshl_b32 s72, s71, 12
    s_lshl_b32 s73, s70, 8
    s_add_u32 s72, s72, s73
    v_lshlrev_b32 v45, 10, v44
    v_lshl_add_u32 v45, v41, 4, v45
    v_lshl_add_u32 v45, v43, 9, v45
    v_add_u32 v45, s72, v45
    v_add_u32 v3, 53248, v45
    v_lshlrev_b32 v45, 1, v44
    v_add_u32 v45, v45, v43
    v_lshlrev_b32 v45, 13, v45
    v_lshl_add_u32 v45, v41, 4, v45
    s_mul_i32 s72, s3, 327680
    s_lshl_b32 s73, s65, 8
    s_add_u32 s72, s72, s73
    v_add_u32 v4, s72, v45
    s_mul_i32 s74, s65, 5
    s_add_u32 s74, s74, s3
    s_lshl_b32 s72, s74, 13
    v_lshlrev_b32 v45, 8, v42
    v_lshl_add_u32 v45, v41, 4, v45
    v_add_u32 v5, s72, v45
    s_and_b32 s72, s74, 1
    s_lshl_b32 s72, s72, 8
    s_bfe_u32 s73, s74, 0x10001
    s_lshl_b32 s73, s73, 9
    s_add_u32 s72, s72, s73
    s_lshr_b32 s73, s74, 2
    s_lshl_b32 s73, s73, 10
    s_add_u32 s72, s72, s73
    v_lshlrev_b32 v45, 4, v41
    v_lshl_add_u32 v45, v43, 3, v45
    v_add_u32 v45, s72, v45
    v_mov_b32 v46, 0x7fffff00
    v_cmp_gt_u32 vcc, 2, v42
    s_nop 1
    v_cndmask_b32 v6, v46, v45, vcc
    s_and_b32 s72, s74, 1
    s_mul_i32 s72, s72, 20480
    s_lshr_b32 s73, s74, 2
    s_lshl_b32 s73, s73, 5
    s_add_u32 s72, s72, s73
    s_bfe_u32 s73, s74, 0x10001
    s_lshl_b32 s73, s73, 3
    s_add_u32 s72, s72, s73
    v_mul_u32_u24 v45, 1280, v41
    v_lshl_add_u32 v45, v43, 4, v45
    v_add_u32 v45, s72, v45
    v_cndmask_b32 v8, v46, v45, vcc
    s_mul_i32 s74, s65, 5
    s_add_u32 s74, s74, 4
    s_and_b32 s72, s74, 1
    s_lshl_b32 s72, s72, 8
    s_bfe_u32 s73, s74, 0x10001
    s_lshl_b32 s73, s73, 9
    s_add_u32 s72, s72, s73
    s_lshr_b32 s73, s74, 2
    s_lshl_b32 s73, s73, 10
    s_add_u32 s72, s72, s73
    v_lshlrev_b32 v45, 4, v41
    v_lshl_add_u32 v45, v43, 3, v45
    v_add_u32 v45, s72, v45
    v_mov_b32 v46, 0x7fffff00
    v_cmp_gt_u32 vcc, 2, v42
    s_nop 1
    v_cndmask_b32 v7, v46, v45, vcc
    s_and_b32 s72, s74, 1
    s_mul_i32 s72, s72, 20480
    s_lshr_b32 s73, s74, 2
    s_lshl_b32 s73, s73, 5
    s_add_u32 s72, s72, s73
    s_bfe_u32 s73, s74, 0x10001
    s_lshl_b32 s73, s73, 3
    s_add_u32 s72, s72, s73
    v_mul_u32_u24 v45, 1280, v41
    v_lshl_add_u32 v45, v43, 4, v45
    v_add_u32 v45, s72, v45
    v_cndmask_b32 v9, v46, v45, vcc
    v_and_b32 v45, 7, v41
    v_mov_b32 v46, 0x3f80
    v_cmp_eq_u32 vcc, 0, v45
    s_nop 1
    v_cndmask_b32 v10, 0, v46, vcc
    v_mov_b32 v46, 0x3f800000
    v_cmp_eq_u32 vcc, 1, v45
    s_nop 1
    v_cndmask_b32 v10, v10, v46, vcc
    v_mov_b32 v46, 0x3f80
    v_cmp_eq_u32 vcc, 2, v45
    s_nop 1
    v_cndmask_b32 v11, 0, v46, vcc
    v_mov_b32 v46, 0x3f800000
    v_cmp_eq_u32 vcc, 3, v45
    s_nop 1
    v_cndmask_b32 v11, v11, v46, vcc
    v_mov_b32 v46, 0x3f80
    v_cmp_eq_u32 vcc, 4, v45
    s_nop 1
    v_cndmask_b32 v12, 0, v46, vcc
    v_mov_b32 v46, 0x3f800000
    v_cmp_eq_u32 vcc, 5, v45
    s_nop 1
    v_cndmask_b32 v12, v12, v46, vcc
    v_mov_b32 v46, 0x3f80
    v_cmp_eq_u32 vcc, 6, v45
    s_nop 1
    v_cndmask_b32 v13, 0, v46, vcc
    v_mov_b32 v46, 0x3f800000
    v_cmp_eq_u32 vcc, 7, v45
    s_nop 1
    v_cndmask_b32 v13, v13, v46, vcc
    v_lshlrev_b32 v45, 2, v42
    v_add_u32 v46, 0, v45
    v_cmp_le_u32 vcc, v46, v41
    s_nop 1
    s_cmp_eq_u32 s70, 0
    s_cselect_b64 s[80:81], vcc, -1
    s_cselect_b64 s[88:89], 0, vcc
    v_add_u32 v46, 1, v45
    v_cmp_le_u32 vcc, v46, v41
    s_nop 1
    s_cmp_eq_u32 s70, 0
    s_cselect_b64 s[82:83], vcc, -1
    s_cselect_b64 s[90:91], 0, vcc
    v_add_u32 v46, 2, v45
    v_cmp_le_u32 vcc, v46, v41
    s_nop 1
    s_cmp_eq_u32 s70, 0
    s_cselect_b64 s[84:85], vcc, -1
    s_cselect_b64 s[92:93], 0, vcc
    v_add_u32 v46, 3, v45
    v_cmp_le_u32 vcc, v46, v41
    s_nop 1
    s_cmp_eq_u32 s70, 0
    s_cselect_b64 s[86:87], vcc, -1
    s_cselect_b64 s[94:95], 0, vcc
    v_cmp_gt_u32 vcc, 2, v42
    s_nop 1
    s_mov_b64 s[96:97], vcc
    s_mul_i32 s72, s65, 163840
    s_add_u32 s48, s26, s72
    s_addc_u32 s49, s27, 0
    s_mov_b32 s50, 163840
    s_mov_b32 s51, 0x20000
    s_mul_i32 s73, s65, s79
    s_mul_i32 s72, s73, 81920
    s_add_u32 s52, s36, s72
    s_addc_u32 s53, s37, 0
    s_mov_b32 s54, 81920
    s_mov_b32 s55, 0x20000
    s_lshl_b32 s72, s73, 7
    s_add_u32 s56, s32, s72
    s_addc_u32 s57, s33, 0
    s_sub_u32 s58, 2211840, s72
    s_mov_b32 s59, 0x20000
    s_add_u32 s60, s34, s72
    s_addc_u32 s61, s35, 0
    s_sub_u32 s62, 2211840, s72
    s_mov_b32 s63, 0x20000
    s_lshr_b32 s72, s3, 1
    s_lshl_b32 s72, s72, 1
    v_xor_b32 v44, s72, v42
    v_lshrrev_b32 v45, 2, v41
    v_xor_b32 v45, v45, v44
    v_mul_u32_u24 v45, 320, v45
    v_and_b32 v46, 3, v41
    v_lshl_add_u32 v45, v46, 4, v45
    v_mul_u32_u24 v46, 1280, v42
    v_add_u32 v50, v45, v46
    v_lshrrev_b32 v45, 3, v40
    v_mul_u32_u24 v45, 3456, v45
    v_and_b32 v46, 7, v40
    v_lshl_add_u32 v51, v46, 4, v45
    v_lshrrev_b32 v44, 2, v41
    v_and_b32 v45, 3, v41
    v_and_b32 v46, 1, v42
    v_lshrrev_b32 v47, 1, v42
    v_lshl_add_u32 v48, v47, 2, v44
    v_lshlrev_b32 v48, 8, v48
    v_xor_b32 v49, s3, v44
    v_lshlrev_b32 v49, 2, v49
    v_lshl_add_u32 v49, v46, 1, v49
    v_lshrrev_b32 v52, 1, v45
    v_add_u32 v49, v49, v52
    v_lshl_add_u32 v48, v49, 4, v48
    v_and_b32 v52, 1, v45
    v_lshl_add_u32 v52, v52, 3, v48
    v_xor_b32 v53, 0x80, v52
    v_lshl_add_u32 v48, v47, 2, v44
    v_lshlrev_b32 v48, 7, v48
    v_lshl_add_u32 v48, v46, 12, v48
    v_lshl_add_u32 v48, v45, 3, v48
    s_lshl_b32 s72, s3, 5
    v_add_u32 v54, s72, v48
    s_mul_i32 s72, s3, 10240
    s_add_u32 s72, s72, 0
    s_lshl_b32 s73, s3, 11
    s_add_u32 s73, s73, 0
    s_mov_b32 m0, s73
    s_add_u32 s73, s73, 1024
    buffer_load_dwordx4 v50, s[48:51], s72 offen lds
    s_add_u32 s72, s72, 5120
    s_mov_b32 m0, s73
    s_nop 0
    buffer_load_dwordx4 v50, s[48:51], s72 offen lds
    s_mul_i32 s72, s3, 10240
    s_add_u32 s72, s72, 64
    s_lshl_b32 s73, s3, 11
    s_add_u32 s73, s73, 8192
    s_mov_b32 m0, s73
    s_add_u32 s73, s73, 1024
    buffer_load_dwordx4 v50, s[48:51], s72 offen lds
    s_add_u32 s72, s72, 5120
    s_mov_b32 m0, s73
    s_nop 0
    buffer_load_dwordx4 v50, s[48:51], s72 offen lds
    s_mul_i32 s72, s3, 10240
    s_add_u32 s72, s72, 128
    s_lshl_b32 s73, s3, 11
    s_add_u32 s73, s73, 16384
    s_mov_b32 m0, s73
    s_add_u32 s73, s73, 1024
    buffer_load_dwordx4 v50, s[48:51], s72 offen lds
    s_add_u32 s72, s72, 5120
    s_mov_b32 m0, s73
    s_nop 0
    buffer_load_dwordx4 v50, s[48:51], s72 offen lds
    s_mul_i32 s72, s3, 10240
    s_add_u32 s72, s72, 192
    s_lshl_b32 s73, s3, 11
    s_add_u32 s73, s73, 24576
    s_mov_b32 m0, s73
    s_add_u32 s73, s73, 1024
    buffer_load_dwordx4 v50, s[48:51], s72 offen lds
    s_add_u32 s72, s72, 5120
    s_mov_b32 m0, s73
    s_nop 0
    buffer_load_dwordx4 v50, s[48:51], s72 offen lds
    s_mul_i32 s72, s3, 10240
    s_add_u32 s72, s72, 256
    s_lshl_b32 s73, s3, 11
    s_add_u32 s73, s73, 32768
    s_mov_b32 m0, s73
    s_add_u32 s73, s73, 1024
    buffer_load_dwordx4 v50, s[48:51], s72 offen lds
    s_add_u32 s72, s72, 5120
    s_mov_b32 m0, s73
    s_nop 0
    buffer_load_dwordx4 v50, s[48:51], s72 offen lds
    s_mul_i32 s72, s3, 10240
    s_add_u32 s72, s72, 40960
    s_lshl_b32 s73, s3, 11
    s_add_u32 s73, s73, 40960
    s_mov_b32 m0, s73
    s_add_u32 s73, s73, 1024
    buffer_load_dwordx4 v50, s[48:51], s72 offen lds
    s_add_u32 s72, s72, 5120
    s_mov_b32 m0, s73
    s_nop 0
    buffer_load_dwordx4 v50, s[48:51], s72 offen lds
    s_waitcnt vmcnt(10)
    s_waitcnt lgkmcnt(0)
    s_barrier
    s_mul_i32 s72, s3, 10240
    s_add_u32 s72, s72, 41024
    s_lshl_b32 s73, s3, 11
    s_add_u32 s73, s73, 49152
    s_mov_b32 m0, s73
    s_add_u32 s73, s73, 1024
    buffer_load_dwordx4 v50, s[48:51], s72 offen lds
    s_add_u32 s72, s72, 5120
    s_mov_b32 m0, s73
    s_nop 0
    buffer_load_dwordx4 v50, s[48:51], s72 offen lds
    ds_read_b64_tr_b16 v[112:113], v52 offset:0
    ds_read_b64_tr_b16 v[114:115], v53 offset:4096
    ds_read_b64_tr_b16 v[116:117], v52 offset:2048
    ds_read_b64_tr_b16 v[118:119], v53 offset:6144
    s_waitcnt vmcnt(10)
    s_waitcnt lgkmcnt(0)
    s_barrier
    s_mul_i32 s72, s3, 10240
    s_add_u32 s72, s72, 41088
    s_lshl_b32 s73, s3, 11
    s_add_u32 s73, s73, 57344
    s_mov_b32 m0, s73
    s_add_u32 s73, s73, 1024
    buffer_load_dwordx4 v50, s[48:51], s72 offen lds
    s_add_u32 s72, s72, 5120
    s_mov_b32 m0, s73
    s_nop 0
    buffer_load_dwordx4 v50, s[48:51], s72 offen lds
    ds_read_b64_tr_b16 v[144:145], v52 offset:8192
    ds_read_b64_tr_b16 v[146:147], v53 offset:12288
    ds_read_b64_tr_b16 v[148:149], v52 offset:10240
    ds_read_b64_tr_b16 v[150:151], v53 offset:14336
    s_waitcnt vmcnt(10)
    s_waitcnt lgkmcnt(0)
    s_barrier
    s_mul_i32 s72, s3, 10240
    s_add_u32 s72, s72, 41152
    s_lshl_b32 s73, s3, 11
    s_add_u32 s73, s73, 0
    s_mov_b32 m0, s73
    s_add_u32 s73, s73, 1024
    buffer_load_dwordx4 v50, s[48:51], s72 offen lds
    s_add_u32 s72, s72, 5120
    s_mov_b32 m0, s73
    s_nop 0
    buffer_load_dwordx4 v50, s[48:51], s72 offen lds
    ds_read_b64_tr_b16 v[176:177], v52 offset:16384
    ds_read_b64_tr_b16 v[178:179], v53 offset:20480
    ds_read_b64_tr_b16 v[180:181], v52 offset:18432
    ds_read_b64_tr_b16 v[182:183], v53 offset:22528
    s_waitcnt vmcnt(10)
    s_waitcnt lgkmcnt(0)
    s_barrier
    s_mul_i32 s72, s3, 10240
    s_add_u32 s72, s72, 41216
    s_lshl_b32 s73, s3, 11
    s_add_u32 s73, s73, 8192
    s_mov_b32 m0, s73
    s_add_u32 s73, s73, 1024
    buffer_load_dwordx4 v50, s[48:51], s72 offen lds
    s_add_u32 s72, s72, 5120
    s_mov_b32 m0, s73
    s_nop 0
    buffer_load_dwordx4 v50, s[48:51], s72 offen lds
    ds_read_b64_tr_b16 v[208:209], v52 offset:24576
    ds_read_b64_tr_b16 v[210:211], v53 offset:28672
    ds_read_b64_tr_b16 v[212:213], v52 offset:26624
    ds_read_b64_tr_b16 v[214:215], v53 offset:30720
    s_waitcnt vmcnt(10)
    s_waitcnt lgkmcnt(0)
    s_barrier
    s_mul_i32 s72, s3, 10240
    s_add_u32 s72, s72, 81920
    s_lshl_b32 s73, s3, 11
    s_add_u32 s73, s73, 16384
    s_mov_b32 m0, s73
    s_add_u32 s73, s73, 1024
    buffer_load_dwordx4 v50, s[48:51], s72 offen lds
    s_add_u32 s72, s72, 5120
    s_mov_b32 m0, s73
    s_nop 0
    buffer_load_dwordx4 v50, s[48:51], s72 offen lds
    ds_read_b64_tr_b16 v[240:241], v52 offset:32768
    ds_read_b64_tr_b16 v[242:243], v53 offset:36864
    ds_read_b64_tr_b16 v[244:245], v52 offset:34816
    ds_read_b64_tr_b16 v[246:247], v53 offset:38912
    s_waitcnt vmcnt(10)
    s_waitcnt lgkmcnt(0)
    s_barrier
    s_mul_i32 s72, s3, 10240
    s_add_u32 s72, s72, 81984
    s_lshl_b32 s73, s3, 11
    s_add_u32 s73, s73, 24576
    s_mov_b32 m0, s73
    s_add_u32 s73, s73, 1024
    buffer_load_dwordx4 v50, s[48:51], s72 offen lds
    s_add_u32 s72, s72, 5120
    s_mov_b32 m0, s73
    s_nop 0
    buffer_load_dwordx4 v50, s[48:51], s72 offen lds
    ds_read_b64_tr_b16 v[120:121], v52 offset:40960
    ds_read_b64_tr_b16 v[122:123], v53 offset:45056
    ds_read_b64_tr_b16 v[124:125], v52 offset:43008
    ds_read_b64_tr_b16 v[126:127], v53 offset:47104
    s_waitcnt vmcnt(10)
    s_waitcnt lgkmcnt(0)
    s_barrier
    s_mul_i32 s72, s3, 10240
    s_add_u32 s72, s72, 82048
    s_lshl_b32 s73, s3, 11
    s_add_u32 s73, s73, 32768
    s_mov_b32 m0, s73
    s_add_u32 s73, s73, 1024
    buffer_load_dwordx4 v50, s[48:51], s72 offen lds
    s_add_u32 s72, s72, 5120
    s_mov_b32 m0, s73
    s_nop 0
    buffer_load_dwordx4 v50, s[48:51], s72 offen lds
    ds_read_b64_tr_b16 v[152:153], v52 offset:49152
    ds_read_b64_tr_b16 v[154:155], v53 offset:53248
    ds_read_b64_tr_b16 v[156:157], v52 offset:51200
    ds_read_b64_tr_b16 v[158:159], v53 offset:55296
    s_waitcnt vmcnt(10)
    s_waitcnt lgkmcnt(0)
    s_barrier
    s_mul_i32 s72, s3, 10240
    s_add_u32 s72, s72, 82112
    s_lshl_b32 s73, s3, 11
    s_add_u32 s73, s73, 40960
    s_mov_b32 m0, s73
    s_add_u32 s73, s73, 1024
    buffer_load_dwordx4 v50, s[48:51], s72 offen lds
    s_add_u32 s72, s72, 5120
    s_mov_b32 m0, s73
    s_nop 0
    buffer_load_dwordx4 v50, s[48:51], s72 offen lds
    ds_read_b64_tr_b16 v[184:185], v52 offset:57344
    ds_read_b64_tr_b16 v[186:187], v53 offset:61440
    ds_read_b64_tr_b16 v[188:189], v52 offset:59392
    ds_read_b64_tr_b16 v[190:191], v53 offset:63488
    s_waitcnt vmcnt(10)
    s_waitcnt lgkmcnt(0)
    s_barrier
    s_mul_i32 s72, s3, 10240
    s_add_u32 s72, s72, 82176
    s_lshl_b32 s73, s3, 11
    s_add_u32 s73, s73, 49152
    s_mov_b32 m0, s73
    s_add_u32 s73, s73, 1024
    buffer_load_dwordx4 v50, s[48:51], s72 offen lds
    s_add_u32 s72, s72, 5120
    s_mov_b32 m0, s73
    s_nop 0
    buffer_load_dwordx4 v50, s[48:51], s72 offen lds
    ds_read_b64_tr_b16 v[216:217], v52 offset:0
    ds_read_b64_tr_b16 v[218:219], v53 offset:4096
    ds_read_b64_tr_b16 v[220:221], v52 offset:2048
    ds_read_b64_tr_b16 v[222:223], v53 offset:6144
    s_waitcnt vmcnt(10)
    s_waitcnt lgkmcnt(0)
    s_barrier
    s_mul_i32 s72, s3, 10240
    s_add_u32 s72, s72, 122880
    s_lshl_b32 s73, s3, 11
    s_add_u32 s73, s73, 57344
    s_mov_b32 m0, s73
    s_add_u32 s73, s73, 1024
    buffer_load_dwordx4 v50, s[48:51], s72 offen lds
    s_add_u32 s72, s72, 5120
    s_mov_b32 m0, s73
    s_nop 0
    buffer_load_dwordx4 v50, s[48:51], s72 offen lds
    ds_read_b64_tr_b16 v[248:249], v52 offset:8192
    ds_read_b64_tr_b16 v[250:251], v53 offset:12288
    ds_read_b64_tr_b16 v[252:253], v52 offset:10240
    ds_read_b64_tr_b16 v[254:255], v53 offset:14336
    s_waitcnt vmcnt(10)
    s_waitcnt lgkmcnt(0)
    s_barrier
    s_mul_i32 s72, s3, 10240
    s_add_u32 s72, s72, 122944
    s_lshl_b32 s73, s3, 11
    s_add_u32 s73, s73, 0
    s_mov_b32 m0, s73
    s_add_u32 s73, s73, 1024
    buffer_load_dwordx4 v50, s[48:51], s72 offen lds
    s_add_u32 s72, s72, 5120
    s_mov_b32 m0, s73
    s_nop 0
    buffer_load_dwordx4 v50, s[48:51], s72 offen lds
    ds_read_b64_tr_b16 v[128:129], v52 offset:16384
    ds_read_b64_tr_b16 v[130:131], v53 offset:20480
    ds_read_b64_tr_b16 v[132:133], v52 offset:18432
    ds_read_b64_tr_b16 v[134:135], v53 offset:22528
    s_waitcnt vmcnt(10)
    s_waitcnt lgkmcnt(0)
    s_barrier
    s_mul_i32 s72, s3, 10240
    s_add_u32 s72, s72, 123008
    s_lshl_b32 s73, s3, 11
    s_add_u32 s73, s73, 8192
    s_mov_b32 m0, s73
    s_add_u32 s73, s73, 1024
    buffer_load_dwordx4 v50, s[48:51], s72 offen lds
    s_add_u32 s72, s72, 5120
    s_mov_b32 m0, s73
    s_nop 0
    buffer_load_dwordx4 v50, s[48:51], s72 offen lds
    ds_read_b64_tr_b16 v[160:161], v52 offset:24576
    ds_read_b64_tr_b16 v[162:163], v53 offset:28672
    ds_read_b64_tr_b16 v[164:165], v52 offset:26624
    ds_read_b64_tr_b16 v[166:167], v53 offset:30720
    s_waitcnt vmcnt(10)
    s_waitcnt lgkmcnt(0)
    s_barrier
    s_mul_i32 s72, s3, 10240
    s_add_u32 s72, s72, 123072
    s_lshl_b32 s73, s3, 11
    s_add_u32 s73, s73, 16384
    s_mov_b32 m0, s73
    s_add_u32 s73, s73, 1024
    buffer_load_dwordx4 v50, s[48:51], s72 offen lds
    s_add_u32 s72, s72, 5120
    s_mov_b32 m0, s73
    s_nop 0
    buffer_load_dwordx4 v50, s[48:51], s72 offen lds
    ds_read_b64_tr_b16 v[192:193], v52 offset:32768
    ds_read_b64_tr_b16 v[194:195], v53 offset:36864
    ds_read_b64_tr_b16 v[196:197], v52 offset:34816
    ds_read_b64_tr_b16 v[198:199], v53 offset:38912
    s_waitcnt vmcnt(10)
    s_waitcnt lgkmcnt(0)
    s_barrier
    s_mul_i32 s72, s3, 10240
    s_add_u32 s72, s72, 123136
    s_lshl_b32 s73, s3, 11
    s_add_u32 s73, s73, 24576
    s_mov_b32 m0, s73
    s_add_u32 s73, s73, 1024
    buffer_load_dwordx4 v50, s[48:51], s72 offen lds
    s_add_u32 s72, s72, 5120
    s_mov_b32 m0, s73
    s_nop 0
    buffer_load_dwordx4 v50, s[48:51], s72 offen lds
    ds_read_b64_tr_b16 v[224:225], v52 offset:40960
    ds_read_b64_tr_b16 v[226:227], v53 offset:45056
    ds_read_b64_tr_b16 v[228:229], v52 offset:43008
    ds_read_b64_tr_b16 v[230:231], v53 offset:47104
    s_waitcnt vmcnt(10)
    s_waitcnt lgkmcnt(0)
    s_barrier
    s_mul_i32 s72, s3, 10240
    s_add_u32 s72, s72, 0
    s_lshl_b32 s73, s3, 11
    s_add_u32 s73, s73, 32768
    s_mov_b32 m0, s73
    s_add_u32 s73, s73, 1024
    buffer_load_dwordx4 v50, s[52:55], s72 offen lds
    s_add_u32 s72, s72, 5120
    s_mov_b32 m0, s73
    s_nop 0
    buffer_load_dwordx4 v50, s[52:55], s72 offen lds
    ds_read_b64_tr_b16 a[0:1], v52 offset:49152
    ds_read_b64_tr_b16 a[2:3], v53 offset:53248
    ds_read_b64_tr_b16 a[4:5], v52 offset:51200
    ds_read_b64_tr_b16 a[6:7], v53 offset:55296
    s_waitcnt vmcnt(10)
    s_waitcnt lgkmcnt(0)
    s_barrier
    s_mul_i32 s72, s3, 10240
    s_add_u32 s72, s72, 64
    s_lshl_b32 s73, s3, 11
    s_add_u32 s73, s73, 40960
    s_mov_b32 m0, s73
    s_add_u32 s73, s73, 1024
    buffer_load_dwordx4 v50, s[52:55], s72 offen lds
    s_add_u32 s72, s72, 5120
    s_mov_b32 m0, s73
    s_nop 0
    buffer_load_dwordx4 v50, s[52:55], s72 offen lds
    ds_read_b64_tr_b16 v[136:137], v52 offset:57344
    ds_read_b64_tr_b16 v[138:139], v53 offset:61440
    ds_read_b64_tr_b16 v[140:141], v52 offset:59392
    ds_read_b64_tr_b16 v[142:143], v53 offset:63488
    s_waitcnt vmcnt(10)
    s_waitcnt lgkmcnt(0)
    s_barrier
    s_mul_i32 s72, s3, 10240
    s_add_u32 s72, s72, 128
    s_lshl_b32 s73, s3, 11
    s_add_u32 s73, s73, 49152
    s_mov_b32 m0, s73
    s_add_u32 s73, s73, 1024
    buffer_load_dwordx4 v50, s[52:55], s72 offen lds
    s_add_u32 s72, s72, 5120
    s_mov_b32 m0, s73
    s_nop 0
    buffer_load_dwordx4 v50, s[52:55], s72 offen lds
    ds_read_b64_tr_b16 v[168:169], v52 offset:0
    ds_read_b64_tr_b16 v[170:171], v53 offset:4096
    ds_read_b64_tr_b16 v[172:173], v52 offset:2048
    ds_read_b64_tr_b16 v[174:175], v53 offset:6144
    s_waitcnt vmcnt(10)
    s_waitcnt lgkmcnt(0)
    s_barrier
    s_mul_i32 s72, s3, 10240
    s_add_u32 s72, s72, 192
    s_lshl_b32 s73, s3, 11
    s_add_u32 s73, s73, 57344
    s_mov_b32 m0, s73
    s_add_u32 s73, s73, 1024
    buffer_load_dwordx4 v50, s[52:55], s72 offen lds
    s_add_u32 s72, s72, 5120
    s_mov_b32 m0, s73
    s_nop 0
    buffer_load_dwordx4 v50, s[52:55], s72 offen lds
    ds_read_b64_tr_b16 v[200:201], v52 offset:8192
    ds_read_b64_tr_b16 v[202:203], v53 offset:12288
    ds_read_b64_tr_b16 v[204:205], v52 offset:10240
    ds_read_b64_tr_b16 v[206:207], v53 offset:14336
    s_waitcnt vmcnt(10)
    s_waitcnt lgkmcnt(0)
    s_barrier
    s_mul_i32 s72, s3, 10240
    s_add_u32 s72, s72, 256
    s_lshl_b32 s73, s3, 11
    s_add_u32 s73, s73, 0
    s_mov_b32 m0, s73
    s_add_u32 s73, s73, 1024
    buffer_load_dwordx4 v50, s[52:55], s72 offen lds
    s_add_u32 s72, s72, 5120
    s_mov_b32 m0, s73
    s_nop 0
    buffer_load_dwordx4 v50, s[52:55], s72 offen lds
    ds_read_b64_tr_b16 v[232:233], v52 offset:16384
    ds_read_b64_tr_b16 v[234:235], v53 offset:20480
    ds_read_b64_tr_b16 v[236:237], v52 offset:18432
    ds_read_b64_tr_b16 v[238:239], v53 offset:22528
    s_waitcnt vmcnt(10)
    s_waitcnt lgkmcnt(0)
    s_barrier
    s_mul_i32 s72, s3, 10240
    s_add_u32 s72, s72, 40960
    s_lshl_b32 s73, s3, 11
    s_add_u32 s73, s73, 8192
    s_mov_b32 m0, s73
    s_add_u32 s73, s73, 1024
    buffer_load_dwordx4 v50, s[52:55], s72 offen lds
    s_add_u32 s72, s72, 5120
    s_mov_b32 m0, s73
    s_nop 0
    buffer_load_dwordx4 v50, s[52:55], s72 offen lds
    ds_read_b64_tr_b16 a[8:9], v52 offset:24576
    ds_read_b64_tr_b16 a[10:11], v53 offset:28672
    ds_read_b64_tr_b16 a[12:13], v52 offset:26624
    ds_read_b64_tr_b16 a[14:15], v53 offset:30720
    s_waitcnt vmcnt(10)
    s_waitcnt lgkmcnt(0)
    s_barrier
    s_mul_i32 s72, s3, 10240
    s_add_u32 s72, s72, 41024
    s_lshl_b32 s73, s3, 11
    s_add_u32 s73, s73, 16384
    s_mov_b32 m0, s73
    s_add_u32 s73, s73, 1024
    buffer_load_dwordx4 v50, s[52:55], s72 offen lds
    s_add_u32 s72, s72, 5120
    s_mov_b32 m0, s73
    s_nop 0
    buffer_load_dwordx4 v50, s[52:55], s72 offen lds
    ds_read_b64_tr_b16 a[176:177], v52 offset:32768
    ds_read_b64_tr_b16 a[178:179], v52 offset:34816
    ds_read_b64_tr_b16 a[180:181], v53 offset:36864
    ds_read_b64_tr_b16 a[182:183], v53 offset:38912
    s_waitcnt vmcnt(10)
    s_waitcnt lgkmcnt(0)
    s_barrier
    s_mul_i32 s72, s3, 10240
    s_add_u32 s72, s72, 41088
    s_lshl_b32 s73, s3, 11
    s_add_u32 s73, s73, 24576
    s_mov_b32 m0, s73
    s_add_u32 s73, s73, 1024
    buffer_load_dwordx4 v50, s[52:55], s72 offen lds
    s_add_u32 s72, s72, 5120
    s_mov_b32 m0, s73
    s_nop 0
    buffer_load_dwordx4 v50, s[52:55], s72 offen lds
    ds_read_b64_tr_b16 a[192:193], v52 offset:40960
    ds_read_b64_tr_b16 a[194:195], v52 offset:43008
    ds_read_b64_tr_b16 a[196:197], v53 offset:45056
    ds_read_b64_tr_b16 a[198:199], v53 offset:47104
    s_waitcnt vmcnt(10)
    s_waitcnt lgkmcnt(0)
    s_barrier
    s_mul_i32 s72, s3, 10240
    s_add_u32 s72, s72, 41152
    s_lshl_b32 s73, s3, 11
    s_add_u32 s73, s73, 32768
    s_mov_b32 m0, s73
    s_add_u32 s73, s73, 1024
    buffer_load_dwordx4 v50, s[52:55], s72 offen lds
    s_add_u32 s72, s72, 5120
    s_mov_b32 m0, s73
    s_nop 0
    buffer_load_dwordx4 v50, s[52:55], s72 offen lds
    ds_read_b64_tr_b16 a[208:209], v52 offset:49152
    ds_read_b64_tr_b16 a[210:211], v52 offset:51200
    ds_read_b64_tr_b16 a[212:213], v53 offset:53248
    ds_read_b64_tr_b16 a[214:215], v53 offset:55296
    s_waitcnt vmcnt(10)
    s_waitcnt lgkmcnt(0)
    s_barrier
    s_mul_i32 s72, s3, 10240
    s_add_u32 s72, s72, 41216
    s_lshl_b32 s73, s3, 11
    s_add_u32 s73, s73, 40960
    s_mov_b32 m0, s73
    s_add_u32 s73, s73, 1024
    buffer_load_dwordx4 v50, s[52:55], s72 offen lds
    s_add_u32 s72, s72, 5120
    s_mov_b32 m0, s73
    s_nop 0
    buffer_load_dwordx4 v50, s[52:55], s72 offen lds
    ds_read_b64_tr_b16 a[224:225], v52 offset:57344
    ds_read_b64_tr_b16 a[226:227], v52 offset:59392
    ds_read_b64_tr_b16 a[228:229], v53 offset:61440
    ds_read_b64_tr_b16 a[230:231], v53 offset:63488
    s_waitcnt vmcnt(10)
    s_waitcnt lgkmcnt(0)
    s_barrier
    s_mul_i32 s72, s3, 27648
    s_add_u32 s72, s72, 0
    s_lshl_b32 s73, s3, 10
    s_add_u32 s73, s73, 49152
    s_mov_b32 m0, s73
    s_add_u32 s73, s73, 4096
    buffer_load_dwordx4 v51, s[56:59], s72 offen lds
    s_mov_b32 m0, s73
    s_nop 0
    buffer_load_dwordx4 v51, s[60:63], s72 offen lds
    ds_read_b64_tr_b16 a[240:241], v52 offset:0
    ds_read_b64_tr_b16 a[242:243], v52 offset:2048
    ds_read_b64_tr_b16 a[244:245], v53 offset:4096
    ds_read_b64_tr_b16 a[246:247], v53 offset:6144
    s_waitcnt vmcnt(10)
    s_waitcnt lgkmcnt(0)
    s_barrier
    s_mul_i32 s72, s3, 27648
    s_add_u32 s72, s72, 110592
    s_lshl_b32 s73, s3, 10
    s_add_u32 s73, s73, 57344
    s_mov_b32 m0, s73
    s_add_u32 s73, s73, 4096
    buffer_load_dwordx4 v51, s[56:59], s72 offen lds
    s_mov_b32 m0, s73
    s_nop 0
    buffer_load_dwordx4 v51, s[60:63], s72 offen lds
    ds_read_b64_tr_b16 a[184:185], v52 offset:8192
    ds_read_b64_tr_b16 a[186:187], v52 offset:10240
    ds_read_b64_tr_b16 a[188:189], v53 offset:12288
    ds_read_b64_tr_b16 a[190:191], v53 offset:14336
    s_waitcnt vmcnt(10)
    s_waitcnt lgkmcnt(0)
    s_barrier
    s_mul_i32 s72, s3, 27648
    s_add_u32 s72, s72, 221184
    s_lshl_b32 s73, s3, 10
    s_add_u32 s73, s73, 0
    s_mov_b32 m0, s73
    s_add_u32 s73, s73, 4096
    buffer_load_dwordx4 v51, s[56:59], s72 offen lds
    s_mov_b32 m0, s73
    s_nop 0
    buffer_load_dwordx4 v51, s[60:63], s72 offen lds
    ds_read_b64_tr_b16 a[200:201], v52 offset:16384
    ds_read_b64_tr_b16 a[202:203], v52 offset:18432
    ds_read_b64_tr_b16 a[204:205], v53 offset:20480
    ds_read_b64_tr_b16 a[206:207], v53 offset:22528
    s_waitcnt vmcnt(10)
    s_waitcnt lgkmcnt(0)
    s_barrier
    s_mul_i32 s72, s3, 27648
    s_add_u32 s72, s72, 331776
    s_lshl_b32 s73, s3, 10
    s_add_u32 s73, s73, 8192
    s_mov_b32 m0, s73
    s_add_u32 s73, s73, 4096
    buffer_load_dwordx4 v51, s[56:59], s72 offen lds
    s_mov_b32 m0, s73
    s_nop 0
    buffer_load_dwordx4 v51, s[60:63], s72 offen lds
    ds_read_b64_tr_b16 a[216:217], v52 offset:24576
    ds_read_b64_tr_b16 a[218:219], v52 offset:26624
    ds_read_b64_tr_b16 a[220:221], v53 offset:28672
    ds_read_b64_tr_b16 a[222:223], v53 offset:30720
    s_waitcnt vmcnt(10)
    s_waitcnt lgkmcnt(0)
    s_barrier
    s_mul_i32 s72, s3, 27648
    s_add_u32 s72, s72, 442368
    s_lshl_b32 s73, s3, 10
    s_add_u32 s73, s73, 16384
    s_mov_b32 m0, s73
    s_add_u32 s73, s73, 4096
    buffer_load_dwordx4 v51, s[56:59], s72 offen lds
    s_mov_b32 m0, s73
    s_nop 0
    buffer_load_dwordx4 v51, s[60:63], s72 offen lds
    ds_read_b64_tr_b16 a[232:233], v52 offset:32768
    ds_read_b64_tr_b16 a[234:235], v52 offset:34816
    ds_read_b64_tr_b16 a[236:237], v53 offset:36864
    ds_read_b64_tr_b16 a[238:239], v53 offset:38912
    s_waitcnt vmcnt(10)
    s_waitcnt lgkmcnt(0)
    s_barrier
    s_mul_i32 s72, s3, 27648
    s_add_u32 s72, s72, 552960
    s_lshl_b32 s73, s3, 10
    s_add_u32 s73, s73, 24576
    s_mov_b32 m0, s73
    s_add_u32 s73, s73, 4096
    buffer_load_dwordx4 v51, s[56:59], s72 offen lds
    s_mov_b32 m0, s73
    s_nop 0
    buffer_load_dwordx4 v51, s[60:63], s72 offen lds
    ds_read_b64_tr_b16 a[248:249], v52 offset:40960
    ds_read_b64_tr_b16 a[250:251], v52 offset:43008
    ds_read_b64_tr_b16 a[252:253], v53 offset:45056
    ds_read_b64_tr_b16 a[254:255], v53 offset:47104
    s_waitcnt vmcnt(10)
    s_waitcnt lgkmcnt(0)
    s_barrier
    s_mul_i32 s72, s3, 27648
    s_add_u32 s72, s72, 663552
    s_lshl_b32 s73, s3, 10
    s_add_u32 s73, s73, 32768
    s_mov_b32 m0, s73
    s_add_u32 s73, s73, 4096
    buffer_load_dwordx4 v51, s[56:59], s72 offen lds
    s_mov_b32 m0, s73
    s_nop 0
    buffer_load_dwordx4 v51, s[60:63], s72 offen lds
    ds_read_b64_tr_b16 a[16:17], v54 offset:49152
    ds_read_b64_tr_b16 a[18:19], v54 offset:50176
    ds_read_b64_tr_b16 a[20:21], v54 offset:51200
    ds_read_b64_tr_b16 a[22:23], v54 offset:52224
    s_waitcnt vmcnt(10)
    s_waitcnt lgkmcnt(0)
    s_barrier
    s_mul_i32 s72, s3, 27648
    s_add_u32 s72, s72, 774144
    s_lshl_b32 s73, s3, 10
    s_add_u32 s73, s73, 40960
    s_mov_b32 m0, s73
    s_add_u32 s73, s73, 4096
    buffer_load_dwordx4 v51, s[56:59], s72 offen lds
    s_mov_b32 m0, s73
    s_nop 0
    buffer_load_dwordx4 v51, s[60:63], s72 offen lds
    ds_read_b64_tr_b16 a[24:25], v54 offset:57344
    ds_read_b64_tr_b16 a[26:27], v54 offset:58368
    ds_read_b64_tr_b16 a[28:29], v54 offset:59392
    ds_read_b64_tr_b16 a[30:31], v54 offset:60416
    s_waitcnt vmcnt(10)
    s_waitcnt lgkmcnt(0)
    s_barrier
    s_mul_i32 s72, s3, 27648
    s_add_u32 s72, s72, 884736
    s_lshl_b32 s73, s3, 10
    s_add_u32 s73, s73, 49152
    s_mov_b32 m0, s73
    s_add_u32 s73, s73, 4096
    buffer_load_dwordx4 v51, s[56:59], s72 offen lds
    s_mov_b32 m0, s73
    s_nop 0
    buffer_load_dwordx4 v51, s[60:63], s72 offen lds
    ds_read_b64_tr_b16 a[32:33], v54 offset:0
    ds_read_b64_tr_b16 a[34:35], v54 offset:1024
    ds_read_b64_tr_b16 a[36:37], v54 offset:2048
    ds_read_b64_tr_b16 a[38:39], v54 offset:3072
    s_waitcnt vmcnt(10)
    s_waitcnt lgkmcnt(0)
    s_barrier
    s_mul_i32 s72, s3, 27648
    s_add_u32 s72, s72, 995328
    s_lshl_b32 s73, s3, 10
    s_add_u32 s73, s73, 57344
    s_mov_b32 m0, s73
    s_add_u32 s73, s73, 4096
    buffer_load_dwordx4 v51, s[56:59], s72 offen lds
    s_mov_b32 m0, s73
    s_nop 0
    buffer_load_dwordx4 v51, s[60:63], s72 offen lds
    ds_read_b64_tr_b16 a[40:41], v54 offset:8192
    ds_read_b64_tr_b16 a[42:43], v54 offset:9216
    ds_read_b64_tr_b16 a[44:45], v54 offset:10240
    ds_read_b64_tr_b16 a[46:47], v54 offset:11264
    s_waitcnt vmcnt(10)
    s_waitcnt lgkmcnt(0)
    s_barrier
    s_mul_i32 s72, s3, 27648
    s_add_u32 s72, s72, 1105920
    s_lshl_b32 s73, s3, 10
    s_add_u32 s73, s73, 0
    s_mov_b32 m0, s73
    s_add_u32 s73, s73, 4096
    buffer_load_dwordx4 v51, s[56:59], s72 offen lds
    s_mov_b32 m0, s73
    s_nop 0
    buffer_load_dwordx4 v51, s[60:63], s72 offen lds
    ds_read_b64_tr_b16 a[48:49], v54 offset:16384
    ds_read_b64_tr_b16 a[50:51], v54 offset:17408
    ds_read_b64_tr_b16 a[52:53], v54 offset:18432
    ds_read_b64_tr_b16 a[54:55], v54 offset:19456
    s_waitcnt vmcnt(10)
    s_waitcnt lgkmcnt(0)
    s_barrier
    s_mul_i32 s72, s3, 27648
    s_add_u32 s72, s72, 1216512
    s_lshl_b32 s73, s3, 10
    s_add_u32 s73, s73, 8192
    s_mov_b32 m0, s73
    s_add_u32 s73, s73, 4096
    buffer_load_dwordx4 v51, s[56:59], s72 offen lds
    s_mov_b32 m0, s73
    s_nop 0
    buffer_load_dwordx4 v51, s[60:63], s72 offen lds
    ds_read_b64_tr_b16 a[56:57], v54 offset:24576
    ds_read_b64_tr_b16 a[58:59], v54 offset:25600
    ds_read_b64_tr_b16 a[60:61], v54 offset:26624
    ds_read_b64_tr_b16 a[62:63], v54 offset:27648
    s_waitcnt vmcnt(10)
    s_waitcnt lgkmcnt(0)
    s_barrier
    s_mul_i32 s72, s3, 27648
    s_add_u32 s72, s72, 1327104
    s_lshl_b32 s73, s3, 10
    s_add_u32 s73, s73, 16384
    s_mov_b32 m0, s73
    s_add_u32 s73, s73, 4096
    buffer_load_dwordx4 v51, s[56:59], s72 offen lds
    s_mov_b32 m0, s73
    s_nop 0
    buffer_load_dwordx4 v51, s[60:63], s72 offen lds
    ds_read_b64_tr_b16 a[64:65], v54 offset:32768
    ds_read_b64_tr_b16 a[66:67], v54 offset:33792
    ds_read_b64_tr_b16 a[68:69], v54 offset:34816
    ds_read_b64_tr_b16 a[70:71], v54 offset:35840
    s_waitcnt vmcnt(10)
    s_waitcnt lgkmcnt(0)
    s_barrier
    s_mul_i32 s72, s3, 27648
    s_add_u32 s72, s72, 1437696
    s_lshl_b32 s73, s3, 10
    s_add_u32 s73, s73, 24576
    s_mov_b32 m0, s73
    s_add_u32 s73, s73, 4096
    buffer_load_dwordx4 v51, s[56:59], s72 offen lds
    s_mov_b32 m0, s73
    s_nop 0
    buffer_load_dwordx4 v51, s[60:63], s72 offen lds
    ds_read_b64_tr_b16 a[72:73], v54 offset:40960
    ds_read_b64_tr_b16 a[74:75], v54 offset:41984
    ds_read_b64_tr_b16 a[76:77], v54 offset:43008
    ds_read_b64_tr_b16 a[78:79], v54 offset:44032
    s_waitcnt vmcnt(10)
    s_waitcnt lgkmcnt(0)
    s_barrier
    s_mul_i32 s72, s3, 27648
    s_add_u32 s72, s72, 1548288
    s_lshl_b32 s73, s3, 10
    s_add_u32 s73, s73, 32768
    s_mov_b32 m0, s73
    s_add_u32 s73, s73, 4096
    buffer_load_dwordx4 v51, s[56:59], s72 offen lds
    s_mov_b32 m0, s73
    s_nop 0
    buffer_load_dwordx4 v51, s[60:63], s72 offen lds
    ds_read_b64_tr_b16 a[80:81], v54 offset:49152
    ds_read_b64_tr_b16 a[82:83], v54 offset:50176
    ds_read_b64_tr_b16 a[84:85], v54 offset:51200
    ds_read_b64_tr_b16 a[86:87], v54 offset:52224
    s_waitcnt vmcnt(10)
    s_waitcnt lgkmcnt(0)
    s_barrier
    s_mul_i32 s72, s3, 27648
    s_add_u32 s72, s72, 1658880
    s_lshl_b32 s73, s3, 10
    s_add_u32 s73, s73, 40960
    s_mov_b32 m0, s73
    s_add_u32 s73, s73, 4096
    buffer_load_dwordx4 v51, s[56:59], s72 offen lds
    s_mov_b32 m0, s73
    s_nop 0
    buffer_load_dwordx4 v51, s[60:63], s72 offen lds
    ds_read_b64_tr_b16 a[88:89], v54 offset:57344
    ds_read_b64_tr_b16 a[90:91], v54 offset:58368
    ds_read_b64_tr_b16 a[92:93], v54 offset:59392
    ds_read_b64_tr_b16 a[94:95], v54 offset:60416
    s_waitcnt vmcnt(10)
    s_waitcnt lgkmcnt(0)
    s_barrier
    s_mul_i32 s72, s3, 27648
    s_add_u32 s72, s72, 1769472
    s_lshl_b32 s73, s3, 10
    s_add_u32 s73, s73, 49152
    s_mov_b32 m0, s73
    s_add_u32 s73, s73, 4096
    buffer_load_dwordx4 v51, s[56:59], s72 offen lds
    s_mov_b32 m0, s73
    s_nop 0
    buffer_load_dwordx4 v51, s[60:63], s72 offen lds
    ds_read_b64_tr_b16 a[96:97], v54 offset:0
    ds_read_b64_tr_b16 a[98:99], v54 offset:1024
    ds_read_b64_tr_b16 a[100:101], v54 offset:2048
    ds_read_b64_tr_b16 a[102:103], v54 offset:3072
    s_waitcnt vmcnt(10)
    s_waitcnt lgkmcnt(0)
    s_barrier
    s_mul_i32 s72, s3, 27648
    s_add_u32 s72, s72, 1880064
    s_lshl_b32 s73, s3, 10
    s_add_u32 s73, s73, 57344
    s_mov_b32 m0, s73
    s_add_u32 s73, s73, 4096
    buffer_load_dwordx4 v51, s[56:59], s72 offen lds
    s_mov_b32 m0, s73
    s_nop 0
    buffer_load_dwordx4 v51, s[60:63], s72 offen lds
    ds_read_b64_tr_b16 a[104:105], v54 offset:8192
    ds_read_b64_tr_b16 a[106:107], v54 offset:9216
    ds_read_b64_tr_b16 a[108:109], v54 offset:10240
    ds_read_b64_tr_b16 a[110:111], v54 offset:11264
    s_waitcnt vmcnt(10)
    s_waitcnt lgkmcnt(0)
    s_barrier
    s_mul_i32 s72, s3, 27648
    s_add_u32 s72, s72, 1990656
    s_lshl_b32 s73, s3, 10
    s_add_u32 s73, s73, 0
    s_mov_b32 m0, s73
    s_add_u32 s73, s73, 4096
    buffer_load_dwordx4 v51, s[56:59], s72 offen lds
    s_mov_b32 m0, s73
    s_nop 0
    buffer_load_dwordx4 v51, s[60:63], s72 offen lds
    ds_read_b64_tr_b16 a[112:113], v54 offset:16384
    ds_read_b64_tr_b16 a[114:115], v54 offset:17408
    ds_read_b64_tr_b16 a[116:117], v54 offset:18432
    ds_read_b64_tr_b16 a[118:119], v54 offset:19456
    s_waitcnt vmcnt(10)
    s_waitcnt lgkmcnt(0)
    s_barrier
    s_mul_i32 s72, s3, 27648
    s_add_u32 s72, s72, 2101248
    s_lshl_b32 s73, s3, 10
    s_add_u32 s73, s73, 8192
    s_mov_b32 m0, s73
    s_add_u32 s73, s73, 4096
    buffer_load_dwordx4 v51, s[56:59], s72 offen lds
    s_mov_b32 m0, s73
    s_nop 0
    buffer_load_dwordx4 v51, s[60:63], s72 offen lds
    ds_read_b64_tr_b16 a[120:121], v54 offset:24576
    ds_read_b64_tr_b16 a[122:123], v54 offset:25600
    ds_read_b64_tr_b16 a[124:125], v54 offset:26624
    ds_read_b64_tr_b16 a[126:127], v54 offset:27648
    s_waitcnt vmcnt(10)
    s_waitcnt lgkmcnt(0)
    s_barrier
    ds_read_b64_tr_b16 a[128:129], v54 offset:32768
    ds_read_b64_tr_b16 a[130:131], v54 offset:33792
    ds_read_b64_tr_b16 a[132:133], v54 offset:34816
    ds_read_b64_tr_b16 a[134:135], v54 offset:35840
    s_waitcnt vmcnt(8)
    s_waitcnt lgkmcnt(0)
    s_barrier
    ds_read_b64_tr_b16 a[136:137], v54 offset:40960
    ds_read_b64_tr_b16 a[138:139], v54 offset:41984
    ds_read_b64_tr_b16 a[140:141], v54 offset:43008
    ds_read_b64_tr_b16 a[142:143], v54 offset:44032
    s_waitcnt vmcnt(6)
    s_waitcnt lgkmcnt(0)
    s_barrier
    ds_read_b64_tr_b16 a[144:145], v54 offset:49152
    ds_read_b64_tr_b16 a[146:147], v54 offset:50176
    ds_read_b64_tr_b16 a[148:149], v54 offset:51200
    ds_read_b64_tr_b16 a[150:151], v54 offset:52224
    s_waitcnt vmcnt(4)
    s_waitcnt lgkmcnt(0)
    s_barrier
    ds_read_b64_tr_b16 a[152:153], v54 offset:57344
    ds_read_b64_tr_b16 a[154:155], v54 offset:58368
    ds_read_b64_tr_b16 a[156:157], v54 offset:59392
    ds_read_b64_tr_b16 a[158:159], v54 offset:60416
    s_waitcnt vmcnt(2)
    s_waitcnt lgkmcnt(0)
    s_barrier
    ds_read_b64_tr_b16 a[160:161], v54 offset:0
    ds_read_b64_tr_b16 a[162:163], v54 offset:1024
    ds_read_b64_tr_b16 a[164:165], v54 offset:2048
    ds_read_b64_tr_b16 a[166:167], v54 offset:3072
    s_waitcnt vmcnt(0)
    s_waitcnt lgkmcnt(0)
    s_barrier
    ds_read_b64_tr_b16 a[168:169], v54 offset:8192
    ds_read_b64_tr_b16 a[170:171], v54 offset:9216
    ds_read_b64_tr_b16 a[172:173], v54 offset:10240
    ds_read_b64_tr_b16 a[174:175], v54 offset:11264
    s_waitcnt vmcnt(0) lgkmcnt(0)
    s_barrier
    v_mov_b32 v44, 0x3f803f80
    v_mov_b32 v45, 0x3f803f80
    v_mov_b32 v46, 0x3f803f80
    v_mov_b32 v47, 0x3f803f80
    s_nop 1
    v_mfma_f32_32x32x16_bf16 v[14:29], a[16:19], v[44:47], 0
    v_mfma_f32_32x32x16_bf16 v[14:29], a[20:23], v[44:47], v[14:29]
    v_mfma_f32_32x32x16_bf16 v[14:29], a[24:27], v[44:47], v[14:29]
    v_mfma_f32_32x32x16_bf16 v[14:29], a[28:31], v[44:47], v[14:29]
    v_mfma_f32_32x32x16_bf16 v[14:29], a[32:35], v[44:47], v[14:29]
    v_mfma_f32_32x32x16_bf16 v[14:29], a[36:39], v[44:47], v[14:29]
    v_mfma_f32_32x32x16_bf16 v[14:29], a[40:43], v[44:47], v[14:29]
    v_mfma_f32_32x32x16_bf16 v[14:29], a[44:47], v[44:47], v[14:29]
    v_mfma_f32_32x32x16_bf16 v[14:29], a[48:51], v[44:47], v[14:29]
    v_mfma_f32_32x32x16_bf16 v[14:29], a[52:55], v[44:47], v[14:29]
    v_mfma_f32_32x32x16_bf16 v[14:29], a[56:59], v[44:47], v[14:29]
    v_mfma_f32_32x32x16_bf16 v[14:29], a[60:63], v[44:47], v[14:29]
    v_mfma_f32_32x32x16_bf16 v[14:29], a[64:67], v[44:47], v[14:29]
    v_mfma_f32_32x32x16_bf16 v[14:29], a[68:71], v[44:47], v[14:29]
    v_mfma_f32_32x32x16_bf16 v[14:29], a[72:75], v[44:47], v[14:29]
    v_mfma_f32_32x32x16_bf16 v[14:29], a[76:79], v[44:47], v[14:29]
    v_mfma_f32_32x32x16_bf16 v[14:29], a[80:83], v[44:47], v[14:29]
    v_mfma_f32_32x32x16_bf16 v[14:29], a[84:87], v[44:47], v[14:29]
    v_mfma_f32_32x32x16_bf16 v[14:29], a[88:91], v[44:47], v[14:29]
    v_mfma_f32_32x32x16_bf16 v[14:29], a[92:95], v[44:47], v[14:29]
    v_mfma_f32_32x32x16_bf16 v[14:29], a[96:99], v[44:47], v[14:29]
    v_mfma_f32_32x32x16_bf16 v[14:29], a[100:103], v[44:47], v[14:29]
    v_mfma_f32_32x32x16_bf16 v[14:29], a[104:107], v[44:47], v[14:29]
    v_mfma_f32_32x32x16_bf16 v[14:29], a[108:111], v[44:47], v[14:29]
    v_mfma_f32_32x32x16_bf16 v[14:29], a[112:115], v[44:47], v[14:29]
    v_mfma_f32_32x32x16_bf16 v[14:29], a[116:119], v[44:47], v[14:29]
    v_mfma_f32_32x32x16_bf16 v[14:29], a[120:123], v[44:47], v[14:29]
    v_mfma_f32_32x32x16_bf16 v[14:29], a[124:127], v[44:47], v[14:29]
    v_mfma_f32_32x32x16_bf16 v[14:29], a[128:131], v[44:47], v[14:29]
    v_mfma_f32_32x32x16_bf16 v[14:29], a[132:135], v[44:47], v[14:29]
    v_mfma_f32_32x32x16_bf16 v[14:29], a[136:139], v[44:47], v[14:29]
    v_mfma_f32_32x32x16_bf16 v[14:29], a[140:143], v[44:47], v[14:29]
    v_mfma_f32_32x32x16_bf16 v[14:29], a[144:147], v[44:47], v[14:29]
    v_mfma_f32_32x32x16_bf16 v[14:29], a[148:151], v[44:47], v[14:29]
    v_mfma_f32_32x32x16_bf16 v[14:29], a[152:155], v[44:47], v[14:29]
    v_mfma_f32_32x32x16_bf16 v[14:29], a[156:159], v[44:47], v[14:29]
    v_mfma_f32_32x32x16_bf16 v[14:29], a[160:163], v[44:47], v[14:29]
    v_mfma_f32_32x32x16_bf16 v[14:29], a[164:167], v[44:47], v[14:29]
    v_mfma_f32_32x32x16_bf16 v[14:29], a[168:171], v[44:47], v[14:29]
    v_mfma_f32_32x32x16_bf16 v[14:29], a[172:175], v[44:47], v[14:29]
    s_cmp_lg_u32 s65, 27
    s_cbranch_scc1 L_po_nz
    v_mov_b32 v48, 0
    v_mov_b32 v49, 0
    v_mov_b32 v50, 0
    v_mov_b32 v51, 0
    v_lshrrev_b32 v44, 8, v38
    v_and_b32 v45, 0xff, v38
    v_lshl_add_u32 v44, v44, 13, v45
    s_add_u32 s72, s68, 1317632
    buffer_store_dwordx4 v[48:51], v44, s[44:47], s72 offen sc1
    s_add_u32 s72, s72, 131072
    buffer_store_dwordx4 v[48:51], v44, s[44:47], s72 offen sc1
    s_add_u32 s72, s72, 131072
    buffer_store_dwordx4 v[48:51], v44, s[44:47], s72 offen sc1
    s_add_u32 s72, s72, 131072
    buffer_store_dwordx4 v[48:51], v44, s[44:47], s72 offen sc1
    s_add_u32 s72, s72, 131072
    buffer_store_dwordx4 v[48:51], v44, s[44:47], s72 offen sc1
    s_add_u32 s72, s72, 131072
    buffer_store_dwordx4 v[48:51], v44, s[44:47], s72 offen sc1
    s_add_u32 s72, s72, 131072
    buffer_store_dwordx4 v[48:51], v44, s[44:47], s72 offen sc1
    s_add_u32 s72, s72, 131072
    buffer_store_dwordx4 v[48:51], v44, s[44:47], s72 offen sc1
    s_add_u32 s72, s72, 131072
    buffer_store_dwordx4 v[48:51], v44, s[44:47], s72 offen sc1
    s_add_u32 s72, s72, 131072
    buffer_store_dwordx4 v[48:51], v44, s[44:47], s72 offen sc1
    s_waitcnt vmcnt(0)
L_po_nz:
    s_nop 15
    v_mov_b32 v44, 144
    s_mov_b32 s12, 0
L_wc_4:
    global_load_dword v45, v44, s[40:41] sc1
    s_waitcnt vmcnt(0)
    v_readfirstlane_b32 s6, v45
    s_add_u32 s12, s12, 1
    s_cmp_ge_u32 s6, 128
    s_cbranch_scc1 L_wc_4_out
    s_sleep 8
    s_cmp_lt_u32 s12, 100000
    s_cbranch_scc1 L_wc_4
L_wc_4_out:
    s_mov_b32 s48, s16
    s_mov_b32 s49, s17
    s_mov_b32 s50, 0x280000
    s_mov_b32 s51, 0x20000
    s_mov_b32 s52, s38
    s_mov_b32 s53, s39
    s_mov_b32 s54, 0x280000
    s_mov_b32 s55, 0x20000
    s_mov_b32 s66, s64
    s_mov_b32 s67, 1
    s_mov_b32 s77, 0
    s_mov_b32 s78, 0
    s_cmp_lt_u32 s66, s77
    s_cbranch_scc1 L_qr_5_out
    s_mov_b32 s12, 0
L_qr_5:
    v_mov_b32 v44, 0
    buffer_load_dwordx4 v[44:47], v44, s[44:47], s76 offen sc1
    s_waitcnt vmcnt(0)
    v_min3_u32 v44, v44, v45, v46
    s_nop 0
    v_readfirstlane_b32 s77, v44
    s_add_u32 s12, s12, 1
    s_cmp_lt_u32 s66, s77
    s_cbranch_scc1 L_qr_5_out
    s_sleep 4
    s_cmp_lt_u32 s12, 100000
    s_cbranch_scc1 L_qr_5
L_qr_5_out:
    s_lshl_b32 s72, s66, 18
    s_lshl_b32 s73, s65, 13
    s_add_u32 s72, s72, s73
    s_lshl_b32 s73, s3, 11
    s_add_u32 s72, s72, s73
    s_add_u32 s73, s73, s78
    s_add_u32 s74, s72, 0x1000000
    s_add_u32 s6, s73, 0
    s_mov_b32 m0, s6
    s_nop 0
    buffer_load_dwordx4 v0, s[44:47], s74 offen offset:0 sc1 lds
    s_add_u32 s74, s74, 1024
    s_add_u32 s6, s73, 1024
    s_mov_b32 m0, s6
    s_nop 0
    buffer_load_dwordx4 v0, s[44:47], s74 offen offset:0 sc1 lds
    s_add_u32 s74, s72, 0x2000000
    s_add_u32 s6, s73, 8192
    s_mov_b32 m0, s6
    s_nop 0
    buffer_load_dwordx4 v0, s[44:47], s74 offen offset:0 sc1 lds
    s_add_u32 s74, s74, 1024
    s_add_u32 s6, s73, 9216
    s_mov_b32 m0, s6
    s_nop 0
    buffer_load_dwordx4 v0, s[44:47], s74 offen offset:0 sc1 lds
    s_add_u32 s74, s72, 0x3000000
    s_add_u32 s6, s73, 16384
    s_mov_b32 m0, s6
    s_nop 0
    buffer_load_dwordx4 v0, s[44:47], s74 offen offset:0 sc1 lds
    s_add_u32 s74, s74, 1024
    s_add_u32 s6, s73, 17408
    s_mov_b32 m0, s6
    s_nop 0
    buffer_load_dwordx4 v0, s[44:47], s74 offen offset:0 sc1 lds
    s_cmp_lg_u32 s11, 0
    s_cbranch_scc1 L_mode1_17
L_po_loop:
    s_and_b32 s61, s67, 1
    s_lshl_b32 s72, s66, 17
    s_lshl_b32 s73, s65, 12
    s_add_u32 s72, s72, s73
    s_add_u32 s72, s72, 0x600000
    s_mov_b32 s12, 0
L_po_km:
    buffer_load_dwordx4 v[44:47], v38, s[44:47], s72 offen sc1
    s_waitcnt vmcnt(0)
    v_max_u32 v48, v45, v47
    v_cmp_eq_u32 vcc, -1, v48
    s_add_u32 s12, s12, 1
    s_cmp_gt_u32 s12, 100000
    s_cbranch_scc1 L_po_km_out
    s_cbranch_vccz L_po_km_out
    s_sleep 2
    s_branch L_po_km
L_po_km_out:
    v_add_u32 v48, 49152, v38
    ds_write_b128 v48, v[44:47]
    s_mul_i32 s72, s66, 40960
    buffer_load_dwordx2 v[100:101], v8, s[48:51], s72 offen
    buffer_load_dwordx2 v[102:103], v9, s[48:51], s72 offen
    s_waitcnt lgkmcnt(0)
    s_barrier
    v_add_u32 v108, s78, v0
    s_lshl_b32 s72, s70, 10
    v_add_u32 v109, s72, v108
    ds_read_b128 v[44:47], v109 offset:0
    ds_read_b128 v[52:55], v108 offset:8192
    ds_read_b128 v[56:59], v108 offset:9216
    ds_read_b64_tr_b16 v[48:49], v1 offset:0
    ds_read_b64_tr_b16 v[50:51], v1 offset:128
    ds_read_b128 v[60:63], v109 offset:2048
    ds_read_b128 v[68:71], v108 offset:10240
    ds_read_b128 v[72:75], v108 offset:11264
    ds_read_b64_tr_b16 v[64:65], v1 offset:512
    ds_read_b64_tr_b16 v[66:67], v1 offset:640
    s_waitcnt lgkmcnt(5)
    v_mfma_f32_16x16x32_bf16 v[76:79], v[52:55], v[44:47], 0
    v_mfma_f32_16x16x32_bf16 v[80:83], v[56:59], v[44:47], 0
    v_mfma_f32_16x16x32_bf16 v[84:87], v[48:51], v[44:47], 0
    ds_read_b128 v[44:47], v109 offset:4096
    ds_read_b128 v[52:55], v108 offset:12288
    ds_read_b128 v[56:59], v108 offset:13312
    ds_read_b64_tr_b16 v[48:49], v1 offset:1024
    ds_read_b64_tr_b16 v[50:51], v1 offset:1152
    s_waitcnt lgkmcnt(5)
    v_mfma_f32_16x16x32_bf16 v[76:79], v[68:71], v[60:63], v[76:79]
    v_mfma_f32_16x16x32_bf16 v[80:83], v[72:75], v[60:63], v[80:83]
    v_mfma_f32_16x16x32_bf16 v[84:87], v[64:67], v[60:63], v[84:87]
    ds_read_b128 v[60:63], v109 offset:6144
    ds_read_b128 v[68:71], v108 offset:14336
    ds_read_b128 v[72:75], v108 offset:15360
    ds_read_b64_tr_b16 v[64:65], v1 offset:1536
    ds_read_b64_tr_b16 v[66:67], v1 offset:1664
    s_waitcnt lgkmcnt(5)
    v_mfma_f32_16x16x32_bf16 v[76:79], v[52:55], v[44:47], v[76:79]
    v_mfma_f32_16x16x32_bf16 v[80:83], v[56:59], v[44:47], v[80:83]
    v_mfma_f32_16x16x32_bf16 v[84:87], v[48:51], v[44:47], v[84:87]
    s_waitcnt lgkmcnt(0)
    v_mfma_f32_16x16x32_bf16 v[76:79], v[68:71], v[60:63], v[76:79]
    v_mfma_f32_16x16x32_bf16 v[80:83], v[72:75], v[60:63], v[80:83]
    v_mfma_f32_16x16x32_bf16 v[84:87], v[64:67], v[60:63], v[84:87]
    s_lshl_b32 s72, s71, 12
    v_add_u32 v109, s72, v108
    ds_read_b128 v[44:47], v109 offset:16384
    ds_read_b64 v[60:61], v2 offset:0
    ds_read_b128 v[48:51], v109 offset:17408
    ds_read_b64 v[62:63], v2 offset:256
    ds_read_b128 v[52:55], v109 offset:18432
    ds_read_b64 v[64:65], v2 offset:512
    ds_read_b128 v[56:59], v109 offset:19456
    ds_read_b64 v[66:67], v2 offset:768
    s_nop 3
    v_mov_b32 v88, s13
    v_cndmask_b32 v76, v88, v76, s[80:81]
    v_cndmask_b32 v80, v88, v80, s[88:89]
    v_cndmask_b32 v77, v88, v77, s[82:83]
    v_cndmask_b32 v81, v88, v81, s[90:91]
    v_cndmask_b32 v78, v88, v78, s[84:85]
    v_cndmask_b32 v82, v88, v82, s[92:93]
    v_cndmask_b32 v79, v88, v79, s[86:87]
    v_cndmask_b32 v83, v88, v83, s[94:95]
    v_max3_f32 v88, v76, v77, v78
    v_max3_f32 v89, v79, v80, v81
    v_max3_f32 v90, v82, v83, v84
    v_max3_f32 v91, v85, v86, v87
    v_max3_f32 v88, v88, v89, v90
    v_max_f32 v88, v88, v91
    v_mov_b32 v89, v88
    s_nop 1
    v_permlane16_swap_b32 v88, v89
    v_max_f32 v88, v88, v89
    v_mov_b32 v89, v88
    s_nop 1
    v_permlane32_swap_b32 v88, v89
    v_max_f32 v88, v88, v89
    v_mul_f32 v89, s75, v88
    v_fma_f32 v76, v76, s75, -v89
    v_fma_f32 v77, v77, s75, -v89
    v_fma_f32 v78, v78, s75, -v89
    v_fma_f32 v79, v79, s75, -v89
    v_fma_f32 v80, v80, s75, -v89
    v_fma_f32 v81, v81, s75, -v89
    v_fma_f32 v82, v82, s75, -v89
    v_fma_f32 v83, v83, s75, -v89
    v_fma_f32 v84, v84, s75, -v89
    v_fma_f32 v85, v85, s75, -v89
    v_fma_f32 v86, v86, s75, -v89
    v_fma_f32 v87, v87, s75, -v89
    v_exp_f32 v76, v76
    v_exp_f32 v77, v77
    v_exp_f32 v78, v78
    v_exp_f32 v79, v79
    v_exp_f32 v80, v80
    v_exp_f32 v81, v81
    v_exp_f32 v82, v82
    v_exp_f32 v83, v83
    v_exp_f32 v84, v84
    v_exp_f32 v85, v85
    v_exp_f32 v86, v86
    v_exp_f32 v87, v87
    s_nop 0
    v_cvt_pk_bf16_f32 v68, v76, v77
    v_cvt_pk_bf16_f32 v69, v78, v79
    v_cvt_pk_bf16_f32 v70, v80, v81
    v_cvt_pk_bf16_f32 v71, v82, v83
    v_cvt_pk_bf16_f32 v72, v84, v85
    v_cvt_pk_bf16_f32 v73, v86, v87
    v_cndmask_b32 v72, 0, v72, s[96:97]
    v_cndmask_b32 v73, 0, v73, s[96:97]
    v_mov_b32 v92, 0x3f803f80
    v_mov_b32 v93, 0x3f803f80
    v_mov_b32 v94, 0x3f803f80
    v_mov_b32 v95, 0x3f803f80
    s_waitcnt lgkmcnt(0)
    s_nop 0
    v_mfma_f32_16x16x32_bf16 v[96:99], v[92:95], v[68:71], 0
    v_mfma_f32_16x16x32_bf16 v[76:79], v[44:47], v[68:71], 0
    v_mfma_f32_16x16x32_bf16 v[80:83], v[48:51], v[68:71], 0
    v_mfma_f32_16x16x32_bf16 v[84:87], v[52:55], v[68:71], 0
    v_mfma_f32_16x16x32_bf16 v[88:91], v[56:59], v[68:71], 0
    v_mfma_f32_16x16x16_bf16 v[96:99], v[92:93], v[72:73], v[96:99]
    v_mfma_f32_16x16x16_bf16 v[76:79], v[60:61], v[72:73], v[76:79]
    v_mfma_f32_16x16x16_bf16 v[80:83], v[62:63], v[72:73], v[80:83]
    v_mfma_f32_16x16x16_bf16 v[84:87], v[64:65], v[72:73], v[84:87]
    v_mfma_f32_16x16x16_bf16 v[88:91], v[66:67], v[72:73], v[88:91]
    s_nop 3
    v_rcp_f32 v96, v96
    s_nop 3
    v_mul_f32 v76, v76, v96
    v_mul_f32 v77, v77, v96
    v_mul_f32 v78, v78, v96
    v_mul_f32 v79, v79, v96
    v_mul_f32 v80, v80, v96
    v_mul_f32 v81, v81, v96
    v_mul_f32 v82, v82, v96
    v_mul_f32 v83, v83, v96
    v_mul_f32 v84, v84, v96
    v_mul_f32 v85, v85, v96
    v_mul_f32 v86, v86, v96
    v_mul_f32 v87, v87, v96
    v_mul_f32 v88, v88, v96
    v_mul_f32 v89, v89, v96
    v_mul_f32 v90, v90, v96
    v_mul_f32 v91, v91, v96
    v_cvt_pk_bf16_f32 v44, v76, v77
    v_cvt_pk_bf16_f32 v45, v78, v79
    v_cvt_pk_bf16_f32 v46, v80, v81
    v_cvt_pk_bf16_f32 v47, v82, v83
    v_cvt_pk_bf16_f32 v48, v84, v85
    v_cvt_pk_bf16_f32 v49, v86, v87
    v_cvt_pk_bf16_f32 v50, v88, v89
    v_cvt_pk_bf16_f32 v51, v90, v91
    ds_write_b128 v3, v[44:47]
    ds_write_b128 v3, v[48:51] offset:2048
    s_waitcnt lgkmcnt(0)
    s_barrier
    s_add_u32 s14, s66, 4
    s_min_u32 s14, s14, 63
    s_xor_b32 s15, s78, 24576
    s_cmp_lt_u32 s14, s77
    s_cbranch_scc1 L_qr_6_out
    s_mov_b32 s12, 0
L_qr_6:
    v_mov_b32 v44, 0
    buffer_load_dwordx4 v[44:47], v44, s[44:47], s76 offen sc1
    s_waitcnt vmcnt(0)
    v_min3_u32 v44, v44, v45, v46
    s_nop 0
    v_readfirstlane_b32 s77, v44
    s_add_u32 s12, s12, 1
    s_cmp_lt_u32 s14, s77
    s_cbranch_scc1 L_qr_6_out
    s_sleep 4
    s_cmp_lt_u32 s12, 100000
    s_cbranch_scc1 L_qr_6
L_qr_6_out:
    s_lshl_b32 s72, s14, 18
    s_lshl_b32 s73, s65, 13
    s_add_u32 s72, s72, s73
    s_lshl_b32 s73, s3, 11
    s_add_u32 s72, s72, s73
    s_add_u32 s73, s73, s15
    s_add_u32 s74, s72, 0x1000000
    s_add_u32 s6, s73, 0
    s_mov_b32 m0, s6
    s_nop 0
    buffer_load_dwordx4 v0, s[44:47], s74 offen offset:0 sc1 lds
    s_add_u32 s74, s74, 1024
    s_add_u32 s6, s73, 1024
    s_mov_b32 m0, s6
    s_nop 0
    buffer_load_dwordx4 v0, s[44:47], s74 offen offset:0 sc1 lds
    s_add_u32 s74, s72, 0x2000000
    s_add_u32 s6, s73, 8192
    s_mov_b32 m0, s6
    s_nop 0
    buffer_load_dwordx4 v0, s[44:47], s74 offen offset:0 sc1 lds
    s_add_u32 s74, s74, 1024
    s_add_u32 s6, s73, 9216
    s_mov_b32 m0, s6
    s_nop 0
    buffer_load_dwordx4 v0, s[44:47], s74 offen offset:0 sc1 lds
    s_add_u32 s74, s72, 0x3000000
    s_add_u32 s6, s73, 16384
    s_mov_b32 m0, s6
    s_nop 0
    buffer_load_dwordx4 v0, s[44:47], s74 offen offset:0 sc1 lds
    s_add_u32 s74, s74, 1024
    s_add_u32 s6, s73, 17408
    s_mov_b32 m0, s6
    s_nop 0
    buffer_load_dwordx4 v0, s[44:47], s74 offen offset:0 sc1 lds
    ds_read_b128 v[44:47], v0 offset:53248
    ds_read_b128 v[48:51], v0 offset:54272
    ds_read_b128 v[52:55], v0 offset:55296
    ds_read_b128 v[56:59], v0 offset:56320
    s_waitcnt lgkmcnt(3)
    v_mfma_f32_32x32x16_bf16 v[76:91], v[112:115], v[44:47], 0
    ds_read_b128 v[44:47], v0 offset:57344
    s_waitcnt lgkmcnt(3)
    v_mfma_f32_32x32x16_bf16 v[76:91], v[116:119], v[48:51], v[76:91]
    ds_read_b128 v[48:51], v0 offset:58368
    s_waitcnt lgkmcnt(3)
    v_mfma_f32_32x32x16_bf16 v[76:91], v[120:123], v[52:55], v[76:91]
    ds_read_b128 v[52:55], v0 offset:59392
    s_waitcnt lgkmcnt(3)
    v_mfma_f32_32x32x16_bf16 v[76:91], v[124:127], v[56:59], v[76:91]
    ds_read_b128 v[56:59], v0 offset:60416
    s_waitcnt lgkmcnt(3)
    v_mfma_f32_32x32x16_bf16 v[76:91], v[128:131], v[44:47], v[76:91]
    ds_read_b128 v[44:47], v0 offset:53248
    s_waitcnt lgkmcnt(3)
    v_mfma_f32_32x32x16_bf16 v[76:91], v[132:135], v[48:51], v[76:91]
    ds_read_b128 v[48:51], v0 offset:54272
    s_waitcnt lgkmcnt(3)
    v_mfma_f32_32x32x16_bf16 v[76:91], v[136:139], v[52:55], v[76:91]
    ds_read_b128 v[52:55], v0 offset:55296
    s_waitcnt lgkmcnt(3)
    v_mfma_f32_32x32x16_bf16 v[76:91], v[140:143], v[56:59], v[76:91]
    ds_read_b128 v[56:59], v0 offset:56320
    s_waitcnt lgkmcnt(3)
    v_mfma_f32_32x32x16_bf16 v[60:75], v[144:147], v[44:47], 0
    ds_read_b128 v[44:47], v0 offset:57344
    s_waitcnt lgkmcnt(3)
    v_mfma_f32_32x32x16_bf16 v[60:75], v[148:151], v[48:51], v[60:75]
    ds_read_b128 v[48:51], v0 offset:58368
    s_waitcnt lgkmcnt(3)
    v_mfma_f32_32x32x16_bf16 v[60:75], v[152:155], v[52:55], v[60:75]
    ds_read_b128 v[52:55], v0 offset:59392
    s_waitcnt lgkmcnt(3)
    v_mfma_f32_32x32x16_bf16 v[60:75], v[156:159], v[56:59], v[60:75]
    v_cvt_pk_bf16_f32 v92, v76, v77
    v_cvt_pk_bf16_f32 v93, v78, v79
    ds_read_b128 v[56:59], v0 offset:60416
    s_waitcnt lgkmcnt(3)
    v_mfma_f32_32x32x16_bf16 v[60:75], v[160:163], v[44:47], v[60:75]
    v_cvt_pk_bf16_f32 v94, v80, v81
    v_cvt_pk_bf16_f32 v95, v82, v83
    s_add_u32 s72, s68, 0
    buffer_store_dwordx4 v[92:95], v4, s[44:47], s72 offen
    ds_read_b128 v[44:47], v0 offset:53248
    s_waitcnt lgkmcnt(3)
    v_mfma_f32_32x32x16_bf16 v[60:75], v[164:167], v[48:51], v[60:75]
    v_cvt_pk_bf16_f32 v96, v84, v85
    v_cvt_pk_bf16_f32 v97, v86, v87
    ds_read_b128 v[48:51], v0 offset:54272
    s_waitcnt lgkmcnt(3)
    v_mfma_f32_32x32x16_bf16 v[60:75], v[168:171], v[52:55], v[60:75]
    v_cvt_pk_bf16_f32 v98, v88, v89
    v_cvt_pk_bf16_f32 v99, v90, v91
    s_add_u32 s73, s68, 32768
    buffer_store_dwordx4 v[96:99], v4, s[44:47], s73 offen
    ds_read_b128 v[52:55], v0 offset:55296
    s_waitcnt lgkmcnt(3)
    v_mfma_f32_32x32x16_bf16 v[60:75], v[172:175], v[56:59], v[60:75]
    ds_read_b128 v[56:59], v0 offset:56320
    s_waitcnt lgkmcnt(3)
    v_mfma_f32_32x32x16_bf16 v[76:91], v[176:179], v[44:47], 0
    ds_read_b128 v[44:47], v0 offset:57344
    s_waitcnt lgkmcnt(3)
    v_mfma_f32_32x32x16_bf16 v[76:91], v[180:183], v[48:51], v[76:91]
    ds_read_b128 v[48:51], v0 offset:58368
    s_waitcnt lgkmcnt(3)
    v_mfma_f32_32x32x16_bf16 v[76:91], v[184:187], v[52:55], v[76:91]
    ds_read_b128 v[52:55], v0 offset:59392
    s_waitcnt lgkmcnt(3)
    v_mfma_f32_32x32x16_bf16 v[76:91], v[188:191], v[56:59], v[76:91]
    v_cvt_pk_bf16_f32 v92, v60, v61
    v_cvt_pk_bf16_f32 v93, v62, v63
    ds_read_b128 v[56:59], v0 offset:60416
    s_waitcnt lgkmcnt(3)
    v_mfma_f32_32x32x16_bf16 v[76:91], v[192:195], v[44:47], v[76:91]
    v_cvt_pk_bf16_f32 v94, v64, v65
    v_cvt_pk_bf16_f32 v95, v66, v67
    s_add_u32 s72, s68, 65536
    buffer_store_dwordx4 v[92:95], v4, s[44:47], s72 offen
    ds_read_b128 v[44:47], v0 offset:53248
    s_waitcnt lgkmcnt(3)
    v_mfma_f32_32x32x16_bf16 v[76:91], v[196:199], v[48:51], v[76:91]
    v_cvt_pk_bf16_f32 v96, v68, v69
    v_cvt_pk_bf16_f32 v97, v70, v71
    ds_read_b128 v[48:51], v0 offset:54272
    s_waitcnt lgkmcnt(3)
    v_mfma_f32_32x32x16_bf16 v[76:91], v[200:203], v[52:55], v[76:91]
    v_cvt_pk_bf16_f32 v98, v72, v73
    v_cvt_pk_bf16_f32 v99, v74, v75
    s_add_u32 s73, s68, 98304
    buffer_store_dwordx4 v[96:99], v4, s[44:47], s73 offen
    ds_read_b128 v[52:55], v0 offset:55296
    s_waitcnt lgkmcnt(3)
    v_mfma_f32_32x32x16_bf16 v[76:91], v[204:207], v[56:59], v[76:91]
    ds_read_b128 v[56:59], v0 offset:56320
    s_waitcnt lgkmcnt(3)
    v_mfma_f32_32x32x16_bf16 v[60:75], v[208:211], v[44:47], 0
    ds_read_b128 v[44:47], v0 offset:57344
    s_waitcnt lgkmcnt(3)
    v_mfma_f32_32x32x16_bf16 v[60:75], v[212:215], v[48:51], v[60:75]
    ds_read_b128 v[48:51], v0 offset:58368
    s_waitcnt lgkmcnt(3)
    v_mfma_f32_32x32x16_bf16 v[60:75], v[216:219], v[52:55], v[60:75]
    ds_read_b128 v[52:55], v0 offset:59392
    s_waitcnt lgkmcnt(3)
    v_mfma_f32_32x32x16_bf16 v[60:75], v[220:223], v[56:59], v[60:75]
    v_cvt_pk_bf16_f32 v92, v76, v77
    v_cvt_pk_bf16_f32 v93, v78, v79
    ds_read_b128 v[56:59], v0 offset:60416
    s_waitcnt lgkmcnt(3)
    v_mfma_f32_32x32x16_bf16 v[60:75], v[224:227], v[44:47], v[60:75]
    v_cvt_pk_bf16_f32 v94, v80, v81
    v_cvt_pk_bf16_f32 v95, v82, v83
    s_add_u32 s72, s68, 131072
    buffer_store_dwordx4 v[92:95], v4, s[44:47], s72 offen
    ds_read_b128 v[44:47], v0 offset:53248
    s_waitcnt lgkmcnt(3)
    v_mfma_f32_32x32x16_bf16 v[60:75], v[228:231], v[48:51], v[60:75]
    v_cvt_pk_bf16_f32 v96, v84, v85
    v_cvt_pk_bf16_f32 v97, v86, v87
    ds_read_b128 v[48:51], v0 offset:54272
    s_waitcnt lgkmcnt(3)
    v_mfma_f32_32x32x16_bf16 v[60:75], v[232:235], v[52:55], v[60:75]
    v_cvt_pk_bf16_f32 v98, v88, v89
    v_cvt_pk_bf16_f32 v99, v90, v91
    s_add_u32 s73, s68, 163840
    buffer_store_dwordx4 v[96:99], v4, s[44:47], s73 offen
    ds_read_b128 v[52:55], v0 offset:55296
    s_waitcnt lgkmcnt(3)
    v_mfma_f32_32x32x16_bf16 v[60:75], v[236:239], v[56:59], v[60:75]
    ds_read_b128 v[56:59], v0 offset:56320
    s_waitcnt lgkmcnt(3)
    v_mfma_f32_32x32x16_bf16 v[76:91], v[240:243], v[44:47], 0
    ds_read_b128 v[44:47], v0 offset:57344
    s_waitcnt lgkmcnt(3)
    v_mfma_f32_32x32x16_bf16 v[76:91], v[244:247], v[48:51], v[76:91]
    ds_read_b128 v[48:51], v0 offset:58368
    s_waitcnt lgkmcnt(3)
    v_mfma_f32_32x32x16_bf16 v[76:91], v[248:251], v[52:55], v[76:91]
    ds_read_b128 v[52:55], v0 offset:59392
    s_waitcnt lgkmcnt(3)
    v_mfma_f32_32x32x16_bf16 v[76:91], v[252:255], v[56:59], v[76:91]
    v_cvt_pk_bf16_f32 v92, v60, v61
    v_cvt_pk_bf16_f32 v93, v62, v63
    ds_read_b128 v[56:59], v0 offset:60416
    s_waitcnt lgkmcnt(3)
    v_mfma_f32_32x32x16_bf16 v[76:91], a[0:3], v[44:47], v[76:91]
    v_cvt_pk_bf16_f32 v94, v64, v65
    v_cvt_pk_bf16_f32 v95, v66, v67
    s_add_u32 s72, s68, 196608
    buffer_store_dwordx4 v[92:95], v4, s[44:47], s72 offen
    s_waitcnt lgkmcnt(2)
    v_mfma_f32_32x32x16_bf16 v[76:91], a[4:7], v[48:51], v[76:91]
    v_cvt_pk_bf16_f32 v96, v68, v69
    v_cvt_pk_bf16_f32 v97, v70, v71
    s_waitcnt lgkmcnt(1)
    v_mfma_f32_32x32x16_bf16 v[76:91], a[8:11], v[52:55], v[76:91]
    v_cvt_pk_bf16_f32 v98, v72, v73
    v_cvt_pk_bf16_f32 v99, v74, v75
    s_add_u32 s73, s68, 229376
    buffer_store_dwordx4 v[96:99], v4, s[44:47], s73 offen
    s_waitcnt lgkmcnt(0)
    v_mfma_f32_32x32x16_bf16 v[76:91], a[12:15], v[56:59], v[76:91]
    s_nop 11
    v_cvt_pk_bf16_f32 v92, v76, v77
    v_cvt_pk_bf16_f32 v93, v78, v79
    v_cvt_pk_bf16_f32 v94, v80, v81
    v_cvt_pk_bf16_f32 v95, v82, v83
    s_add_u32 s72, s68, 262144
    buffer_store_dwordx4 v[92:95], v4, s[44:47], s72 offen
    v_cvt_pk_bf16_f32 v96, v84, v85
    v_cvt_pk_bf16_f32 v97, v86, v87
    v_cvt_pk_bf16_f32 v98, v88, v89
    v_cvt_pk_bf16_f32 v99, v90, v91
    s_add_u32 s73, s68, 294912
    buffer_store_dwordx4 v[96:99], v4, s[44:47], s73 offen
    s_waitcnt vmcnt(0)
    s_barrier
    s_cmp_lg_u32 s3, 0
    s_cbranch_scc1 L_fs_7
    s_lshl_b32 s72, s65, 2
    s_add_u32 s72, s72, s69
    s_add_u32 s72, s72, 0
    v_mov_b32 v40, s67
    v_mov_b32 v41, 0
    s_mov_b64 exec, 1
    buffer_store_dword v40, v41, s[44:47], s72 offen
    s_mov_b64 exec, -1
L_fs_7:
    v_lshrrev_b32 v41, 2, v0
    v_mov_b32 v42, 0x7fffff00
    v_cmp_gt_u32 vcc, 128, v41
    s_add_u32 s72, s69, 0
    s_nop 0
    v_cndmask_b32 v41, v42, v41, vcc
    s_mov_b64 s[6:7], vcc
    s_mov_b32 s12, 0
L_fw_8:
    buffer_load_dword v42, v41, s[44:47], s72 offen sc1
    s_waitcnt vmcnt(0)
    v_cmp_gt_u32 vcc, s67, v42
    s_add_u32 s12, s12, 1
    s_and_b64 vcc, vcc, s[6:7]
    s_cmp_gt_u32 s12, 100000
    s_cbranch_scc1 L_fw_8_out
    s_cbranch_vccnz L_fw_8
L_fw_8_out:
    s_add_u32 s72, s68, 0
    s_add_u32 s73, s72, 4096
    buffer_load_dwordx4 v[44:47], v5, s[44:47], s72 offen offset:0 sc1
    buffer_load_dwordx4 v[48:51], v5, s[44:47], s72 offen offset:1024 sc1
    buffer_load_dwordx4 v[52:55], v5, s[44:47], s72 offen offset:2048 sc1
    buffer_load_dwordx4 v[56:59], v5, s[44:47], s72 offen offset:3072 sc1
    buffer_load_dwordx4 v[60:63], v5, s[44:47], s73 offen offset:0 sc1
    buffer_load_dwordx4 v[64:67], v5, s[44:47], s73 offen offset:1024 sc1
    buffer_load_dwordx4 v[68:71], v5, s[44:47], s73 offen offset:2048 sc1
    buffer_load_dwordx4 v[72:75], v5, s[44:47], s73 offen offset:3072 sc1
    s_waitcnt vmcnt(7)
    v_mfma_f32_16x16x32_bf16 v[104:107], v[10:13], v[44:47], 0
    s_waitcnt vmcnt(6)
    v_mfma_f32_16x16x32_bf16 v[104:107], v[10:13], v[48:51], v[104:107]
    s_waitcnt vmcnt(5)
    v_mfma_f32_16x16x32_bf16 v[104:107], v[10:13], v[52:55], v[104:107]
    s_waitcnt vmcnt(4)
    v_mfma_f32_16x16x32_bf16 v[104:107], v[10:13], v[56:59], v[104:107]
    s_waitcnt vmcnt(3)
    v_mfma_f32_16x16x32_bf16 v[104:107], v[10:13], v[60:63], v[104:107]
    s_waitcnt vmcnt(2)
    v_mfma_f32_16x16x32_bf16 v[104:107], v[10:13], v[64:67], v[104:107]
    s_waitcnt vmcnt(1)
    v_mfma_f32_16x16x32_bf16 v[104:107], v[10:13], v[68:71], v[104:107]
    s_waitcnt vmcnt(0)
    v_mfma_f32_16x16x32_bf16 v[104:107], v[10:13], v[72:75], v[104:107]
    s_nop 7
    v_lshlrev_b32 v76, 16, v100
    v_and_b32 v77, 0xffff0000, v100
    v_lshlrev_b32 v78, 16, v101
    v_and_b32 v79, 0xffff0000, v101
    v_add_f32 v76, v76, v104
    v_add_f32 v77, v77, v105
    v_add_f32 v78, v78, v106
    v_add_f32 v79, v79, v107
    v_cvt_pk_bf16_f32 v80, v76, v77
    v_cvt_pk_bf16_f32 v81, v78, v79
    v_lshlrev_b32 v30, 16, v80
    v_and_b32 v31, 0xffff0000, v80
    v_lshlrev_b32 v32, 16, v81
    v_and_b32 v33, 0xffff0000, v81
    s_add_u32 s72, s68, 2621440
    buffer_store_dwordx2 v[80:81], v6, s[44:47], s72 offen
    s_cmp_lg_u32 s3, 0
    s_cbranch_scc1 L_po_r1done
    s_add_u32 s72, s68, 32768
    s_add_u32 s73, s72, 4096
    buffer_load_dwordx4 v[44:47], v5, s[44:47], s72 offen offset:0 sc1
    buffer_load_dwordx4 v[48:51], v5, s[44:47], s72 offen offset:1024 sc1
    buffer_load_dwordx4 v[52:55], v5, s[44:47], s72 offen offset:2048 sc1
    buffer_load_dwordx4 v[56:59], v5, s[44:47], s72 offen offset:3072 sc1
    buffer_load_dwordx4 v[60:63], v5, s[44:47], s73 offen offset:0 sc1
    buffer_load_dwordx4 v[64:67], v5, s[44:47], s73 offen offset:1024 sc1
    buffer_load_dwordx4 v[68:71], v5, s[44:47], s73 offen offset:2048 sc1
    buffer_load_dwordx4 v[72:75], v5, s[44:47], s73 offen offset:3072 sc1
    s_waitcnt vmcnt(7)
    v_mfma_f32_16x16x32_bf16 v[104:107], v[10:13], v[44:47], 0
    s_waitcnt vmcnt(6)
    v_mfma_f32_16x16x32_bf16 v[104:107], v[10:13], v[48:51], v[104:107]
    s_waitcnt vmcnt(5)
    v_mfma_f32_16x16x32_bf16 v[104:107], v[10:13], v[52:55], v[104:107]
    s_waitcnt vmcnt(4)
    v_mfma_f32_16x16x32_bf16 v[104:107], v[10:13], v[56:59], v[104:107]
    s_waitcnt vmcnt(3)
    v_mfma_f32_16x16x32_bf16 v[104:107], v[10:13], v[60:63], v[104:107]
    s_waitcnt vmcnt(2)
    v_mfma_f32_16x16x32_bf16 v[104:107], v[10:13], v[64:67], v[104:107]
    s_waitcnt vmcnt(1)
    v_mfma_f32_16x16x32_bf16 v[104:107], v[10:13], v[68:71], v[104:107]
    s_waitcnt vmcnt(0)
    v_mfma_f32_16x16x32_bf16 v[104:107], v[10:13], v[72:75], v[104:107]
    s_nop 7
    v_lshlrev_b32 v76, 16, v102
    v_and_b32 v77, 0xffff0000, v102
    v_lshlrev_b32 v78, 16, v103
    v_and_b32 v79, 0xffff0000, v103
    v_add_f32 v76, v76, v104
    v_add_f32 v77, v77, v105
    v_add_f32 v78, v78, v106
    v_add_f32 v79, v79, v107
    v_cvt_pk_bf16_f32 v80, v76, v77
    v_cvt_pk_bf16_f32 v81, v78, v79
    v_lshlrev_b32 v34, 16, v80
    v_and_b32 v35, 0xffff0000, v80
    v_lshlrev_b32 v36, 16, v81
    v_and_b32 v37, 0xffff0000, v81
    s_add_u32 s72, s68, 2621440
    buffer_store_dwordx2 v[80:81], v7, s[44:47], s72 offen
L_po_r1done:
    s_waitcnt vmcnt(0)
    s_barrier
    s_cmp_lg_u32 s3, 0
    s_cbranch_scc1 L_fs_11
    s_lshl_b32 s72, s65, 2
    s_add_u32 s72, s72, s69
    s_add_u32 s72, s72, 128
    v_mov_b32 v40, s67
    v_mov_b32 v41, 0
    s_mov_b64 exec, 1
    buffer_store_dword v40, v41, s[44:47], s72 offen
    s_mov_b64 exec, -1
L_fs_11:
    v_lshrrev_b32 v41, 2, v0
    v_mov_b32 v42, 0x7fffff00
    v_cmp_gt_u32 vcc, 128, v41
    s_add_u32 s72, s69, 128
    s_nop 0
    v_cndmask_b32 v41, v42, v41, vcc
    s_mov_b64 s[6:7], vcc
    s_mov_b32 s12, 0
L_fw_12:
    buffer_load_dword v42, v41, s[44:47], s72 offen sc1
    s_waitcnt vmcnt(0)
    v_cmp_gt_u32 vcc, s67, v42
    s_add_u32 s12, s12, 1
    s_and_b64 vcc, vcc, s[6:7]
    s_cmp_gt_u32 s12, 100000
    s_cbranch_scc1 L_fw_12_out
    s_cbranch_vccnz L_fw_12
L_fw_12_out:
    s_mul_i32 s73, s3, 10240
    s_add_u32 s72, s68, s73
    s_add_u32 s72, s72, 2621440
    s_add_u32 s73, s73, 62464
    s_mov_b32 m0, s73
    s_add_u32 s73, s73, 1024
    buffer_load_dwordx4 v0, s[44:47], s72 offen sc1 lds
    s_add_u32 s72, s72, 1024
    s_mov_b32 m0, s73
    s_add_u32 s73, s73, 1024
    buffer_load_dwordx4 v0, s[44:47], s72 offen sc1 lds
    s_add_u32 s72, s72, 1024
    s_mov_b32 m0, s73
    s_add_u32 s73, s73, 1024
    buffer_load_dwordx4 v0, s[44:47], s72 offen sc1 lds
    s_add_u32 s72, s72, 1024
    s_mov_b32 m0, s73
    s_add_u32 s73, s73, 1024
    buffer_load_dwordx4 v0, s[44:47], s72 offen sc1 lds
    s_add_u32 s72, s72, 1024
    s_mov_b32 m0, s73
    s_add_u32 s73, s73, 1024
    buffer_load_dwordx4 v0, s[44:47], s72 offen sc1 lds
    s_add_u32 s72, s72, 1024
    s_mov_b32 m0, s73
    s_add_u32 s73, s73, 1024
    buffer_load_dwordx4 v0, s[44:47], s72 offen sc1 lds
    s_add_u32 s72, s72, 1024
    s_mov_b32 m0, s73
    s_add_u32 s73, s73, 1024
    buffer_load_dwordx4 v0, s[44:47], s72 offen sc1 lds
    s_add_u32 s72, s72, 1024
    s_mov_b32 m0, s73
    s_add_u32 s73, s73, 1024
    buffer_load_dwordx4 v0, s[44:47], s72 offen sc1 lds
    s_add_u32 s72, s72, 1024
    s_mov_b32 m0, s73
    s_add_u32 s73, s73, 1024
    buffer_load_dwordx4 v0, s[44:47], s72 offen sc1 lds
    s_add_u32 s72, s72, 1024
    s_mov_b32 m0, s73
    s_add_u32 s73, s73, 1024
    buffer_load_dwordx4 v0, s[44:47], s72 offen sc1 lds
    s_add_u32 s72, s72, 1024
    s_waitcnt vmcnt(0)
    s_barrier
    s_cmp_eq_u32 s79, 0
    s_cbranch_scc1 L_po_noffn
    v_add_u32 v108, 62464, v0
    v_mov_b32 v92, 0
    v_mov_b32 v93, 0
    v_mov_b32 v94, 0x3f803f80
    ds_read_b128 v[44:47], v108 offset:0
    ds_read_b128 v[48:51], v108 offset:1024
    ds_read_b128 v[52:55], v108 offset:2048
    ds_read_b128 v[56:59], v108 offset:3072
    ds_read_b128 v[60:63], v108 offset:4096
    s_cmp_lg_u32 s3, 0
    s_cbranch_scc1 L_po_f1_1
    ds_read_b128 v[64:67], v108 offset:5120
    s_waitcnt lgkmcnt(5)
    v_mfma_f32_32x32x16_bf16 v[76:91], a[16:19], v[44:47], 0
    v_dot2_f32_bf16 v92, v44, v94, v92
    v_dot2_f32_bf16 v93, v44, v44, v93
    v_dot2_f32_bf16 v92, v45, v94, v92
    v_dot2_f32_bf16 v93, v45, v45, v93
    v_dot2_f32_bf16 v92, v46, v94, v92
    v_dot2_f32_bf16 v93, v46, v46, v93
    v_dot2_f32_bf16 v92, v47, v94, v92
    v_dot2_f32_bf16 v93, v47, v47, v93
    ds_read_b128 v[44:47], v108 offset:6144
    s_waitcnt lgkmcnt(5)
    v_mfma_f32_32x32x16_bf16 v[76:91], a[20:23], v[48:51], v[76:91]
    ds_read_b128 v[48:51], v108 offset:7168
    s_waitcnt lgkmcnt(5)
    v_mfma_f32_32x32x16_bf16 v[76:91], a[24:27], v[52:55], v[76:91]
    ds_read_b128 v[52:55], v108 offset:8192
    s_waitcnt lgkmcnt(5)
    v_mfma_f32_32x32x16_bf16 v[76:91], a[28:31], v[56:59], v[76:91]
    ds_read_b128 v[56:59], v108 offset:9216
    s_waitcnt lgkmcnt(5)
    v_mfma_f32_32x32x16_bf16 v[76:91], a[32:35], v[60:63], v[76:91]
    v_dot2_f32_bf16 v92, v60, v94, v92
    v_dot2_f32_bf16 v93, v60, v60, v93
    v_dot2_f32_bf16 v92, v61, v94, v92
    v_dot2_f32_bf16 v93, v61, v61, v93
    v_dot2_f32_bf16 v92, v62, v94, v92
    v_dot2_f32_bf16 v93, v62, v62, v93
    v_dot2_f32_bf16 v92, v63, v94, v92
    v_dot2_f32_bf16 v93, v63, v63, v93
    ds_read_b128 v[60:63], v108 offset:10240
    s_waitcnt lgkmcnt(5)
    v_mfma_f32_32x32x16_bf16 v[76:91], a[36:39], v[64:67], v[76:91]
    ds_read_b128 v[64:67], v108 offset:11264
    s_waitcnt lgkmcnt(5)
    v_mfma_f32_32x32x16_bf16 v[76:91], a[40:43], v[44:47], v[76:91]
    ds_read_b128 v[44:47], v108 offset:12288
    s_waitcnt lgkmcnt(5)
    v_mfma_f32_32x32x16_bf16 v[76:91], a[44:47], v[48:51], v[76:91]
    ds_read_b128 v[48:51], v108 offset:13312
    s_waitcnt lgkmcnt(5)
    v_mfma_f32_32x32x16_bf16 v[76:91], a[48:51], v[52:55], v[76:91]
    v_dot2_f32_bf16 v92, v52, v94, v92
    v_dot2_f32_bf16 v93, v52, v52, v93
    v_dot2_f32_bf16 v92, v53, v94, v92
    v_dot2_f32_bf16 v93, v53, v53, v93
    v_dot2_f32_bf16 v92, v54, v94, v92
    v_dot2_f32_bf16 v93, v54, v54, v93
    v_dot2_f32_bf16 v92, v55, v94, v92
    v_dot2_f32_bf16 v93, v55, v55, v93
    ds_read_b128 v[52:55], v108 offset:14336
    s_waitcnt lgkmcnt(5)
    v_mfma_f32_32x32x16_bf16 v[76:91], a[52:55], v[56:59], v[76:91]
    ds_read_b128 v[56:59], v108 offset:15360
    s_waitcnt lgkmcnt(5)
    v_mfma_f32_32x32x16_bf16 v[76:91], a[56:59], v[60:63], v[76:91]
    ds_read_b128 v[60:63], v108 offset:16384
    s_waitcnt lgkmcnt(5)
    v_mfma_f32_32x32x16_bf16 v[76:91], a[60:63], v[64:67], v[76:91]
    ds_read_b128 v[64:67], v108 offset:17408
    s_waitcnt lgkmcnt(5)
    v_mfma_f32_32x32x16_bf16 v[76:91], a[64:67], v[44:47], v[76:91]
    v_dot2_f32_bf16 v92, v44, v94, v92
    v_dot2_f32_bf16 v93, v44, v44, v93
    v_dot2_f32_bf16 v92, v45, v94, v92
    v_dot2_f32_bf16 v93, v45, v45, v93
    v_dot2_f32_bf16 v92, v46, v94, v92
    v_dot2_f32_bf16 v93, v46, v46, v93
    v_dot2_f32_bf16 v92, v47, v94, v92
    v_dot2_f32_bf16 v93, v47, v47, v93
    ds_read_b128 v[44:47], v108 offset:18432
    s_waitcnt lgkmcnt(5)
    v_mfma_f32_32x32x16_bf16 v[76:91], a[68:71], v[48:51], v[76:91]
    ds_read_b128 v[48:51], v108 offset:19456
    s_waitcnt lgkmcnt(5)
    v_mfma_f32_32x32x16_bf16 v[76:91], a[72:75], v[52:55], v[76:91]
    ds_read_b128 v[52:55], v108 offset:20480
    s_waitcnt lgkmcnt(5)
    v_mfma_f32_32x32x16_bf16 v[76:91], a[76:79], v[56:59], v[76:91]
    ds_read_b128 v[56:59], v108 offset:21504
    s_waitcnt lgkmcnt(5)
    v_mfma_f32_32x32x16_bf16 v[76:91], a[80:83], v[60:63], v[76:91]
    v_dot2_f32_bf16 v92, v60, v94, v92
    v_dot2_f32_bf16 v93, v60, v60, v93
    v_dot2_f32_bf16 v92, v61, v94, v92
    v_dot2_f32_bf16 v93, v61, v61, v93
    v_dot2_f32_bf16 v92, v62, v94, v92
    v_dot2_f32_bf16 v93, v62, v62, v93
    v_dot2_f32_bf16 v92, v63, v94, v92
    v_dot2_f32_bf16 v93, v63, v63, v93
    ds_read_b128 v[60:63], v108 offset:22528
    s_waitcnt lgkmcnt(5)
    v_mfma_f32_32x32x16_bf16 v[76:91], a[84:87], v[64:67], v[76:91]
    ds_read_b128 v[64:67], v108 offset:23552
    s_waitcnt lgkmcnt(5)
    v_mfma_f32_32x32x16_bf16 v[76:91], a[88:91], v[44:47], v[76:91]
    ds_read_b128 v[44:47], v108 offset:24576
    s_waitcnt lgkmcnt(5)
    v_mfma_f32_32x32x16_bf16 v[76:91], a[92:95], v[48:51], v[76:91]
    ds_read_b128 v[48:51], v108 offset:25600
    s_waitcnt lgkmcnt(5)
    v_mfma_f32_32x32x16_bf16 v[76:91], a[96:99], v[52:55], v[76:91]
    v_dot2_f32_bf16 v92, v52, v94, v92
    v_dot2_f32_bf16 v93, v52, v52, v93
    v_dot2_f32_bf16 v92, v53, v94, v92
    v_dot2_f32_bf16 v93, v53, v53, v93
    v_dot2_f32_bf16 v92, v54, v94, v92
    v_dot2_f32_bf16 v93, v54, v54, v93
    v_dot2_f32_bf16 v92, v55, v94, v92
    v_dot2_f32_bf16 v93, v55, v55, v93
    ds_read_b128 v[52:55], v108 offset:26624
    s_waitcnt lgkmcnt(5)
    v_mfma_f32_32x32x16_bf16 v[76:91], a[100:103], v[56:59], v[76:91]
    ds_read_b128 v[56:59], v108 offset:27648
    s_waitcnt lgkmcnt(5)
    v_mfma_f32_32x32x16_bf16 v[76:91], a[104:107], v[60:63], v[76:91]
    ds_read_b128 v[60:63], v108 offset:28672
    s_waitcnt lgkmcnt(5)
    v_mfma_f32_32x32x16_bf16 v[76:91], a[108:111], v[64:67], v[76:91]
    ds_read_b128 v[64:67], v108 offset:29696
    s_waitcnt lgkmcnt(5)
    v_mfma_f32_32x32x16_bf16 v[76:91], a[112:115], v[44:47], v[76:91]
    v_dot2_f32_bf16 v92, v44, v94, v92
    v_dot2_f32_bf16 v93, v44, v44, v93
    v_dot2_f32_bf16 v92, v45, v94, v92
    v_dot2_f32_bf16 v93, v45, v45, v93
    v_dot2_f32_bf16 v92, v46, v94, v92
    v_dot2_f32_bf16 v93, v46, v46, v93
    v_dot2_f32_bf16 v92, v47, v94, v92
    v_dot2_f32_bf16 v93, v47, v47, v93
    ds_read_b128 v[44:47], v108 offset:30720
    s_waitcnt lgkmcnt(5)
    v_mfma_f32_32x32x16_bf16 v[76:91], a[116:119], v[48:51], v[76:91]
    ds_read_b128 v[48:51], v108 offset:31744
    s_waitcnt lgkmcnt(5)
    v_mfma_f32_32x32x16_bf16 v[76:91], a[120:123], v[52:55], v[76:91]
    ds_read_b128 v[52:55], v108 offset:32768
    s_waitcnt lgkmcnt(5)
    v_mfma_f32_32x32x16_bf16 v[76:91], a[124:127], v[56:59], v[76:91]
    ds_read_b128 v[56:59], v108 offset:33792
    s_waitcnt lgkmcnt(5)
    v_mfma_f32_32x32x16_bf16 v[76:91], a[128:131], v[60:63], v[76:91]
    v_dot2_f32_bf16 v92, v60, v94, v92
    v_dot2_f32_bf16 v93, v60, v60, v93
    v_dot2_f32_bf16 v92, v61, v94, v92
    v_dot2_f32_bf16 v93, v61, v61, v93
    v_dot2_f32_bf16 v92, v62, v94, v92
    v_dot2_f32_bf16 v93, v62, v62, v93
    v_dot2_f32_bf16 v92, v63, v94, v92
    v_dot2_f32_bf16 v93, v63, v63, v93
    ds_read_b128 v[60:63], v108 offset:34816
    s_waitcnt lgkmcnt(5)
    v_mfma_f32_32x32x16_bf16 v[76:91], a[132:135], v[64:67], v[76:91]
    ds_read_b128 v[64:67], v108 offset:35840
    s_waitcnt lgkmcnt(5)
    v_mfma_f32_32x32x16_bf16 v[76:91], a[136:139], v[44:47], v[76:91]
    ds_read_b128 v[44:47], v108 offset:36864
    s_waitcnt lgkmcnt(5)
    v_mfma_f32_32x32x16_bf16 v[76:91], a[140:143], v[48:51], v[76:91]
    ds_read_b128 v[48:51], v108 offset:37888
    s_waitcnt lgkmcnt(5)
    v_mfma_f32_32x32x16_bf16 v[76:91], a[144:147], v[52:55], v[76:91]
    v_dot2_f32_bf16 v92, v52, v94, v92
    v_dot2_f32_bf16 v93, v52, v52, v93
    v_dot2_f32_bf16 v92, v53, v94, v92
    v_dot2_f32_bf16 v93, v53, v53, v93
    v_dot2_f32_bf16 v92, v54, v94, v92
    v_dot2_f32_bf16 v93, v54, v54, v93
    v_dot2_f32_bf16 v92, v55, v94, v92
    v_dot2_f32_bf16 v93, v55, v55, v93
    ds_read_b128 v[52:55], v108 offset:38912
    s_waitcnt lgkmcnt(5)
    v_mfma_f32_32x32x16_bf16 v[76:91], a[148:151], v[56:59], v[76:91]
    ds_read_b128 v[56:59], v108 offset:39936
    s_waitcnt lgkmcnt(5)
    v_mfma_f32_32x32x16_bf16 v[76:91], a[152:155], v[60:63], v[76:91]
    s_waitcnt lgkmcnt(4)
    v_mfma_f32_32x32x16_bf16 v[76:91], a[156:159], v[64:67], v[76:91]
    s_waitcnt lgkmcnt(3)
    v_mfma_f32_32x32x16_bf16 v[76:91], a[160:163], v[44:47], v[76:91]
    v_dot2_f32_bf16 v92, v44, v94, v92
    v_dot2_f32_bf16 v93, v44, v44, v93
    v_dot2_f32_bf16 v92, v45, v94, v92
    v_dot2_f32_bf16 v93, v45, v45, v93
    v_dot2_f32_bf16 v92, v46, v94, v92
    v_dot2_f32_bf16 v93, v46, v46, v93
    v_dot2_f32_bf16 v92, v47, v94, v92
    v_dot2_f32_bf16 v93, v47, v47, v93
    s_waitcnt lgkmcnt(2)
    v_mfma_f32_32x32x16_bf16 v[76:91], a[164:167], v[48:51], v[76:91]
    s_waitcnt lgkmcnt(1)
    v_mfma_f32_32x32x16_bf16 v[76:91], a[168:171], v[52:55], v[76:91]
    s_waitcnt lgkmcnt(0)
    v_mfma_f32_32x32x16_bf16 v[76:91], a[172:175], v[56:59], v[76:91]
    s_branch L_po_f1_done
L_po_f1_1:
    s_cmp_lg_u32 s3, 1
    s_cbranch_scc1 L_po_f1_2
    ds_read_b128 v[64:67], v108 offset:5120
    s_waitcnt lgkmcnt(5)
    v_mfma_f32_32x32x16_bf16 v[76:91], a[16:19], v[44:47], 0
    ds_read_b128 v[44:47], v108 offset:6144
    s_waitcnt lgkmcnt(5)
    v_mfma_f32_32x32x16_bf16 v[76:91], a[20:23], v[48:51], v[76:91]
    v_dot2_f32_bf16 v92, v48, v94, v92
    v_dot2_f32_bf16 v93, v48, v48, v93
    v_dot2_f32_bf16 v92, v49, v94, v92
    v_dot2_f32_bf16 v93, v49, v49, v93
    v_dot2_f32_bf16 v92, v50, v94, v92
    v_dot2_f32_bf16 v93, v50, v50, v93
    v_dot2_f32_bf16 v92, v51, v94, v92
    v_dot2_f32_bf16 v93, v51, v51, v93
    ds_read_b128 v[48:51], v108 offset:7168
    s_waitcnt lgkmcnt(5)
    v_mfma_f32_32x32x16_bf16 v[76:91], a[24:27], v[52:55], v[76:91]
    ds_read_b128 v[52:55], v108 offset:8192
    s_waitcnt lgkmcnt(5)
    v_mfma_f32_32x32x16_bf16 v[76:91], a[28:31], v[56:59], v[76:91]
    ds_read_b128 v[56:59], v108 offset:9216
    s_waitcnt lgkmcnt(5)
    v_mfma_f32_32x32x16_bf16 v[76:91], a[32:35], v[60:63], v[76:91]
    ds_read_b128 v[60:63], v108 offset:10240
    s_waitcnt lgkmcnt(5)
    v_mfma_f32_32x32x16_bf16 v[76:91], a[36:39], v[64:67], v[76:91]
    v_dot2_f32_bf16 v92, v64, v94, v92
    v_dot2_f32_bf16 v93, v64, v64, v93
    v_dot2_f32_bf16 v92, v65, v94, v92
    v_dot2_f32_bf16 v93, v65, v65, v93
    v_dot2_f32_bf16 v92, v66, v94, v92
    v_dot2_f32_bf16 v93, v66, v66, v93
    v_dot2_f32_bf16 v92, v67, v94, v92
    v_dot2_f32_bf16 v93, v67, v67, v93
    ds_read_b128 v[64:67], v108 offset:11264
    s_waitcnt lgkmcnt(5)
    v_mfma_f32_32x32x16_bf16 v[76:91], a[40:43], v[44:47], v[76:91]
    ds_read_b128 v[44:47], v108 offset:12288
    s_waitcnt lgkmcnt(5)
    v_mfma_f32_32x32x16_bf16 v[76:91], a[44:47], v[48:51], v[76:91]
    ds_read_b128 v[48:51], v108 offset:13312
    s_waitcnt lgkmcnt(5)
    v_mfma_f32_32x32x16_bf16 v[76:91], a[48:51], v[52:55], v[76:91]
    ds_read_b128 v[52:55], v108 offset:14336
    s_waitcnt lgkmcnt(5)
    v_mfma_f32_32x32x16_bf16 v[76:91], a[52:55], v[56:59], v[76:91]
    v_dot2_f32_bf16 v92, v56, v94, v92
    v_dot2_f32_bf16 v93, v56, v56, v93
    v_dot2_f32_bf16 v92, v57, v94, v92
    v_dot2_f32_bf16 v93, v57, v57, v93
    v_dot2_f32_bf16 v92, v58, v94, v92
    v_dot2_f32_bf16 v93, v58, v58, v93
    v_dot2_f32_bf16 v92, v59, v94, v92
    v_dot2_f32_bf16 v93, v59, v59, v93
    ds_read_b128 v[56:59], v108 offset:15360
    s_waitcnt lgkmcnt(5)
    v_mfma_f32_32x32x16_bf16 v[76:91], a[56:59], v[60:63], v[76:91]
    ds_read_b128 v[60:63], v108 offset:16384
    s_waitcnt lgkmcnt(5)
    v_mfma_f32_32x32x16_bf16 v[76:91], a[60:63], v[64:67], v[76:91]
    ds_read_b128 v[64:67], v108 offset:17408
    s_waitcnt lgkmcnt(5)
    v_mfma_f32_32x32x16_bf16 v[76:91], a[64:67], v[44:47], v[76:91]
    ds_read_b128 v[44:47], v108 offset:18432
    s_waitcnt lgkmcnt(5)
    v_mfma_f32_32x32x16_bf16 v[76:91], a[68:71], v[48:51], v[76:91]
    v_dot2_f32_bf16 v92, v48, v94, v92
    v_dot2_f32_bf16 v93, v48, v48, v93
    v_dot2_f32_bf16 v92, v49, v94, v92
    v_dot2_f32_bf16 v93, v49, v49, v93
    v_dot2_f32_bf16 v92, v50, v94, v92
    v_dot2_f32_bf16 v93, v50, v50, v93
    v_dot2_f32_bf16 v92, v51, v94, v92
    v_dot2_f32_bf16 v93, v51, v51, v93
    ds_read_b128 v[48:51], v108 offset:19456
    s_waitcnt lgkmcnt(5)
    v_mfma_f32_32x32x16_bf16 v[76:91], a[72:75], v[52:55], v[76:91]
    ds_read_b128 v[52:55], v108 offset:20480
    s_waitcnt lgkmcnt(5)
    v_mfma_f32_32x32x16_bf16 v[76:91], a[76:79], v[56:59], v[76:91]
    ds_read_b128 v[56:59], v108 offset:21504
    s_waitcnt lgkmcnt(5)
    v_mfma_f32_32x32x16_bf16 v[76:91], a[80:83], v[60:63], v[76:91]
    ds_read_b128 v[60:63], v108 offset:22528
    s_waitcnt lgkmcnt(5)
    v_mfma_f32_32x32x16_bf16 v[76:91], a[84:87], v[64:67], v[76:91]
    v_dot2_f32_bf16 v92, v64, v94, v92
    v_dot2_f32_bf16 v93, v64, v64, v93
    v_dot2_f32_bf16 v92, v65, v94, v92
    v_dot2_f32_bf16 v93, v65, v65, v93
    v_dot2_f32_bf16 v92, v66, v94, v92
    v_dot2_f32_bf16 v93, v66, v66, v93
    v_dot2_f32_bf16 v92, v67, v94, v92
    v_dot2_f32_bf16 v93, v67, v67, v93
    ds_read_b128 v[64:67], v108 offset:23552
    s_waitcnt lgkmcnt(5)
    v_mfma_f32_32x32x16_bf16 v[76:91], a[88:91], v[44:47], v[76:91]
    ds_read_b128 v[44:47], v108 offset:24576
    s_waitcnt lgkmcnt(5)
    v_mfma_f32_32x32x16_bf16 v[76:91], a[92:95], v[48:51], v[76:91]
    ds_read_b128 v[48:51], v108 offset:25600
    s_waitcnt lgkmcnt(5)
    v_mfma_f32_32x32x16_bf16 v[76:91], a[96:99], v[52:55], v[76:91]
    ds_read_b128 v[52:55], v108 offset:26624
    s_waitcnt lgkmcnt(5)
    v_mfma_f32_32x32x16_bf16 v[76:91], a[100:103], v[56:59], v[76:91]
    v_dot2_f32_bf16 v92, v56, v94, v92
    v_dot2_f32_bf16 v93, v56, v56, v93
    v_dot2_f32_bf16 v92, v57, v94, v92
    v_dot2_f32_bf16 v93, v57, v57, v93
    v_dot2_f32_bf16 v92, v58, v94, v92
    v_dot2_f32_bf16 v93, v58, v58, v93
    v_dot2_f32_bf16 v92, v59, v94, v92
    v_dot2_f32_bf16 v93, v59, v59, v93
    ds_read_b128 v[56:59], v108 offset:27648
    s_waitcnt lgkmcnt(5)
    v_mfma_f32_32x32x16_bf16 v[76:91], a[104:107], v[60:63], v[76:91]
    ds_read_b128 v[60:63], v108 offset:28672
    s_waitcnt lgkmcnt(5)
    v_mfma_f32_32x32x16_bf16 v[76:91], a[108:111], v[64:67], v[76:91]
    ds_read_b128 v[64:67], v108 offset:29696
    s_waitcnt lgkmcnt(5)
    v_mfma_f32_32x32x16_bf16 v[76:91], a[112:115], v[44:47], v[76:91]
    ds_read_b128 v[44:47], v108 offset:30720
    s_waitcnt lgkmcnt(5)
    v_mfma_f32_32x32x16_bf16 v[76:91], a[116:119], v[48:51], v[76:91]
    v_dot2_f32_bf16 v92, v48, v94, v92
    v_dot2_f32_bf16 v93, v48, v48, v93
    v_dot2_f32_bf16 v92, v49, v94, v92
    v_dot2_f32_bf16 v93, v49, v49, v93
    v_dot2_f32_bf16 v92, v50, v94, v92
    v_dot2_f32_bf16 v93, v50, v50, v93
    v_dot2_f32_bf16 v92, v51, v94, v92
    v_dot2_f32_bf16 v93, v51, v51, v93
    ds_read_b128 v[48:51], v108 offset:31744
    s_waitcnt lgkmcnt(5)
    v_mfma_f32_32x32x16_bf16 v[76:91], a[120:123], v[52:55], v[76:91]
    ds_read_b128 v[52:55], v108 offset:32768
    s_waitcnt lgkmcnt(5)
    v_mfma_f32_32x32x16_bf16 v[76:91], a[124:127], v[56:59], v[76:91]
    ds_read_b128 v[56:59], v108 offset:33792
    s_waitcnt lgkmcnt(5)
    v_mfma_f32_32x32x16_bf16 v[76:91], a[128:131], v[60:63], v[76:91]
    ds_read_b128 v[60:63], v108 offset:34816
    s_waitcnt lgkmcnt(5)
    v_mfma_f32_32x32x16_bf16 v[76:91], a[132:135], v[64:67], v[76:91]
    v_dot2_f32_bf16 v92, v64, v94, v92
    v_dot2_f32_bf16 v93, v64, v64, v93
    v_dot2_f32_bf16 v92, v65, v94, v92
    v_dot2_f32_bf16 v93, v65, v65, v93
    v_dot2_f32_bf16 v92, v66, v94, v92
    v_dot2_f32_bf16 v93, v66, v66, v93
    v_dot2_f32_bf16 v92, v67, v94, v92
    v_dot2_f32_bf16 v93, v67, v67, v93
    ds_read_b128 v[64:67], v108 offset:35840
    s_waitcnt lgkmcnt(5)
    v_mfma_f32_32x32x16_bf16 v[76:91], a[136:139], v[44:47], v[76:91]
    ds_read_b128 v[44:47], v108 offset:36864
    s_waitcnt lgkmcnt(5)
    v_mfma_f32_32x32x16_bf16 v[76:91], a[140:143], v[48:51], v[76:91]
    ds_read_b128 v[48:51], v108 offset:37888
    s_waitcnt lgkmcnt(5)
    v_mfma_f32_32x32x16_bf16 v[76:91], a[144:147], v[52:55], v[76:91]
    ds_read_b128 v[52:55], v108 offset:38912
    s_waitcnt lgkmcnt(5)
    v_mfma_f32_32x32x16_bf16 v[76:91], a[148:151], v[56:59], v[76:91]
    v_dot2_f32_bf16 v92, v56, v94, v92
    v_dot2_f32_bf16 v93, v56, v56, v93
    v_dot2_f32_bf16 v92, v57, v94, v92
    v_dot2_f32_bf16 v93, v57, v57, v93
    v_dot2_f32_bf16 v92, v58, v94, v92
    v_dot2_f32_bf16 v93, v58, v58, v93
    v_dot2_f32_bf16 v92, v59, v94, v92
    v_dot2_f32_bf16 v93, v59, v59, v93
    ds_read_b128 v[56:59], v108 offset:39936
    s_waitcnt lgkmcnt(5)
    v_mfma_f32_32x32x16_bf16 v[76:91], a[152:155], v[60:63], v[76:91]
    s_waitcnt lgkmcnt(4)
    v_mfma_f32_32x32x16_bf16 v[76:91], a[156:159], v[64:67], v[76:91]
    s_waitcnt lgkmcnt(3)
    v_mfma_f32_32x32x16_bf16 v[76:91], a[160:163], v[44:47], v[76:91]
    s_waitcnt lgkmcnt(2)
    v_mfma_f32_32x32x16_bf16 v[76:91], a[164:167], v[48:51], v[76:91]
    v_dot2_f32_bf16 v92, v48, v94, v92
    v_dot2_f32_bf16 v93, v48, v48, v93
    v_dot2_f32_bf16 v92, v49, v94, v92
    v_dot2_f32_bf16 v93, v49, v49, v93
    v_dot2_f32_bf16 v92, v50, v94, v92
    v_dot2_f32_bf16 v93, v50, v50, v93
    v_dot2_f32_bf16 v92, v51, v94, v92
    v_dot2_f32_bf16 v93, v51, v51, v93
    s_waitcnt lgkmcnt(1)
    v_mfma_f32_32x32x16_bf16 v[76:91], a[168:171], v[52:55], v[76:91]
    s_waitcnt lgkmcnt(0)
    v_mfma_f32_32x32x16_bf16 v[76:91], a[172:175], v[56:59], v[76:91]
    s_branch L_po_f1_done
L_po_f1_2:
    s_cmp_lg_u32 s3, 2
    s_cbranch_scc1 L_po_f1_3
    ds_read_b128 v[64:67], v108 offset:5120
    s_waitcnt lgkmcnt(5)
    v_mfma_f32_32x32x16_bf16 v[76:91], a[16:19], v[44:47], 0
    ds_read_b128 v[44:47], v108 offset:6144
    s_waitcnt lgkmcnt(5)
    v_mfma_f32_32x32x16_bf16 v[76:91], a[20:23], v[48:51], v[76:91]
    ds_read_b128 v[48:51], v108 offset:7168
    s_waitcnt lgkmcnt(5)
    v_mfma_f32_32x32x16_bf16 v[76:91], a[24:27], v[52:55], v[76:91]
    v_dot2_f32_bf16 v92, v52, v94, v92
    v_dot2_f32_bf16 v93, v52, v52, v93
    v_dot2_f32_bf16 v92, v53, v94, v92
    v_dot2_f32_bf16 v93, v53, v53, v93
    v_dot2_f32_bf16 v92, v54, v94, v92
    v_dot2_f32_bf16 v93, v54, v54, v93
    v_dot2_f32_bf16 v92, v55, v94, v92
    v_dot2_f32_bf16 v93, v55, v55, v93
    ds_read_b128 v[52:55], v108 offset:8192
    s_waitcnt lgkmcnt(5)
    v_mfma_f32_32x32x16_bf16 v[76:91], a[28:31], v[56:59], v[76:91]
    ds_read_b128 v[56:59], v108 offset:9216
    s_waitcnt lgkmcnt(5)
    v_mfma_f32_32x32x16_bf16 v[76:91], a[32:35], v[60:63], v[76:91]
    ds_read_b128 v[60:63], v108 offset:10240
    s_waitcnt lgkmcnt(5)
    v_mfma_f32_32x32x16_bf16 v[76:91], a[36:39], v[64:67], v[76:91]
    ds_read_b128 v[64:67], v108 offset:11264
    s_waitcnt lgkmcnt(5)
    v_mfma_f32_32x32x16_bf16 v[76:91], a[40:43], v[44:47], v[76:91]
    v_dot2_f32_bf16 v92, v44, v94, v92
    v_dot2_f32_bf16 v93, v44, v44, v93
    v_dot2_f32_bf16 v92, v45, v94, v92
    v_dot2_f32_bf16 v93, v45, v45, v93
    v_dot2_f32_bf16 v92, v46, v94, v92
    v_dot2_f32_bf16 v93, v46, v46, v93
    v_dot2_f32_bf16 v92, v47, v94, v92
    v_dot2_f32_bf16 v93, v47, v47, v93
    ds_read_b128 v[44:47], v108 offset:12288
    s_waitcnt lgkmcnt(5)
    v_mfma_f32_32x32x16_bf16 v[76:91], a[44:47], v[48:51], v[76:91]
    ds_read_b128 v[48:51], v108 offset:13312
    s_waitcnt lgkmcnt(5)
    v_mfma_f32_32x32x16_bf16 v[76:91], a[48:51], v[52:55], v[76:91]
    ds_read_b128 v[52:55], v108 offset:14336
    s_waitcnt lgkmcnt(5)
    v_mfma_f32_32x32x16_bf16 v[76:91], a[52:55], v[56:59], v[76:91]
    ds_read_b128 v[56:59], v108 offset:15360
    s_waitcnt lgkmcnt(5)
    v_mfma_f32_32x32x16_bf16 v[76:91], a[56:59], v[60:63], v[76:91]
    v_dot2_f32_bf16 v92, v60, v94, v92
    v_dot2_f32_bf16 v93, v60, v60, v93
    v_dot2_f32_bf16 v92, v61, v94, v92
    v_dot2_f32_bf16 v93, v61, v61, v93
    v_dot2_f32_bf16 v92, v62, v94, v92
    v_dot2_f32_bf16 v93, v62, v62, v93
    v_dot2_f32_bf16 v92, v63, v94, v92
    v_dot2_f32_bf16 v93, v63, v63, v93
    ds_read_b128 v[60:63], v108 offset:16384
    s_waitcnt lgkmcnt(5)
    v_mfma_f32_32x32x16_bf16 v[76:91], a[60:63], v[64:67], v[76:91]
    ds_read_b128 v[64:67], v108 offset:17408
    s_waitcnt lgkmcnt(5)
    v_mfma_f32_32x32x16_bf16 v[76:91], a[64:67], v[44:47], v[76:91]
    ds_read_b128 v[44:47], v108 offset:18432
    s_waitcnt lgkmcnt(5)
    v_mfma_f32_32x32x16_bf16 v[76:91], a[68:71], v[48:51], v[76:91]
    ds_read_b128 v[48:51], v108 offset:19456
    s_waitcnt lgkmcnt(5)
    v_mfma_f32_32x32x16_bf16 v[76:91], a[72:75], v[52:55], v[76:91]
    v_dot2_f32_bf16 v92, v52, v94, v92
    v_dot2_f32_bf16 v93, v52, v52, v93
    v_dot2_f32_bf16 v92, v53, v94, v92
    v_dot2_f32_bf16 v93, v53, v53, v93
    v_dot2_f32_bf16 v92, v54, v94, v92
    v_dot2_f32_bf16 v93, v54, v54, v93
    v_dot2_f32_bf16 v92, v55, v94, v92
    v_dot2_f32_bf16 v93, v55, v55, v93
    ds_read_b128 v[52:55], v108 offset:20480
    s_waitcnt lgkmcnt(5)
    v_mfma_f32_32x32x16_bf16 v[76:91], a[76:79], v[56:59], v[76:91]
    ds_read_b128 v[56:59], v108 offset:21504
    s_waitcnt lgkmcnt(5)
    v_mfma_f32_32x32x16_bf16 v[76:91], a[80:83], v[60:63], v[76:91]
    ds_read_b128 v[60:63], v108 offset:22528
    s_waitcnt lgkmcnt(5)
    v_mfma_f32_32x32x16_bf16 v[76:91], a[84:87], v[64:67], v[76:91]
    ds_read_b128 v[64:67], v108 offset:23552
    s_waitcnt lgkmcnt(5)
    v_mfma_f32_32x32x16_bf16 v[76:91], a[88:91], v[44:47], v[76:91]
    v_dot2_f32_bf16 v92, v44, v94, v92
    v_dot2_f32_bf16 v93, v44, v44, v93
    v_dot2_f32_bf16 v92, v45, v94, v92
    v_dot2_f32_bf16 v93, v45, v45, v93
    v_dot2_f32_bf16 v92, v46, v94, v92
    v_dot2_f32_bf16 v93, v46, v46, v93
    v_dot2_f32_bf16 v92, v47, v94, v92
    v_dot2_f32_bf16 v93, v47, v47, v93
    ds_read_b128 v[44:47], v108 offset:24576
    s_waitcnt lgkmcnt(5)
    v_mfma_f32_32x32x16_bf16 v[76:91], a[92:95], v[48:51], v[76:91]
    ds_read_b128 v[48:51], v108 offset:25600
    s_waitcnt lgkmcnt(5)
    v_mfma_f32_32x32x16_bf16 v[76:91], a[96:99], v[52:55], v[76:91]
    ds_read_b128 v[52:55], v108 offset:26624
    s_waitcnt lgkmcnt(5)
    v_mfma_f32_32x32x16_bf16 v[76:91], a[100:103], v[56:59], v[76:91]
    ds_read_b128 v[56:59], v108 offset:27648
    s_waitcnt lgkmcnt(5)
    v_mfma_f32_32x32x16_bf16 v[76:91], a[104:107], v[60:63], v[76:91]
    v_dot2_f32_bf16 v92, v60, v94, v92
    v_dot2_f32_bf16 v93, v60, v60, v93
    v_dot2_f32_bf16 v92, v61, v94, v92
    v_dot2_f32_bf16 v93, v61, v61, v93
    v_dot2_f32_bf16 v92, v62, v94, v92
    v_dot2_f32_bf16 v93, v62, v62, v93
    v_dot2_f32_bf16 v92, v63, v94, v92
    v_dot2_f32_bf16 v93, v63, v63, v93
    ds_read_b128 v[60:63], v108 offset:28672
    s_waitcnt lgkmcnt(5)
    v_mfma_f32_32x32x16_bf16 v[76:91], a[108:111], v[64:67], v[76:91]
    ds_read_b128 v[64:67], v108 offset:29696
    s_waitcnt lgkmcnt(5)
    v_mfma_f32_32x32x16_bf16 v[76:91], a[112:115], v[44:47], v[76:91]
    ds_read_b128 v[44:47], v108 offset:30720
    s_waitcnt lgkmcnt(5)
    v_mfma_f32_32x32x16_bf16 v[76:91], a[116:119], v[48:51], v[76:91]
    ds_read_b128 v[48:51], v108 offset:31744
    s_waitcnt lgkmcnt(5)
    v_mfma_f32_32x32x16_bf16 v[76:91], a[120:123], v[52:55], v[76:91]
    v_dot2_f32_bf16 v92, v52, v94, v92
    v_dot2_f32_bf16 v93, v52, v52, v93
    v_dot2_f32_bf16 v92, v53, v94, v92
    v_dot2_f32_bf16 v93, v53, v53, v93
    v_dot2_f32_bf16 v92, v54, v94, v92
    v_dot2_f32_bf16 v93, v54, v54, v93
    v_dot2_f32_bf16 v92, v55, v94, v92
    v_dot2_f32_bf16 v93, v55, v55, v93
    ds_read_b128 v[52:55], v108 offset:32768
    s_waitcnt lgkmcnt(5)
    v_mfma_f32_32x32x16_bf16 v[76:91], a[124:127], v[56:59], v[76:91]
    ds_read_b128 v[56:59], v108 offset:33792
    s_waitcnt lgkmcnt(5)
    v_mfma_f32_32x32x16_bf16 v[76:91], a[128:131], v[60:63], v[76:91]
    ds_read_b128 v[60:63], v108 offset:34816
    s_waitcnt lgkmcnt(5)
    v_mfma_f32_32x32x16_bf16 v[76:91], a[132:135], v[64:67], v[76:91]
    ds_read_b128 v[64:67], v108 offset:35840
    s_waitcnt lgkmcnt(5)
    v_mfma_f32_32x32x16_bf16 v[76:91], a[136:139], v[44:47], v[76:91]
    v_dot2_f32_bf16 v92, v44, v94, v92
    v_dot2_f32_bf16 v93, v44, v44, v93
    v_dot2_f32_bf16 v92, v45, v94, v92
    v_dot2_f32_bf16 v93, v45, v45, v93
    v_dot2_f32_bf16 v92, v46, v94, v92
    v_dot2_f32_bf16 v93, v46, v46, v93
    v_dot2_f32_bf16 v92, v47, v94, v92
    v_dot2_f32_bf16 v93, v47, v47, v93
    ds_read_b128 v[44:47], v108 offset:36864
    s_waitcnt lgkmcnt(5)
    v_mfma_f32_32x32x16_bf16 v[76:91], a[140:143], v[48:51], v[76:91]
    ds_read_b128 v[48:51], v108 offset:37888
    s_waitcnt lgkmcnt(5)
    v_mfma_f32_32x32x16_bf16 v[76:91], a[144:147], v[52:55], v[76:91]
    ds_read_b128 v[52:55], v108 offset:38912
    s_waitcnt lgkmcnt(5)
    v_mfma_f32_32x32x16_bf16 v[76:91], a[148:151], v[56:59], v[76:91]
    ds_read_b128 v[56:59], v108 offset:39936
    s_waitcnt lgkmcnt(5)
    v_mfma_f32_32x32x16_bf16 v[76:91], a[152:155], v[60:63], v[76:91]
    v_dot2_f32_bf16 v92, v60, v94, v92
    v_dot2_f32_bf16 v93, v60, v60, v93
    v_dot2_f32_bf16 v92, v61, v94, v92
    v_dot2_f32_bf16 v93, v61, v61, v93
    v_dot2_f32_bf16 v92, v62, v94, v92
    v_dot2_f32_bf16 v93, v62, v62, v93
    v_dot2_f32_bf16 v92, v63, v94, v92
    v_dot2_f32_bf16 v93, v63, v63, v93
    s_waitcnt lgkmcnt(4)
    v_mfma_f32_32x32x16_bf16 v[76:91], a[156:159], v[64:67], v[76:91]
    s_waitcnt lgkmcnt(3)
    v_mfma_f32_32x32x16_bf16 v[76:91], a[160:163], v[44:47], v[76:91]
    s_waitcnt lgkmcnt(2)
    v_mfma_f32_32x32x16_bf16 v[76:91], a[164:167], v[48:51], v[76:91]
    s_waitcnt lgkmcnt(1)
    v_mfma_f32_32x32x16_bf16 v[76:91], a[168:171], v[52:55], v[76:91]
    v_dot2_f32_bf16 v92, v52, v94, v92
    v_dot2_f32_bf16 v93, v52, v52, v93
    v_dot2_f32_bf16 v92, v53, v94, v92
    v_dot2_f32_bf16 v93, v53, v53, v93
    v_dot2_f32_bf16 v92, v54, v94, v92
    v_dot2_f32_bf16 v93, v54, v54, v93
    v_dot2_f32_bf16 v92, v55, v94, v92
    v_dot2_f32_bf16 v93, v55, v55, v93
    s_waitcnt lgkmcnt(0)
    v_mfma_f32_32x32x16_bf16 v[76:91], a[172:175], v[56:59], v[76:91]
    s_branch L_po_f1_done
L_po_f1_3:
    ds_read_b128 v[64:67], v108 offset:5120
    s_waitcnt lgkmcnt(5)
    v_mfma_f32_32x32x16_bf16 v[76:91], a[16:19], v[44:47], 0
    ds_read_b128 v[44:47], v108 offset:6144
    s_waitcnt lgkmcnt(5)
    v_mfma_f32_32x32x16_bf16 v[76:91], a[20:23], v[48:51], v[76:91]
    ds_read_b128 v[48:51], v108 offset:7168
    s_waitcnt lgkmcnt(5)
    v_mfma_f32_32x32x16_bf16 v[76:91], a[24:27], v[52:55], v[76:91]
    ds_read_b128 v[52:55], v108 offset:8192
    s_waitcnt lgkmcnt(5)
    v_mfma_f32_32x32x16_bf16 v[76:91], a[28:31], v[56:59], v[76:91]
    v_dot2_f32_bf16 v92, v56, v94, v92
    v_dot2_f32_bf16 v93, v56, v56, v93
    v_dot2_f32_bf16 v92, v57, v94, v92
    v_dot2_f32_bf16 v93, v57, v57, v93
    v_dot2_f32_bf16 v92, v58, v94, v92
    v_dot2_f32_bf16 v93, v58, v58, v93
    v_dot2_f32_bf16 v92, v59, v94, v92
    v_dot2_f32_bf16 v93, v59, v59, v93
    ds_read_b128 v[56:59], v108 offset:9216
    s_waitcnt lgkmcnt(5)
    v_mfma_f32_32x32x16_bf16 v[76:91], a[32:35], v[60:63], v[76:91]
    ds_read_b128 v[60:63], v108 offset:10240
    s_waitcnt lgkmcnt(5)
    v_mfma_f32_32x32x16_bf16 v[76:91], a[36:39], v[64:67], v[76:91]
    ds_read_b128 v[64:67], v108 offset:11264
    s_waitcnt lgkmcnt(5)
    v_mfma_f32_32x32x16_bf16 v[76:91], a[40:43], v[44:47], v[76:91]
    ds_read_b128 v[44:47], v108 offset:12288
    s_waitcnt lgkmcnt(5)
    v_mfma_f32_32x32x16_bf16 v[76:91], a[44:47], v[48:51], v[76:91]
    v_dot2_f32_bf16 v92, v48, v94, v92
    v_dot2_f32_bf16 v93, v48, v48, v93
    v_dot2_f32_bf16 v92, v49, v94, v92
    v_dot2_f32_bf16 v93, v49, v49, v93
    v_dot2_f32_bf16 v92, v50, v94, v92
    v_dot2_f32_bf16 v93, v50, v50, v93
    v_dot2_f32_bf16 v92, v51, v94, v92
    v_dot2_f32_bf16 v93, v51, v51, v93
    ds_read_b128 v[48:51], v108 offset:13312
    s_waitcnt lgkmcnt(5)
    v_mfma_f32_32x32x16_bf16 v[76:91], a[48:51], v[52:55], v[76:91]
    ds_read_b128 v[52:55], v108 offset:14336
    s_waitcnt lgkmcnt(5)
    v_mfma_f32_32x32x16_bf16 v[76:91], a[52:55], v[56:59], v[76:91]
    ds_read_b128 v[56:59], v108 offset:15360
    s_waitcnt lgkmcnt(5)
    v_mfma_f32_32x32x16_bf16 v[76:91], a[56:59], v[60:63], v[76:91]
    ds_read_b128 v[60:63], v108 offset:16384
    s_waitcnt lgkmcnt(5)
    v_mfma_f32_32x32x16_bf16 v[76:91], a[60:63], v[64:67], v[76:91]
    v_dot2_f32_bf16 v92, v64, v94, v92
    v_dot2_f32_bf16 v93, v64, v64, v93
    v_dot2_f32_bf16 v92, v65, v94, v92
    v_dot2_f32_bf16 v93, v65, v65, v93
    v_dot2_f32_bf16 v92, v66, v94, v92
    v_dot2_f32_bf16 v93, v66, v66, v93
    v_dot2_f32_bf16 v92, v67, v94, v92
    v_dot2_f32_bf16 v93, v67, v67, v93
    ds_read_b128 v[64:67], v108 offset:17408
    s_waitcnt lgkmcnt(5)
    v_mfma_f32_32x32x16_bf16 v[76:91], a[64:67], v[44:47], v[76:91]
    ds_read_b128 v[44:47], v108 offset:18432
    s_waitcnt lgkmcnt(5)
    v_mfma_f32_32x32x16_bf16 v[76:91], a[68:71], v[48:51], v[76:91]
    ds_read_b128 v[48:51], v108 offset:19456
    s_waitcnt lgkmcnt(5)
    v_mfma_f32_32x32x16_bf16 v[76:91], a[72:75], v[52:55], v[76:91]
    ds_read_b128 v[52:55], v108 offset:20480
    s_waitcnt lgkmcnt(5)
    v_mfma_f32_32x32x16_bf16 v[76:91], a[76:79], v[56:59], v[76:91]
    v_dot2_f32_bf16 v92, v56, v94, v92
    v_dot2_f32_bf16 v93, v56, v56, v93
    v_dot2_f32_bf16 v92, v57, v94, v92
    v_dot2_f32_bf16 v93, v57, v57, v93
    v_dot2_f32_bf16 v92, v58, v94, v92
    v_dot2_f32_bf16 v93, v58, v58, v93
    v_dot2_f32_bf16 v92, v59, v94, v92
    v_dot2_f32_bf16 v93, v59, v59, v93
    ds_read_b128 v[56:59], v108 offset:21504
    s_waitcnt lgkmcnt(5)
    v_mfma_f32_32x32x16_bf16 v[76:91], a[80:83], v[60:63], v[76:91]
    ds_read_b128 v[60:63], v108 offset:22528
    s_waitcnt lgkmcnt(5)
    v_mfma_f32_32x32x16_bf16 v[76:91], a[84:87], v[64:67], v[76:91]
    ds_read_b128 v[64:67], v108 offset:23552
    s_waitcnt lgkmcnt(5)
    v_mfma_f32_32x32x16_bf16 v[76:91], a[88:91], v[44:47], v[76:91]
    ds_read_b128 v[44:47], v108 offset:24576
    s_waitcnt lgkmcnt(5)
    v_mfma_f32_32x32x16_bf16 v[76:91], a[92:95], v[48:51], v[76:91]
    v_dot2_f32_bf16 v92, v48, v94, v92
    v_dot2_f32_bf16 v93, v48, v48, v93
    v_dot2_f32_bf16 v92, v49, v94, v92
    v_dot2_f32_bf16 v93, v49, v49, v93
    v_dot2_f32_bf16 v92, v50, v94, v92
    v_dot2_f32_bf16 v93, v50, v50, v93
    v_dot2_f32_bf16 v92, v51, v94, v92
    v_dot2_f32_bf16 v93, v51, v51, v93
    ds_read_b128 v[48:51], v108 offset:25600
    s_waitcnt lgkmcnt(5)
    v_mfma_f32_32x32x16_bf16 v[76:91], a[96:99], v[52:55], v[76:91]
    ds_read_b128 v[52:55], v108 offset:26624
    s_waitcnt lgkmcnt(5)
    v_mfma_f32_32x32x16_bf16 v[76:91], a[100:103], v[56:59], v[76:91]
    ds_read_b128 v[56:59], v108 offset:27648
    s_waitcnt lgkmcnt(5)
    v_mfma_f32_32x32x16_bf16 v[76:91], a[104:107], v[60:63], v[76:91]
    ds_read_b128 v[60:63], v108 offset:28672
    s_waitcnt lgkmcnt(5)
    v_mfma_f32_32x32x16_bf16 v[76:91], a[108:111], v[64:67], v[76:91]
    v_dot2_f32_bf16 v92, v64, v94, v92
    v_dot2_f32_bf16 v93, v64, v64, v93
    v_dot2_f32_bf16 v92, v65, v94, v92
    v_dot2_f32_bf16 v93, v65, v65, v93
    v_dot2_f32_bf16 v92, v66, v94, v92
    v_dot2_f32_bf16 v93, v66, v66, v93
    v_dot2_f32_bf16 v92, v67, v94, v92
    v_dot2_f32_bf16 v93, v67, v67, v93
    ds_read_b128 v[64:67], v108 offset:29696
    s_waitcnt lgkmcnt(5)
    v_mfma_f32_32x32x16_bf16 v[76:91], a[112:115], v[44:47], v[76:91]
    ds_read_b128 v[44:47], v108 offset:30720
    s_waitcnt lgkmcnt(5)
    v_mfma_f32_32x32x16_bf16 v[76:91], a[116:119], v[48:51], v[76:91]
    ds_read_b128 v[48:51], v108 offset:31744
    s_waitcnt lgkmcnt(5)
    v_mfma_f32_32x32x16_bf16 v[76:91], a[120:123], v[52:55], v[76:91]
    ds_read_b128 v[52:55], v108 offset:32768
    s_waitcnt lgkmcnt(5)
    v_mfma_f32_32x32x16_bf16 v[76:91], a[124:127], v[56:59], v[76:91]
    v_dot2_f32_bf16 v92, v56, v94, v92
    v_dot2_f32_bf16 v93, v56, v56, v93
    v_dot2_f32_bf16 v92, v57, v94, v92
    v_dot2_f32_bf16 v93, v57, v57, v93
    v_dot2_f32_bf16 v92, v58, v94, v92
    v_dot2_f32_bf16 v93, v58, v58, v93
    v_dot2_f32_bf16 v92, v59, v94, v92
    v_dot2_f32_bf16 v93, v59, v59, v93
    ds_read_b128 v[56:59], v108 offset:33792
    s_waitcnt lgkmcnt(5)
    v_mfma_f32_32x32x16_bf16 v[76:91], a[128:131], v[60:63], v[76:91]
    ds_read_b128 v[60:63], v108 offset:34816
    s_waitcnt lgkmcnt(5)
    v_mfma_f32_32x32x16_bf16 v[76:91], a[132:135], v[64:67], v[76:91]
    ds_read_b128 v[64:67], v108 offset:35840
    s_waitcnt lgkmcnt(5)
    v_mfma_f32_32x32x16_bf16 v[76:91], a[136:139], v[44:47], v[76:91]
    ds_read_b128 v[44:47], v108 offset:36864
    s_waitcnt lgkmcnt(5)
    v_mfma_f32_32x32x16_bf16 v[76:91], a[140:143], v[48:51], v[76:91]
    v_dot2_f32_bf16 v92, v48, v94, v92
    v_dot2_f32_bf16 v93, v48, v48, v93
    v_dot2_f32_bf16 v92, v49, v94, v92
    v_dot2_f32_bf16 v93, v49, v49, v93
    v_dot2_f32_bf16 v92, v50, v94, v92
    v_dot2_f32_bf16 v93, v50, v50, v93
    v_dot2_f32_bf16 v92, v51, v94, v92
    v_dot2_f32_bf16 v93, v51, v51, v93
    ds_read_b128 v[48:51], v108 offset:37888
    s_waitcnt lgkmcnt(5)
    v_mfma_f32_32x32x16_bf16 v[76:91], a[144:147], v[52:55], v[76:91]
    ds_read_b128 v[52:55], v108 offset:38912
    s_waitcnt lgkmcnt(5)
    v_mfma_f32_32x32x16_bf16 v[76:91], a[148:151], v[56:59], v[76:91]
    ds_read_b128 v[56:59], v108 offset:39936
    s_waitcnt lgkmcnt(5)
    v_mfma_f32_32x32x16_bf16 v[76:91], a[152:155], v[60:63], v[76:91]
    s_waitcnt lgkmcnt(4)
    v_mfma_f32_32x32x16_bf16 v[76:91], a[156:159], v[64:67], v[76:91]
    v_dot2_f32_bf16 v92, v64, v94, v92
    v_dot2_f32_bf16 v93, v64, v64, v93
    v_dot2_f32_bf16 v92, v65, v94, v92
    v_dot2_f32_bf16 v93, v65, v65, v93
    v_dot2_f32_bf16 v92, v66, v94, v92
    v_dot2_f32_bf16 v93, v66, v66, v93
    v_dot2_f32_bf16 v92, v67, v94, v92
    v_dot2_f32_bf16 v93, v67, v67, v93
    s_waitcnt lgkmcnt(3)
    v_mfma_f32_32x32x16_bf16 v[76:91], a[160:163], v[44:47], v[76:91]
    s_waitcnt lgkmcnt(2)
    v_mfma_f32_32x32x16_bf16 v[76:91], a[164:167], v[48:51], v[76:91]
    s_waitcnt lgkmcnt(1)
    v_mfma_f32_32x32x16_bf16 v[76:91], a[168:171], v[52:55], v[76:91]
    s_waitcnt lgkmcnt(0)
    v_mfma_f32_32x32x16_bf16 v[76:91], a[172:175], v[56:59], v[76:91]
    v_dot2_f32_bf16 v92, v56, v94, v92
    v_dot2_f32_bf16 v93, v56, v56, v93
    v_dot2_f32_bf16 v92, v57, v94, v92
    v_dot2_f32_bf16 v93, v57, v57, v93
    v_dot2_f32_bf16 v92, v58, v94, v92
    v_dot2_f32_bf16 v93, v58, v58, v93
    v_dot2_f32_bf16 v92, v59, v94, v92
    v_dot2_f32_bf16 v93, v59, v59, v93
L_po_f1_done:
    s_nop 3
    v_mov_b32 v94, v92
    v_mov_b32 v95, v93
    s_nop 0
    v_permlane32_swap_b32 v92, v94
    v_permlane32_swap_b32 v93, v95
    v_add_f32 v92, v92, v94
    v_add_f32 v93, v93, v95
    v_lshrrev_b32 v94, 1, v0
    v_and_b32 v94, 0xff, v94
    s_lshl_b32 s72, s3, 8
    v_add_u32 v95, s72, v94
    ds_write_b64 v95, v[92:93] offset:61440
    s_waitcnt lgkmcnt(0)
    s_barrier
    ds_read_b64 v[44:45], v94 offset:61440
    ds_read_b64 v[46:47], v94 offset:61696
    ds_read_b64 v[48:49], v94 offset:61952
    ds_read_b64 v[50:51], v94 offset:62208
    s_waitcnt lgkmcnt(0)
    v_add_f32 v44, v44, v46
    v_add_f32 v45, v45, v47
    v_add_f32 v48, v48, v50
    v_add_f32 v49, v49, v51
    v_add_f32 v44, v44, v48
    v_add_f32 v45, v45, v49
    v_mul_f32 v44, 0x3acccccd, v44
    v_mul_f32 v45, 0x3acccccd, v45
    v_fma_f32 v45, -v44, v44, v45
    v_max_f32 v45, 0, v45
    v_add_f32 v45, 0x3727c5ac, v45
    v_rsq_f32 v45, v45
    s_nop 0
    v_fma_f32 v76, -v44, v14, v76
    v_mul_f32 v76, v76, v45
    v_fma_f32 v77, -v44, v15, v77
    v_mul_f32 v77, v77, v45
    v_fma_f32 v78, -v44, v16, v78
    v_mul_f32 v78, v78, v45
    v_fma_f32 v79, -v44, v17, v79
    v_mul_f32 v79, v79, v45
    v_fma_f32 v80, -v44, v18, v80
    v_mul_f32 v80, v80, v45
    v_fma_f32 v81, -v44, v19, v81
    v_mul_f32 v81, v81, v45
    v_fma_f32 v82, -v44, v20, v82
    v_mul_f32 v82, v82, v45
    v_fma_f32 v83, -v44, v21, v83
    v_mul_f32 v83, v83, v45
    v_fma_f32 v84, -v44, v22, v84
    v_mul_f32 v84, v84, v45
    v_fma_f32 v85, -v44, v23, v85
    v_mul_f32 v85, v85, v45
    v_fma_f32 v86, -v44, v24, v86
    v_mul_f32 v86, v86, v45
    v_fma_f32 v87, -v44, v25, v87
    v_mul_f32 v87, v87, v45
    v_fma_f32 v88, -v44, v26, v88
    v_mul_f32 v88, v88, v45
    v_fma_f32 v89, -v44, v27, v89
    v_mul_f32 v89, v89, v45
    v_fma_f32 v90, -v44, v28, v90
    v_mul_f32 v90, v90, v45
    v_fma_f32 v91, -v44, v29, v91
    v_mul_f32 v91, v91, v45
    v_mul_f32 v76, 0xbfb8aa3b, v76
    v_mul_f32 v77, 0xbfb8aa3b, v77
    v_mul_f32 v78, 0xbfb8aa3b, v78
    v_mul_f32 v79, 0xbfb8aa3b, v79
    v_mul_f32 v80, 0xbfb8aa3b, v80
    v_mul_f32 v81, 0xbfb8aa3b, v81
    v_mul_f32 v82, 0xbfb8aa3b, v82
    v_mul_f32 v83, 0xbfb8aa3b, v83
    v_exp_f32 v76, v76
    v_exp_f32 v77, v77
    v_exp_f32 v78, v78
    v_exp_f32 v79, v79
    v_exp_f32 v80, v80
    v_exp_f32 v81, v81
    v_exp_f32 v82, v82
    v_exp_f32 v83, v83
    s_nop 0
    v_add_f32 v76, 1.0, v76
    v_add_f32 v77, 1.0, v77
    v_add_f32 v78, 1.0, v78
    v_add_f32 v79, 1.0, v79
    v_add_f32 v80, 1.0, v80
    v_add_f32 v81, 1.0, v81
    v_add_f32 v82, 1.0, v82
    v_add_f32 v83, 1.0, v83
    v_rcp_f32 v76, v76
    v_rcp_f32 v77, v77
    v_rcp_f32 v78, v78
    v_rcp_f32 v79, v79
    v_rcp_f32 v80, v80
    v_rcp_f32 v81, v81
    v_rcp_f32 v82, v82
    v_rcp_f32 v83, v83
    s_nop 0
    v_mul_f32 v76, v76, v84
    v_mul_f32 v77, v77, v85
    v_mul_f32 v78, v78, v86
    v_mul_f32 v79, v79, v87
    v_mul_f32 v80, v80, v88
    v_mul_f32 v81, v81, v89
    v_mul_f32 v82, v82, v90
    v_mul_f32 v83, v83, v91
    v_cvt_pk_bf16_f32 v44, v76, v77
    v_cvt_pk_bf16_f32 v45, v78, v79
    v_cvt_pk_bf16_f32 v46, v80, v81
    v_cvt_pk_bf16_f32 v47, v82, v83
    s_lshl_b32 s72, s3, 10
    v_add_u32 v95, s72, v0
    v_add_u32 v95, 103424, v95
    ds_write_b128 v95, v[44:47]
    s_waitcnt lgkmcnt(0)
    s_barrier
    v_add_u32 v95, 103424, v0
    ds_read_b128 v[44:47], v95 offset:0
    ds_read_b128 v[48:51], v95 offset:1024
    ds_read_b128 v[52:55], v95 offset:2048
    ds_read_b128 v[56:59], v95 offset:3072
    s_waitcnt lgkmcnt(0)
    v_mfma_f32_32x32x16_bf16 v[76:91], a[176:179], v[44:47], 0
    v_mfma_f32_32x32x16_bf16 v[76:91], a[180:183], v[48:51], v[76:91]
    v_mfma_f32_32x32x16_bf16 v[76:91], a[184:187], v[52:55], v[76:91]
    v_mfma_f32_32x32x16_bf16 v[76:91], a[188:191], v[56:59], v[76:91]
    v_mfma_f32_32x32x16_bf16 v[60:75], a[192:195], v[44:47], 0
    v_mfma_f32_32x32x16_bf16 v[60:75], a[196:199], v[48:51], v[60:75]
    v_mfma_f32_32x32x16_bf16 v[60:75], a[200:203], v[52:55], v[60:75]
    s_nop 8
    v_cvt_pk_bf16_f32 v92, v76, v77
    v_cvt_pk_bf16_f32 v93, v78, v79
    v_cvt_pk_bf16_f32 v94, v80, v81
    v_cvt_pk_bf16_f32 v95, v82, v83
    s_add_u32 s72, s68, 1310720
    buffer_store_dwordx4 v[92:95], v4, s[44:47], s72 offen
    v_mfma_f32_32x32x16_bf16 v[60:75], a[204:207], v[56:59], v[60:75]
    v_cvt_pk_bf16_f32 v96, v84, v85
    v_cvt_pk_bf16_f32 v97, v86, v87
    v_cvt_pk_bf16_f32 v98, v88, v89
    v_cvt_pk_bf16_f32 v99, v90, v91
    s_add_u32 s73, s68, 1343488
    buffer_store_dwordx4 v[96:99], v4, s[44:47], s73 offen
    v_mfma_f32_32x32x16_bf16 v[76:91], a[208:211], v[44:47], 0
    v_mfma_f32_32x32x16_bf16 v[76:91], a[212:215], v[48:51], v[76:91]
    v_mfma_f32_32x32x16_bf16 v[76:91], a[216:219], v[52:55], v[76:91]
    s_nop 2
    v_cvt_pk_bf16_f32 v92, v60, v61
    v_cvt_pk_bf16_f32 v93, v62, v63
    v_cvt_pk_bf16_f32 v94, v64, v65
    v_cvt_pk_bf16_f32 v95, v66, v67
    s_add_u32 s72, s68, 1376256
    buffer_store_dwordx4 v[92:95], v4, s[44:47], s72 offen
    v_mfma_f32_32x32x16_bf16 v[76:91], a[220:223], v[56:59], v[76:91]
    v_cvt_pk_bf16_f32 v96, v68, v69
    v_cvt_pk_bf16_f32 v97, v70, v71
    v_cvt_pk_bf16_f32 v98, v72, v73
    v_cvt_pk_bf16_f32 v99, v74, v75
    s_add_u32 s73, s68, 1409024
    buffer_store_dwordx4 v[96:99], v4, s[44:47], s73 offen
    v_mfma_f32_32x32x16_bf16 v[60:75], a[224:227], v[44:47], 0
    v_mfma_f32_32x32x16_bf16 v[60:75], a[228:231], v[48:51], v[60:75]
    v_mfma_f32_32x32x16_bf16 v[60:75], a[232:235], v[52:55], v[60:75]
    s_nop 2
    v_cvt_pk_bf16_f32 v92, v76, v77
    v_cvt_pk_bf16_f32 v93, v78, v79
    v_cvt_pk_bf16_f32 v94, v80, v81
    v_cvt_pk_bf16_f32 v95, v82, v83
    s_add_u32 s72, s68, 1441792
    buffer_store_dwordx4 v[92:95], v4, s[44:47], s72 offen
    v_mfma_f32_32x32x16_bf16 v[60:75], a[236:239], v[56:59], v[60:75]
    v_cvt_pk_bf16_f32 v96, v84, v85
    v_cvt_pk_bf16_f32 v97, v86, v87
    v_cvt_pk_bf16_f32 v98, v88, v89
    v_cvt_pk_bf16_f32 v99, v90, v91
    s_add_u32 s73, s68, 1474560
    buffer_store_dwordx4 v[96:99], v4, s[44:47], s73 offen
    v_mfma_f32_32x32x16_bf16 v[76:91], a[240:243], v[44:47], 0
    v_mfma_f32_32x32x16_bf16 v[76:91], a[244:247], v[48:51], v[76:91]
    v_mfma_f32_32x32x16_bf16 v[76:91], a[248:251], v[52:55], v[76:91]
    s_nop 2
    v_cvt_pk_bf16_f32 v92, v60, v61
    v_cvt_pk_bf16_f32 v93, v62, v63
    v_cvt_pk_bf16_f32 v94, v64, v65
    v_cvt_pk_bf16_f32 v95, v66, v67
    s_add_u32 s72, s68, 1507328
    buffer_store_dwordx4 v[92:95], v4, s[44:47], s72 offen
    v_mfma_f32_32x32x16_bf16 v[76:91], a[252:255], v[56:59], v[76:91]
    v_cvt_pk_bf16_f32 v96, v68, v69
    v_cvt_pk_bf16_f32 v97, v70, v71
    v_cvt_pk_bf16_f32 v98, v72, v73
    v_cvt_pk_bf16_f32 v99, v74, v75
    s_add_u32 s73, s68, 1540096
    buffer_store_dwordx4 v[96:99], v4, s[44:47], s73 offen
    s_nop 11
    v_cvt_pk_bf16_f32 v92, v76, v77
    v_cvt_pk_bf16_f32 v93, v78, v79
    v_cvt_pk_bf16_f32 v94, v80, v81
    v_cvt_pk_bf16_f32 v95, v82, v83
    s_add_u32 s72, s68, 1572864
    buffer_store_dwordx4 v[92:95], v4, s[44:47], s72 offen
    v_cvt_pk_bf16_f32 v96, v84, v85
    v_cvt_pk_bf16_f32 v97, v86, v87
    v_cvt_pk_bf16_f32 v98, v88, v89
    v_cvt_pk_bf16_f32 v99, v90, v91
    s_add_u32 s73, s68, 1605632
    buffer_store_dwordx4 v[96:99], v4, s[44:47], s73 offen
    s_branch L_po_ffn_done
L_po_noffn:
L_po_ffn_done:
    s_waitcnt vmcnt(0)
    s_barrier
    s_cmp_lg_u32 s3, 0
    s_cbranch_scc1 L_fs_13
    s_lshl_b32 s72, s65, 2
    s_add_u32 s72, s72, s69
    s_add_u32 s72, s72, 256
    v_mov_b32 v40, s67
    v_mov_b32 v41, 0
    s_mov_b64 exec, 1
    buffer_store_dword v40, v41, s[44:47], s72 offen
    s_mov_b64 exec, -1
L_fs_13:
    v_lshrrev_b32 v41, 2, v0
    v_mov_b32 v42, 0x7fffff00
    v_cmp_gt_u32 vcc, 112, v41
    s_add_u32 s72, s69, 256
    s_nop 0
    v_cndmask_b32 v41, v42, v41, vcc
    s_mov_b64 s[6:7], vcc
    s_mov_b32 s12, 0
L_fw_14:
    buffer_load_dword v42, v41, s[44:47], s72 offen sc1
    s_waitcnt vmcnt(0)
    v_cmp_gt_u32 vcc, s67, v42
    s_add_u32 s12, s12, 1
    s_and_b64 vcc, vcc, s[6:7]
    s_cmp_gt_u32 s12, 100000
    s_cbranch_scc1 L_fw_14_out
    s_cbranch_vccnz L_fw_14
L_fw_14_out:
    s_add_u32 s72, s68, 1310720
    s_add_u32 s73, s72, 4096
    buffer_load_dwordx4 v[44:47], v5, s[44:47], s72 offen offset:0 sc1
    buffer_load_dwordx4 v[48:51], v5, s[44:47], s72 offen offset:1024 sc1
    buffer_load_dwordx4 v[52:55], v5, s[44:47], s72 offen offset:2048 sc1
    buffer_load_dwordx4 v[56:59], v5, s[44:47], s72 offen offset:3072 sc1
    buffer_load_dwordx4 v[60:63], v5, s[44:47], s73 offen offset:0 sc1
    buffer_load_dwordx4 v[64:67], v5, s[44:47], s73 offen offset:1024 sc1
    buffer_load_dwordx4 v[68:71], v5, s[44:47], s73 offen offset:2048 sc1
    s_waitcnt vmcnt(6)
    v_mfma_f32_16x16x32_bf16 v[104:107], v[10:13], v[44:47], 0
    s_waitcnt vmcnt(5)
    v_mfma_f32_16x16x32_bf16 v[104:107], v[10:13], v[48:51], v[104:107]
    s_waitcnt vmcnt(4)
    v_mfma_f32_16x16x32_bf16 v[104:107], v[10:13], v[52:55], v[104:107]
    s_waitcnt vmcnt(3)
    v_mfma_f32_16x16x32_bf16 v[104:107], v[10:13], v[56:59], v[104:107]
    s_waitcnt vmcnt(2)
    v_mfma_f32_16x16x32_bf16 v[104:107], v[10:13], v[60:63], v[104:107]
    s_waitcnt vmcnt(1)
    v_mfma_f32_16x16x32_bf16 v[104:107], v[10:13], v[64:67], v[104:107]
    s_waitcnt vmcnt(0)
    v_mfma_f32_16x16x32_bf16 v[104:107], v[10:13], v[68:71], v[104:107]
    s_nop 7
    v_add_f32 v76, v30, v104
    v_add_f32 v77, v31, v105
    v_add_f32 v78, v32, v106
    v_add_f32 v79, v33, v107
    v_cvt_pk_bf16_f32 v80, v76, v77
    v_cvt_pk_bf16_f32 v81, v78, v79
    s_mul_i32 s72, s66, 40960
    buffer_store_dwordx2 v[80:81], v8, s[52:55], s72 offen
    s_cmp_lg_u32 s3, 0
    s_cbranch_scc1 L_po_r2done
    s_add_u32 s72, s68, 1343488
    s_add_u32 s73, s72, 4096
    buffer_load_dwordx4 v[44:47], v5, s[44:47], s72 offen offset:0 sc1
    buffer_load_dwordx4 v[48:51], v5, s[44:47], s72 offen offset:1024 sc1
    buffer_load_dwordx4 v[52:55], v5, s[44:47], s72 offen offset:2048 sc1
    buffer_load_dwordx4 v[56:59], v5, s[44:47], s72 offen offset:3072 sc1
    buffer_load_dwordx4 v[60:63], v5, s[44:47], s73 offen offset:0 sc1
    buffer_load_dwordx4 v[64:67], v5, s[44:47], s73 offen offset:1024 sc1
    buffer_load_dwordx4 v[68:71], v5, s[44:47], s73 offen offset:2048 sc1
    s_waitcnt vmcnt(6)
    v_mfma_f32_16x16x32_bf16 v[104:107], v[10:13], v[44:47], 0
    s_waitcnt vmcnt(5)
    v_mfma_f32_16x16x32_bf16 v[104:107], v[10:13], v[48:51], v[104:107]
    s_waitcnt vmcnt(4)
    v_mfma_f32_16x16x32_bf16 v[104:107], v[10:13], v[52:55], v[104:107]
    s_waitcnt vmcnt(3)
    v_mfma_f32_16x16x32_bf16 v[104:107], v[10:13], v[56:59], v[104:107]
    s_waitcnt vmcnt(2)
    v_mfma_f32_16x16x32_bf16 v[104:107], v[10:13], v[60:63], v[104:107]
    s_waitcnt vmcnt(1)
    v_mfma_f32_16x16x32_bf16 v[104:107], v[10:13], v[64:67], v[104:107]
    s_waitcnt vmcnt(0)
    v_mfma_f32_16x16x32_bf16 v[104:107], v[10:13], v[68:71], v[104:107]
    s_nop 7
    v_add_f32 v76, v34, v104
    v_add_f32 v77, v35, v105
    v_add_f32 v78, v36, v106
    v_add_f32 v79, v37, v107
    v_cvt_pk_bf16_f32 v80, v76, v77
    v_cvt_pk_bf16_f32 v81, v78, v79
    s_mul_i32 s72, s66, 40960
    buffer_store_dwordx2 v[80:81], v9, s[52:55], s72 offen
L_po_r2done:
    s_xor_b32 s78, s78, 24576
    s_add_u32 s66, s66, 4
    s_add_u32 s67, s67, 1
    s_waitcnt vmcnt(0)
    s_barrier
    s_cmp_lt_u32 s66, 64
    s_cbranch_scc1 L_po_loop
    s_branch L_po_fin
L_mode1_17:
L_po_loop_f:
    s_and_b32 s61, s67, 1
    s_lshl_b32 s72, s66, 17
    s_lshl_b32 s73, s65, 12
    s_add_u32 s72, s72, s73
    s_add_u32 s72, s72, 0x600000
    s_mov_b32 s12, 0
L_po_km_f:
    buffer_load_dwordx4 v[44:47], v38, s[44:47], s72 offen sc1
    s_waitcnt vmcnt(0)
    v_max_u32 v48, v45, v47
    v_cmp_eq_u32 vcc, -1, v48
    s_add_u32 s12, s12, 1
    s_cmp_gt_u32 s12, 100000
    s_cbranch_scc1 L_po_km_out_f
    s_cbranch_vccz L_po_km_out_f
    s_sleep 2
    s_branch L_po_km_f
L_po_km_out_f:
    v_add_u32 v48, 49152, v38
    ds_write_b128 v48, v[44:47]
    s_mul_i32 s72, s66, 40960
    buffer_load_dwordx2 v[100:101], v8, s[48:51], s72 offen
    buffer_load_dwordx2 v[102:103], v9, s[48:51], s72 offen
    s_waitcnt lgkmcnt(0)
    s_barrier
    v_add_u32 v108, s78, v0
    s_lshl_b32 s72, s70, 10
    v_add_u32 v109, s72, v108
    ds_read_b128 v[44:47], v109 offset:0
    ds_read_b128 v[52:55], v108 offset:8192
    ds_read_b128 v[56:59], v108 offset:9216
    ds_read_b64_tr_b16 v[48:49], v1 offset:0
    ds_read_b64_tr_b16 v[50:51], v1 offset:128
    ds_read_b128 v[60:63], v109 offset:2048
    ds_read_b128 v[68:71], v108 offset:10240
    ds_read_b128 v[72:75], v108 offset:11264
    ds_read_b64_tr_b16 v[64:65], v1 offset:512
    ds_read_b64_tr_b16 v[66:67], v1 offset:640
    s_waitcnt lgkmcnt(5)
    v_mfma_f32_16x16x32_bf16 v[76:79], v[52:55], v[44:47], 0
    v_mfma_f32_16x16x32_bf16 v[80:83], v[56:59], v[44:47], 0
    v_mfma_f32_16x16x32_bf16 v[84:87], v[48:51], v[44:47], 0
    ds_read_b128 v[44:47], v109 offset:4096
    ds_read_b128 v[52:55], v108 offset:12288
    ds_read_b128 v[56:59], v108 offset:13312
    ds_read_b64_tr_b16 v[48:49], v1 offset:1024
    ds_read_b64_tr_b16 v[50:51], v1 offset:1152
    s_waitcnt lgkmcnt(5)
    v_mfma_f32_16x16x32_bf16 v[76:79], v[68:71], v[60:63], v[76:79]
    v_mfma_f32_16x16x32_bf16 v[80:83], v[72:75], v[60:63], v[80:83]
    v_mfma_f32_16x16x32_bf16 v[84:87], v[64:67], v[60:63], v[84:87]
    ds_read_b128 v[60:63], v109 offset:6144
    ds_read_b128 v[68:71], v108 offset:14336
    ds_read_b128 v[72:75], v108 offset:15360
    ds_read_b64_tr_b16 v[64:65], v1 offset:1536
    ds_read_b64_tr_b16 v[66:67], v1 offset:1664
    s_waitcnt lgkmcnt(5)
    v_mfma_f32_16x16x32_bf16 v[76:79], v[52:55], v[44:47], v[76:79]
    v_mfma_f32_16x16x32_bf16 v[80:83], v[56:59], v[44:47], v[80:83]
    v_mfma_f32_16x16x32_bf16 v[84:87], v[48:51], v[44:47], v[84:87]
    s_waitcnt lgkmcnt(0)
    v_mfma_f32_16x16x32_bf16 v[76:79], v[68:71], v[60:63], v[76:79]
    v_mfma_f32_16x16x32_bf16 v[80:83], v[72:75], v[60:63], v[80:83]
    v_mfma_f32_16x16x32_bf16 v[84:87], v[64:67], v[60:63], v[84:87]
    s_lshl_b32 s72, s71, 12
    v_add_u32 v109, s72, v108
    ds_read_b128 v[44:47], v109 offset:16384
    ds_read_b64 v[60:61], v2 offset:0
    ds_read_b128 v[48:51], v109 offset:17408
    ds_read_b64 v[62:63], v2 offset:256
    ds_read_b128 v[52:55], v109 offset:18432
    ds_read_b64 v[64:65], v2 offset:512
    ds_read_b128 v[56:59], v109 offset:19456
    ds_read_b64 v[66:67], v2 offset:768
    s_nop 3
    v_mov_b32 v88, s13
    v_cndmask_b32 v76, v88, v76, s[80:81]
    v_cndmask_b32 v80, v88, v80, s[88:89]
    v_cndmask_b32 v77, v88, v77, s[82:83]
    v_cndmask_b32 v81, v88, v81, s[90:91]
    v_cndmask_b32 v78, v88, v78, s[84:85]
    v_cndmask_b32 v82, v88, v82, s[92:93]
    v_cndmask_b32 v79, v88, v79, s[86:87]
    v_cndmask_b32 v83, v88, v83, s[94:95]
    v_max3_f32 v88, v76, v77, v78
    v_max3_f32 v89, v79, v80, v81
    v_max3_f32 v90, v82, v83, v84
    v_max3_f32 v91, v85, v86, v87
    v_max3_f32 v88, v88, v89, v90
    v_max_f32 v88, v88, v91
    v_mov_b32 v89, v88
    s_nop 1
    v_permlane16_swap_b32 v88, v89
    v_max_f32 v88, v88, v89
    v_mov_b32 v89, v88
    s_nop 1
    v_permlane32_swap_b32 v88, v89
    v_max_f32 v88, v88, v89
    v_mul_f32 v89, s75, v88
    v_fma_f32 v76, v76, s75, -v89
    v_fma_f32 v77, v77, s75, -v89
    v_fma_f32 v78, v78, s75, -v89
    v_fma_f32 v79, v79, s75, -v89
    v_fma_f32 v80, v80, s75, -v89
    v_fma_f32 v81, v81, s75, -v89
    v_fma_f32 v82, v82, s75, -v89
    v_fma_f32 v83, v83, s75, -v89
    v_fma_f32 v84, v84, s75, -v89
    v_fma_f32 v85, v85, s75, -v89
    v_fma_f32 v86, v86, s75, -v89
    v_fma_f32 v87, v87, s75, -v89
    v_exp_f32 v76, v76
    v_exp_f32 v77, v77
    v_exp_f32 v78, v78
    v_exp_f32 v79, v79
    v_exp_f32 v80, v80
    v_exp_f32 v81, v81
    v_exp_f32 v82, v82
    v_exp_f32 v83, v83
    v_exp_f32 v84, v84
    v_exp_f32 v85, v85
    v_exp_f32 v86, v86
    v_exp_f32 v87, v87
    s_nop 0
    v_cvt_pk_bf16_f32 v68, v76, v77
    v_cvt_pk_bf16_f32 v69, v78, v79
    v_cvt_pk_bf16_f32 v70, v80, v81
    v_cvt_pk_bf16_f32 v71, v82, v83
    v_cvt_pk_bf16_f32 v72, v84, v85
    v_cvt_pk_bf16_f32 v73, v86, v87
    v_cndmask_b32 v72, 0, v72, s[96:97]
    v_cndmask_b32 v73, 0, v73, s[96:97]
    v_mov_b32 v92, 0x3f803f80
    v_mov_b32 v93, 0x3f803f80
    v_mov_b32 v94, 0x3f803f80
    v_mov_b32 v95, 0x3f803f80
    s_waitcnt lgkmcnt(0)
    s_nop 0
    v_mfma_f32_16x16x32_bf16 v[96:99], v[92:95], v[68:71], 0
    v_mfma_f32_16x16x32_bf16 v[76:79], v[44:47], v[68:71], 0
    v_mfma_f32_16x16x32_bf16 v[80:83], v[48:51], v[68:71], 0
    v_mfma_f32_16x16x32_bf16 v[84:87], v[52:55], v[68:71], 0
    v_mfma_f32_16x16x32_bf16 v[88:91], v[56:59], v[68:71], 0
    v_mfma_f32_16x16x16_bf16 v[96:99], v[92:93], v[72:73], v[96:99]
    v_mfma_f32_16x16x16_bf16 v[76:79], v[60:61], v[72:73], v[76:79]
    v_mfma_f32_16x16x16_bf16 v[80:83], v[62:63], v[72:73], v[80:83]
    v_mfma_f32_16x16x16_bf16 v[84:87], v[64:65], v[72:73], v[84:87]
    v_mfma_f32_16x16x16_bf16 v[88:91], v[66:67], v[72:73], v[88:91]
    s_nop 3
    v_rcp_f32 v96, v96
    s_nop 3
    v_mul_f32 v76, v76, v96
    v_mul_f32 v77, v77, v96
    v_mul_f32 v78, v78, v96
    v_mul_f32 v79, v79, v96
    v_mul_f32 v80, v80, v96
    v_mul_f32 v81, v81, v96
    v_mul_f32 v82, v82, v96
    v_mul_f32 v83, v83, v96
    v_mul_f32 v84, v84, v96
    v_mul_f32 v85, v85, v96
    v_mul_f32 v86, v86, v96
    v_mul_f32 v87, v87, v96
    v_mul_f32 v88, v88, v96
    v_mul_f32 v89, v89, v96
    v_mul_f32 v90, v90, v96
    v_mul_f32 v91, v91, v96
    v_cvt_pk_bf16_f32 v44, v76, v77
    v_cvt_pk_bf16_f32 v45, v78, v79
    v_cvt_pk_bf16_f32 v46, v80, v81
    v_cvt_pk_bf16_f32 v47, v82, v83
    v_cvt_pk_bf16_f32 v48, v84, v85
    v_cvt_pk_bf16_f32 v49, v86, v87
    v_cvt_pk_bf16_f32 v50, v88, v89
    v_cvt_pk_bf16_f32 v51, v90, v91
    ds_write_b128 v3, v[44:47]
    ds_write_b128 v3, v[48:51] offset:2048
    s_waitcnt lgkmcnt(0)
    s_barrier
    s_add_u32 s14, s66, 4
    s_min_u32 s14, s14, 63
    s_xor_b32 s15, s78, 24576
    s_cmp_lt_u32 s14, s77
    s_cbranch_scc1 L_qr_6_out_f
    s_mov_b32 s12, 0
L_qr_6_f:
    v_mov_b32 v44, 0
    buffer_load_dwordx4 v[44:47], v44, s[44:47], s76 offen sc1
    s_waitcnt vmcnt(0)
    v_min3_u32 v44, v44, v45, v46
    s_nop 0
    v_readfirstlane_b32 s77, v44
    s_add_u32 s12, s12, 1
    s_cmp_lt_u32 s14, s77
    s_cbranch_scc1 L_qr_6_out_f
    s_sleep 4
    s_cmp_lt_u32 s12, 100000
    s_cbranch_scc1 L_qr_6_f
L_qr_6_out_f:
    s_lshl_b32 s72, s14, 18
    s_lshl_b32 s73, s65, 13
    s_add_u32 s72, s72, s73
    s_lshl_b32 s73, s3, 11
    s_add_u32 s72, s72, s73
    s_add_u32 s73, s73, s15
    s_add_u32 s74, s72, 0x1000000
    s_add_u32 s6, s73, 0
    s_mov_b32 m0, s6
    s_nop 0
    buffer_load_dwordx4 v0, s[44:47], s74 offen offset:0 sc1 lds
    s_add_u32 s74, s74, 1024
    s_add_u32 s6, s73, 1024
    s_mov_b32 m0, s6
    s_nop 0
    buffer_load_dwordx4 v0, s[44:47], s74 offen offset:0 sc1 lds
    s_add_u32 s74, s72, 0x2000000
    s_add_u32 s6, s73, 8192
    s_mov_b32 m0, s6
    s_nop 0
    buffer_load_dwordx4 v0, s[44:47], s74 offen offset:0 sc1 lds
    s_add_u32 s74, s74, 1024
    s_add_u32 s6, s73, 9216
    s_mov_b32 m0, s6
    s_nop 0
    buffer_load_dwordx4 v0, s[44:47], s74 offen offset:0 sc1 lds
    s_add_u32 s74, s72, 0x3000000
    s_add_u32 s6, s73, 16384
    s_mov_b32 m0, s6
    s_nop 0
    buffer_load_dwordx4 v0, s[44:47], s74 offen offset:0 sc1 lds
    s_add_u32 s74, s74, 1024
    s_add_u32 s6, s73, 17408
    s_mov_b32 m0, s6
    s_nop 0
    buffer_load_dwordx4 v0, s[44:47], s74 offen offset:0 sc1 lds
    ds_read_b128 v[44:47], v0 offset:53248
    ds_read_b128 v[48:51], v0 offset:54272
    ds_read_b128 v[52:55], v0 offset:55296
    ds_read_b128 v[56:59], v0 offset:56320
    s_waitcnt lgkmcnt(3)
    v_mfma_f32_32x32x16_bf16 v[76:91], v[112:115], v[44:47], 0
    ds_read_b128 v[44:47], v0 offset:57344
    s_waitcnt lgkmcnt(3)
    v_mfma_f32_32x32x16_bf16 v[76:91], v[116:119], v[48:51], v[76:91]
    ds_read_b128 v[48:51], v0 offset:58368
    s_waitcnt lgkmcnt(3)
    v_mfma_f32_32x32x16_bf16 v[76:91], v[120:123], v[52:55], v[76:91]
    ds_read_b128 v[52:55], v0 offset:59392
    s_waitcnt lgkmcnt(3)
    v_mfma_f32_32x32x16_bf16 v[76:91], v[124:127], v[56:59], v[76:91]
    ds_read_b128 v[56:59], v0 offset:60416
    s_waitcnt lgkmcnt(3)
    v_mfma_f32_32x32x16_bf16 v[76:91], v[128:131], v[44:47], v[76:91]
    ds_read_b128 v[44:47], v0 offset:53248
    s_waitcnt lgkmcnt(3)
    v_mfma_f32_32x32x16_bf16 v[76:91], v[132:135], v[48:51], v[76:91]
    ds_read_b128 v[48:51], v0 offset:54272
    s_waitcnt lgkmcnt(3)
    v_mfma_f32_32x32x16_bf16 v[76:91], v[136:139], v[52:55], v[76:91]
    ds_read_b128 v[52:55], v0 offset:55296
    s_waitcnt lgkmcnt(3)
    v_mfma_f32_32x32x16_bf16 v[76:91], v[140:143], v[56:59], v[76:91]
    ds_read_b128 v[56:59], v0 offset:56320
    s_waitcnt lgkmcnt(3)
    v_mfma_f32_32x32x16_bf16 v[60:75], v[144:147], v[44:47], 0
    ds_read_b128 v[44:47], v0 offset:57344
    s_waitcnt lgkmcnt(3)
    v_mfma_f32_32x32x16_bf16 v[60:75], v[148:151], v[48:51], v[60:75]
    ds_read_b128 v[48:51], v0 offset:58368
    s_waitcnt lgkmcnt(3)
    v_mfma_f32_32x32x16_bf16 v[60:75], v[152:155], v[52:55], v[60:75]
    ds_read_b128 v[52:55], v0 offset:59392
    s_waitcnt lgkmcnt(3)
    v_mfma_f32_32x32x16_bf16 v[60:75], v[156:159], v[56:59], v[60:75]
    v_cvt_pk_bf16_f32 v92, v76, v77
    v_cvt_pk_bf16_f32 v93, v78, v79
    ds_read_b128 v[56:59], v0 offset:60416
    s_waitcnt lgkmcnt(3)
    v_mfma_f32_32x32x16_bf16 v[60:75], v[160:163], v[44:47], v[60:75]
    v_cvt_pk_bf16_f32 v94, v80, v81
    v_cvt_pk_bf16_f32 v95, v82, v83
    s_add_u32 s72, s68, 0
    buffer_store_dwordx4 v[92:95], v4, s[44:47], s72 offen sc1
    ds_read_b128 v[44:47], v0 offset:53248
    s_waitcnt lgkmcnt(3)
    v_mfma_f32_32x32x16_bf16 v[60:75], v[164:167], v[48:51], v[60:75]
    v_cvt_pk_bf16_f32 v96, v84, v85
    v_cvt_pk_bf16_f32 v97, v86, v87
    ds_read_b128 v[48:51], v0 offset:54272
    s_waitcnt lgkmcnt(3)
    v_mfma_f32_32x32x16_bf16 v[60:75], v[168:171], v[52:55], v[60:75]
    v_cvt_pk_bf16_f32 v98, v88, v89
    v_cvt_pk_bf16_f32 v99, v90, v91
    s_add_u32 s73, s68, 32768
    buffer_store_dwordx4 v[96:99], v4, s[44:47], s73 offen sc1
    ds_read_b128 v[52:55], v0 offset:55296
    s_waitcnt lgkmcnt(3)
    v_mfma_f32_32x32x16_bf16 v[60:75], v[172:175], v[56:59], v[60:75]
    ds_read_b128 v[56:59], v0 offset:56320
    s_waitcnt lgkmcnt(3)
    v_mfma_f32_32x32x16_bf16 v[76:91], v[176:179], v[44:47], 0
    ds_read_b128 v[44:47], v0 offset:57344
    s_waitcnt lgkmcnt(3)
    v_mfma_f32_32x32x16_bf16 v[76:91], v[180:183], v[48:51], v[76:91]
    ds_read_b128 v[48:51], v0 offset:58368
    s_waitcnt lgkmcnt(3)
    v_mfma_f32_32x32x16_bf16 v[76:91], v[184:187], v[52:55], v[76:91]
    ds_read_b128 v[52:55], v0 offset:59392
    s_waitcnt lgkmcnt(3)
    v_mfma_f32_32x32x16_bf16 v[76:91], v[188:191], v[56:59], v[76:91]
    v_cvt_pk_bf16_f32 v92, v60, v61
    v_cvt_pk_bf16_f32 v93, v62, v63
    ds_read_b128 v[56:59], v0 offset:60416
    s_waitcnt lgkmcnt(3)
    v_mfma_f32_32x32x16_bf16 v[76:91], v[192:195], v[44:47], v[76:91]
    v_cvt_pk_bf16_f32 v94, v64, v65
    v_cvt_pk_bf16_f32 v95, v66, v67
    s_add_u32 s72, s68, 65536
    buffer_store_dwordx4 v[92:95], v4, s[44:47], s72 offen sc1
    ds_read_b128 v[44:47], v0 offset:53248
    s_waitcnt lgkmcnt(3)
    v_mfma_f32_32x32x16_bf16 v[76:91], v[196:199], v[48:51], v[76:91]
    v_cvt_pk_bf16_f32 v96, v68, v69
    v_cvt_pk_bf16_f32 v97, v70, v71
    ds_read_b128 v[48:51], v0 offset:54272
    s_waitcnt lgkmcnt(3)
    v_mfma_f32_32x32x16_bf16 v[76:91], v[200:203], v[52:55], v[76:91]
    v_cvt_pk_bf16_f32 v98, v72, v73
    v_cvt_pk_bf16_f32 v99, v74, v75
    s_add_u32 s73, s68, 98304
    buffer_store_dwordx4 v[96:99], v4, s[44:47], s73 offen sc1
    ds_read_b128 v[52:55], v0 offset:55296
    s_waitcnt lgkmcnt(3)
    v_mfma_f32_32x32x16_bf16 v[76:91], v[204:207], v[56:59], v[76:91]
    ds_read_b128 v[56:59], v0 offset:56320
    s_waitcnt lgkmcnt(3)
    v_mfma_f32_32x32x16_bf16 v[60:75], v[208:211], v[44:47], 0
    ds_read_b128 v[44:47], v0 offset:57344
    s_waitcnt lgkmcnt(3)
    v_mfma_f32_32x32x16_bf16 v[60:75], v[212:215], v[48:51], v[60:75]
    ds_read_b128 v[48:51], v0 offset:58368
    s_waitcnt lgkmcnt(3)
    v_mfma_f32_32x32x16_bf16 v[60:75], v[216:219], v[52:55], v[60:75]
    ds_read_b128 v[52:55], v0 offset:59392
    s_waitcnt lgkmcnt(3)
    v_mfma_f32_32x32x16_bf16 v[60:75], v[220:223], v[56:59], v[60:75]
    v_cvt_pk_bf16_f32 v92, v76, v77
    v_cvt_pk_bf16_f32 v93, v78, v79
    ds_read_b128 v[56:59], v0 offset:60416
    s_waitcnt lgkmcnt(3)
    v_mfma_f32_32x32x16_bf16 v[60:75], v[224:227], v[44:47], v[60:75]
    v_cvt_pk_bf16_f32 v94, v80, v81
    v_cvt_pk_bf16_f32 v95, v82, v83
    s_add_u32 s72, s68, 131072
    buffer_store_dwordx4 v[92:95], v4, s[44:47], s72 offen sc1
    ds_read_b128 v[44:47], v0 offset:53248
    s_waitcnt lgkmcnt(3)
    v_mfma_f32_32x32x16_bf16 v[60:75], v[228:231], v[48:51], v[60:75]
    v_cvt_pk_bf16_f32 v96, v84, v85
    v_cvt_pk_bf16_f32 v97, v86, v87
    ds_read_b128 v[48:51], v0 offset:54272
    s_waitcnt lgkmcnt(3)
    v_mfma_f32_32x32x16_bf16 v[60:75], v[232:235], v[52:55], v[60:75]
    v_cvt_pk_bf16_f32 v98, v88, v89
    v_cvt_pk_bf16_f32 v99, v90, v91
    s_add_u32 s73, s68, 163840
    buffer_store_dwordx4 v[96:99], v4, s[44:47], s73 offen sc1
    ds_read_b128 v[52:55], v0 offset:55296
    s_waitcnt lgkmcnt(3)
    v_mfma_f32_32x32x16_bf16 v[60:75], v[236:239], v[56:59], v[60:75]
    ds_read_b128 v[56:59], v0 offset:56320
    s_waitcnt lgkmcnt(3)
    v_mfma_f32_32x32x16_bf16 v[76:91], v[240:243], v[44:47], 0
    ds_read_b128 v[44:47], v0 offset:57344
    s_waitcnt lgkmcnt(3)
    v_mfma_f32_32x32x16_bf16 v[76:91], v[244:247], v[48:51], v[76:91]
    ds_read_b128 v[48:51], v0 offset:58368
    s_waitcnt lgkmcnt(3)
    v_mfma_f32_32x32x16_bf16 v[76:91], v[248:251], v[52:55], v[76:91]
    ds_read_b128 v[52:55], v0 offset:59392
    s_waitcnt lgkmcnt(3)
    v_mfma_f32_32x32x16_bf16 v[76:91], v[252:255], v[56:59], v[76:91]
    v_cvt_pk_bf16_f32 v92, v60, v61
    v_cvt_pk_bf16_f32 v93, v62, v63
    ds_read_b128 v[56:59], v0 offset:60416
    s_waitcnt lgkmcnt(3)
    v_mfma_f32_32x32x16_bf16 v[76:91], a[0:3], v[44:47], v[76:91]
    v_cvt_pk_bf16_f32 v94, v64, v65
    v_cvt_pk_bf16_f32 v95, v66, v67
    s_add_u32 s72, s68, 196608
    buffer_store_dwordx4 v[92:95], v4, s[44:47], s72 offen sc1
    s_waitcnt lgkmcnt(2)
    v_mfma_f32_32x32x16_bf16 v[76:91], a[4:7], v[48:51], v[76:91]
    v_cvt_pk_bf16_f32 v96, v68, v69
    v_cvt_pk_bf16_f32 v97, v70, v71
    s_waitcnt lgkmcnt(1)
    v_mfma_f32_32x32x16_bf16 v[76:91], a[8:11], v[52:55], v[76:91]
    v_cvt_pk_bf16_f32 v98, v72, v73
    v_cvt_pk_bf16_f32 v99, v74, v75
    s_add_u32 s73, s68, 229376
    buffer_store_dwordx4 v[96:99], v4, s[44:47], s73 offen sc1
    s_waitcnt lgkmcnt(0)
    v_mfma_f32_32x32x16_bf16 v[76:91], a[12:15], v[56:59], v[76:91]
    s_nop 11
    v_cvt_pk_bf16_f32 v92, v76, v77
    v_cvt_pk_bf16_f32 v93, v78, v79
    v_cvt_pk_bf16_f32 v94, v80, v81
    v_cvt_pk_bf16_f32 v95, v82, v83
    s_add_u32 s72, s68, 262144
    buffer_store_dwordx4 v[92:95], v4, s[44:47], s72 offen sc1
    v_cvt_pk_bf16_f32 v96, v84, v85
    v_cvt_pk_bf16_f32 v97, v86, v87
    v_cvt_pk_bf16_f32 v98, v88, v89
    v_cvt_pk_bf16_f32 v99, v90, v91
    s_add_u32 s73, s68, 294912
    buffer_store_dwordx4 v[96:99], v4, s[44:47], s73 offen sc1
    s_waitcnt vmcnt(0)
    s_barrier
    s_cmp_lg_u32 s3, 0
    s_cbranch_scc1 L_fs_7_f
    s_lshl_b32 s72, s65, 2
    s_add_u32 s72, s72, s69
    s_add_u32 s72, s72, 0
    v_mov_b32 v40, s67
    v_mov_b32 v41, 0
    s_mov_b64 exec, 1
    buffer_store_dword v40, v41, s[44:47], s72 offen sc1
    s_mov_b64 exec, -1
L_fs_7_f:
    v_lshrrev_b32 v41, 2, v0
    v_mov_b32 v42, 0x7fffff00
    v_cmp_gt_u32 vcc, 128, v41
    s_add_u32 s72, s69, 0
    s_nop 0
    v_cndmask_b32 v41, v42, v41, vcc
    s_mov_b64 s[6:7], vcc
    s_mov_b32 s12, 0
L_fw_8_f:
    buffer_load_dword v42, v41, s[44:47], s72 offen sc1
    s_waitcnt vmcnt(0)
    v_cmp_gt_u32 vcc, s67, v42
    s_add_u32 s12, s12, 1
    s_and_b64 vcc, vcc, s[6:7]
    s_cmp_gt_u32 s12, 100000
    s_cbranch_scc1 L_fw_8_out_f
    s_cbranch_vccnz L_fw_8_f
L_fw_8_out_f:
    s_add_u32 s72, s68, 0
    s_add_u32 s73, s72, 4096
    buffer_load_dwordx4 v[44:47], v5, s[44:47], s72 offen offset:0 sc1
    buffer_load_dwordx4 v[48:51], v5, s[44:47], s72 offen offset:1024 sc1
    buffer_load_dwordx4 v[52:55], v5, s[44:47], s72 offen offset:2048 sc1
    buffer_load_dwordx4 v[56:59], v5, s[44:47], s72 offen offset:3072 sc1
    buffer_load_dwordx4 v[60:63], v5, s[44:47], s73 offen offset:0 sc1
    buffer_load_dwordx4 v[64:67], v5, s[44:47], s73 offen offset:1024 sc1
    buffer_load_dwordx4 v[68:71], v5, s[44:47], s73 offen offset:2048 sc1
    buffer_load_dwordx4 v[72:75], v5, s[44:47], s73 offen offset:3072 sc1
    s_waitcnt vmcnt(7)
    v_mfma_f32_16x16x32_bf16 v[104:107], v[10:13], v[44:47], 0
    s_waitcnt vmcnt(6)
    v_mfma_f32_16x16x32_bf16 v[104:107], v[10:13], v[48:51], v[104:107]
    s_waitcnt vmcnt(5)
    v_mfma_f32_16x16x32_bf16 v[104:107], v[10:13], v[52:55], v[104:107]
    s_waitcnt vmcnt(4)
    v_mfma_f32_16x16x32_bf16 v[104:107], v[10:13], v[56:59], v[104:107]
    s_waitcnt vmcnt(3)
    v_mfma_f32_16x16x32_bf16 v[104:107], v[10:13], v[60:63], v[104:107]
    s_waitcnt vmcnt(2)
    v_mfma_f32_16x16x32_bf16 v[104:107], v[10:13], v[64:67], v[104:107]
    s_waitcnt vmcnt(1)
    v_mfma_f32_16x16x32_bf16 v[104:107], v[10:13], v[68:71], v[104:107]
    s_waitcnt vmcnt(0)
    v_mfma_f32_16x16x32_bf16 v[104:107], v[10:13], v[72:75], v[104:107]
    s_nop 7
    v_lshlrev_b32 v76, 16, v100
    v_and_b32 v77, 0xffff0000, v100
    v_lshlrev_b32 v78, 16, v101
    v_and_b32 v79, 0xffff0000, v101
    v_add_f32 v76, v76, v104
    v_add_f32 v77, v77, v105
    v_add_f32 v78, v78, v106
    v_add_f32 v79, v79, v107
    v_cvt_pk_bf16_f32 v80, v76, v77
    v_cvt_pk_bf16_f32 v81, v78, v79
    v_lshlrev_b32 v30, 16, v80
    v_and_b32 v31, 0xffff0000, v80
    v_lshlrev_b32 v32, 16, v81
    v_and_b32 v33, 0xffff0000, v81
    s_add_u32 s72, s68, 2621440
    buffer_store_dwordx2 v[80:81], v6, s[44:47], s72 offen sc1
    s_cmp_lg_u32 s3, 0
    s_cbranch_scc1 L_po_r1done_f
    s_add_u32 s72, s68, 32768
    s_add_u32 s73, s72, 4096
    buffer_load_dwordx4 v[44:47], v5, s[44:47], s72 offen offset:0 sc1
    buffer_load_dwordx4 v[48:51], v5, s[44:47], s72 offen offset:1024 sc1
    buffer_load_dwordx4 v[52:55], v5, s[44:47], s72 offen offset:2048 sc1
    buffer_load_dwordx4 v[56:59], v5, s[44:47], s72 offen offset:3072 sc1
    buffer_load_dwordx4 v[60:63], v5, s[44:47], s73 offen offset:0 sc1
    buffer_load_dwordx4 v[64:67], v5, s[44:47], s73 offen offset:1024 sc1
    buffer_load_dwordx4 v[68:71], v5, s[44:47], s73 offen offset:2048 sc1
    buffer_load_dwordx4 v[72:75], v5, s[44:47], s73 offen offset:3072 sc1
    s_waitcnt vmcnt(7)
    v_mfma_f32_16x16x32_bf16 v[104:107], v[10:13], v[44:47], 0
    s_waitcnt vmcnt(6)
    v_mfma_f32_16x16x32_bf16 v[104:107], v[10:13], v[48:51], v[104:107]
    s_waitcnt vmcnt(5)
    v_mfma_f32_16x16x32_bf16 v[104:107], v[10:13], v[52:55], v[104:107]
    s_waitcnt vmcnt(4)
    v_mfma_f32_16x16x32_bf16 v[104:107], v[10:13], v[56:59], v[104:107]
    s_waitcnt vmcnt(3)
    v_mfma_f32_16x16x32_bf16 v[104:107], v[10:13], v[60:63], v[104:107]
    s_waitcnt vmcnt(2)
    v_mfma_f32_16x16x32_bf16 v[104:107], v[10:13], v[64:67], v[104:107]
    s_waitcnt vmcnt(1)
    v_mfma_f32_16x16x32_bf16 v[104:107], v[10:13], v[68:71], v[104:107]
    s_waitcnt vmcnt(0)
    v_mfma_f32_16x16x32_bf16 v[104:107], v[10:13], v[72:75], v[104:107]
    s_nop 7
    v_lshlrev_b32 v76, 16, v102
    v_and_b32 v77, 0xffff0000, v102
    v_lshlrev_b32 v78, 16, v103
    v_and_b32 v79, 0xffff0000, v103
    v_add_f32 v76, v76, v104
    v_add_f32 v77, v77, v105
    v_add_f32 v78, v78, v106
    v_add_f32 v79, v79, v107
    v_cvt_pk_bf16_f32 v80, v76, v77
    v_cvt_pk_bf16_f32 v81, v78, v79
    v_lshlrev_b32 v34, 16, v80
    v_and_b32 v35, 0xffff0000, v80
    v_lshlrev_b32 v36, 16, v81
    v_and_b32 v37, 0xffff0000, v81
    s_add_u32 s72, s68, 2621440
    buffer_store_dwordx2 v[80:81], v7, s[44:47], s72 offen sc1
L_po_r1done_f:
    s_waitcnt vmcnt(0)
    s_barrier
    s_cmp_lg_u32 s3, 0
    s_cbranch_scc1 L_fs_11_f
    s_lshl_b32 s72, s65, 2
    s_add_u32 s72, s72, s69
    s_add_u32 s72, s72, 128
    v_mov_b32 v40, s67
    v_mov_b32 v41, 0
    s_mov_b64 exec, 1
    buffer_store_dword v40, v41, s[44:47], s72 offen sc1
    s_mov_b64 exec, -1
L_fs_11_f:
    v_lshrrev_b32 v41, 2, v0
    v_mov_b32 v42, 0x7fffff00
    v_cmp_gt_u32 vcc, 128, v41
    s_add_u32 s72, s69, 128
    s_nop 0
    v_cndmask_b32 v41, v42, v41, vcc
    s_mov_b64 s[6:7], vcc
    s_mov_b32 s12, 0
L_fw_12_f:
    buffer_load_dword v42, v41, s[44:47], s72 offen sc1
    s_waitcnt vmcnt(0)
    v_cmp_gt_u32 vcc, s67, v42
    s_add_u32 s12, s12, 1
    s_and_b64 vcc, vcc, s[6:7]
    s_cmp_gt_u32 s12, 100000
    s_cbranch_scc1 L_fw_12_out_f
    s_cbranch_vccnz L_fw_12_f
L_fw_12_out_f:
    s_mul_i32 s73, s3, 10240
    s_add_u32 s72, s68, s73
    s_add_u32 s72, s72, 2621440
    s_add_u32 s73, s73, 62464
    s_mov_b32 m0, s73
    s_add_u32 s73, s73, 1024
    buffer_load_dwordx4 v0, s[44:47], s72 offen sc1 lds
    s_add_u32 s72, s72, 1024
    s_mov_b32 m0, s73
    s_add_u32 s73, s73, 1024
    buffer_load_dwordx4 v0, s[44:47], s72 offen sc1 lds
    s_add_u32 s72, s72, 1024
    s_mov_b32 m0, s73
    s_add_u32 s73, s73, 1024
    buffer_load_dwordx4 v0, s[44:47], s72 offen sc1 lds
    s_add_u32 s72, s72, 1024
    s_mov_b32 m0, s73
    s_add_u32 s73, s73, 1024
    buffer_load_dwordx4 v0, s[44:47], s72 offen sc1 lds
    s_add_u32 s72, s72, 1024
    s_mov_b32 m0, s73
    s_add_u32 s73, s73, 1024
    buffer_load_dwordx4 v0, s[44:47], s72 offen sc1 lds
    s_add_u32 s72, s72, 1024
    s_mov_b32 m0, s73
    s_add_u32 s73, s73, 1024
    buffer_load_dwordx4 v0, s[44:47], s72 offen sc1 lds
    s_add_u32 s72, s72, 1024
    s_mov_b32 m0, s73
    s_add_u32 s73, s73, 1024
    buffer_load_dwordx4 v0, s[44:47], s72 offen sc1 lds
    s_add_u32 s72, s72, 1024
    s_mov_b32 m0, s73
    s_add_u32 s73, s73, 1024
    buffer_load_dwordx4 v0, s[44:47], s72 offen sc1 lds
    s_add_u32 s72, s72, 1024
    s_mov_b32 m0, s73
    s_add_u32 s73, s73, 1024
    buffer_load_dwordx4 v0, s[44:47], s72 offen sc1 lds
    s_add_u32 s72, s72, 1024
    s_mov_b32 m0, s73
    s_add_u32 s73, s73, 1024
    buffer_load_dwordx4 v0, s[44:47], s72 offen sc1 lds
    s_add_u32 s72, s72, 1024
    s_waitcnt vmcnt(0)
    s_barrier
    s_cmp_eq_u32 s79, 0
    s_cbranch_scc1 L_po_noffn_f
    v_add_u32 v108, 62464, v0
    v_mov_b32 v92, 0
    v_mov_b32 v93, 0
    v_mov_b32 v94, 0x3f803f80
    ds_read_b128 v[44:47], v108 offset:0
    ds_read_b128 v[48:51], v108 offset:1024
    ds_read_b128 v[52:55], v108 offset:2048
    ds_read_b128 v[56:59], v108 offset:3072
    ds_read_b128 v[60:63], v108 offset:4096
    s_cmp_lg_u32 s3, 0
    s_cbranch_scc1 L_po_f1_1_f
    ds_read_b128 v[64:67], v108 offset:5120
    s_waitcnt lgkmcnt(5)
    v_mfma_f32_32x32x16_bf16 v[76:91], a[16:19], v[44:47], 0
    v_dot2_f32_bf16 v92, v44, v94, v92
    v_dot2_f32_bf16 v93, v44, v44, v93
    v_dot2_f32_bf16 v92, v45, v94, v92
    v_dot2_f32_bf16 v93, v45, v45, v93
    v_dot2_f32_bf16 v92, v46, v94, v92
    v_dot2_f32_bf16 v93, v46, v46, v93
    v_dot2_f32_bf16 v92, v47, v94, v92
    v_dot2_f32_bf16 v93, v47, v47, v93
    ds_read_b128 v[44:47], v108 offset:6144
    s_waitcnt lgkmcnt(5)
    v_mfma_f32_32x32x16_bf16 v[76:91], a[20:23], v[48:51], v[76:91]
    ds_read_b128 v[48:51], v108 offset:7168
    s_waitcnt lgkmcnt(5)
    v_mfma_f32_32x32x16_bf16 v[76:91], a[24:27], v[52:55], v[76:91]
    ds_read_b128 v[52:55], v108 offset:8192
    s_waitcnt lgkmcnt(5)
    v_mfma_f32_32x32x16_bf16 v[76:91], a[28:31], v[56:59], v[76:91]
    ds_read_b128 v[56:59], v108 offset:9216
    s_waitcnt lgkmcnt(5)
    v_mfma_f32_32x32x16_bf16 v[76:91], a[32:35], v[60:63], v[76:91]
    v_dot2_f32_bf16 v92, v60, v94, v92
    v_dot2_f32_bf16 v93, v60, v60, v93
    v_dot2_f32_bf16 v92, v61, v94, v92
    v_dot2_f32_bf16 v93, v61, v61, v93
    v_dot2_f32_bf16 v92, v62, v94, v92
    v_dot2_f32_bf16 v93, v62, v62, v93
    v_dot2_f32_bf16 v92, v63, v94, v92
    v_dot2_f32_bf16 v93, v63, v63, v93
    ds_read_b128 v[60:63], v108 offset:10240
    s_waitcnt lgkmcnt(5)
    v_mfma_f32_32x32x16_bf16 v[76:91], a[36:39], v[64:67], v[76:91]
    ds_read_b128 v[64:67], v108 offset:11264
    s_waitcnt lgkmcnt(5)
    v_mfma_f32_32x32x16_bf16 v[76:91], a[40:43], v[44:47], v[76:91]
    ds_read_b128 v[44:47], v108 offset:12288
    s_waitcnt lgkmcnt(5)
    v_mfma_f32_32x32x16_bf16 v[76:91], a[44:47], v[48:51], v[76:91]
    ds_read_b128 v[48:51], v108 offset:13312
    s_waitcnt lgkmcnt(5)
    v_mfma_f32_32x32x16_bf16 v[76:91], a[48:51], v[52:55], v[76:91]
    v_dot2_f32_bf16 v92, v52, v94, v92
    v_dot2_f32_bf16 v93, v52, v52, v93
    v_dot2_f32_bf16 v92, v53, v94, v92
    v_dot2_f32_bf16 v93, v53, v53, v93
    v_dot2_f32_bf16 v92, v54, v94, v92
    v_dot2_f32_bf16 v93, v54, v54, v93
    v_dot2_f32_bf16 v92, v55, v94, v92
    v_dot2_f32_bf16 v93, v55, v55, v93
    ds_read_b128 v[52:55], v108 offset:14336
    s_waitcnt lgkmcnt(5)
    v_mfma_f32_32x32x16_bf16 v[76:91], a[52:55], v[56:59], v[76:91]
    ds_read_b128 v[56:59], v108 offset:15360
    s_waitcnt lgkmcnt(5)
    v_mfma_f32_32x32x16_bf16 v[76:91], a[56:59], v[60:63], v[76:91]
    ds_read_b128 v[60:63], v108 offset:16384
    s_waitcnt lgkmcnt(5)
    v_mfma_f32_32x32x16_bf16 v[76:91], a[60:63], v[64:67], v[76:91]
    ds_read_b128 v[64:67], v108 offset:17408
    s_waitcnt lgkmcnt(5)
    v_mfma_f32_32x32x16_bf16 v[76:91], a[64:67], v[44:47], v[76:91]
    v_dot2_f32_bf16 v92, v44, v94, v92
    v_dot2_f32_bf16 v93, v44, v44, v93
    v_dot2_f32_bf16 v92, v45, v94, v92
    v_dot2_f32_bf16 v93, v45, v45, v93
    v_dot2_f32_bf16 v92, v46, v94, v92
    v_dot2_f32_bf16 v93, v46, v46, v93
    v_dot2_f32_bf16 v92, v47, v94, v92
    v_dot2_f32_bf16 v93, v47, v47, v93
    ds_read_b128 v[44:47], v108 offset:18432
    s_waitcnt lgkmcnt(5)
    v_mfma_f32_32x32x16_bf16 v[76:91], a[68:71], v[48:51], v[76:91]
    ds_read_b128 v[48:51], v108 offset:19456
    s_waitcnt lgkmcnt(5)
    v_mfma_f32_32x32x16_bf16 v[76:91], a[72:75], v[52:55], v[76:91]
    ds_read_b128 v[52:55], v108 offset:20480
    s_waitcnt lgkmcnt(5)
    v_mfma_f32_32x32x16_bf16 v[76:91], a[76:79], v[56:59], v[76:91]
    ds_read_b128 v[56:59], v108 offset:21504
    s_waitcnt lgkmcnt(5)
    v_mfma_f32_32x32x16_bf16 v[76:91], a[80:83], v[60:63], v[76:91]
    v_dot2_f32_bf16 v92, v60, v94, v92
    v_dot2_f32_bf16 v93, v60, v60, v93
    v_dot2_f32_bf16 v92, v61, v94, v92
    v_dot2_f32_bf16 v93, v61, v61, v93
    v_dot2_f32_bf16 v92, v62, v94, v92
    v_dot2_f32_bf16 v93, v62, v62, v93
    v_dot2_f32_bf16 v92, v63, v94, v92
    v_dot2_f32_bf16 v93, v63, v63, v93
    ds_read_b128 v[60:63], v108 offset:22528
    s_waitcnt lgkmcnt(5)
    v_mfma_f32_32x32x16_bf16 v[76:91], a[84:87], v[64:67], v[76:91]
    ds_read_b128 v[64:67], v108 offset:23552
    s_waitcnt lgkmcnt(5)
    v_mfma_f32_32x32x16_bf16 v[76:91], a[88:91], v[44:47], v[76:91]
    ds_read_b128 v[44:47], v108 offset:24576
    s_waitcnt lgkmcnt(5)
    v_mfma_f32_32x32x16_bf16 v[76:91], a[92:95], v[48:51], v[76:91]
    ds_read_b128 v[48:51], v108 offset:25600
    s_waitcnt lgkmcnt(5)
    v_mfma_f32_32x32x16_bf16 v[76:91], a[96:99], v[52:55], v[76:91]
    v_dot2_f32_bf16 v92, v52, v94, v92
    v_dot2_f32_bf16 v93, v52, v52, v93
    v_dot2_f32_bf16 v92, v53, v94, v92
    v_dot2_f32_bf16 v93, v53, v53, v93
    v_dot2_f32_bf16 v92, v54, v94, v92
    v_dot2_f32_bf16 v93, v54, v54, v93
    v_dot2_f32_bf16 v92, v55, v94, v92
    v_dot2_f32_bf16 v93, v55, v55, v93
    ds_read_b128 v[52:55], v108 offset:26624
    s_waitcnt lgkmcnt(5)
    v_mfma_f32_32x32x16_bf16 v[76:91], a[100:103], v[56:59], v[76:91]
    ds_read_b128 v[56:59], v108 offset:27648
    s_waitcnt lgkmcnt(5)
    v_mfma_f32_32x32x16_bf16 v[76:91], a[104:107], v[60:63], v[76:91]
    ds_read_b128 v[60:63], v108 offset:28672
    s_waitcnt lgkmcnt(5)
    v_mfma_f32_32x32x16_bf16 v[76:91], a[108:111], v[64:67], v[76:91]
    ds_read_b128 v[64:67], v108 offset:29696
    s_waitcnt lgkmcnt(5)
    v_mfma_f32_32x32x16_bf16 v[76:91], a[112:115], v[44:47], v[76:91]
    v_dot2_f32_bf16 v92, v44, v94, v92
    v_dot2_f32_bf16 v93, v44, v44, v93
    v_dot2_f32_bf16 v92, v45, v94, v92
    v_dot2_f32_bf16 v93, v45, v45, v93
    v_dot2_f32_bf16 v92, v46, v94, v92
    v_dot2_f32_bf16 v93, v46, v46, v93
    v_dot2_f32_bf16 v92, v47, v94, v92
    v_dot2_f32_bf16 v93, v47, v47, v93
    ds_read_b128 v[44:47], v108 offset:30720
    s_waitcnt lgkmcnt(5)
    v_mfma_f32_32x32x16_bf16 v[76:91], a[116:119], v[48:51], v[76:91]
    ds_read_b128 v[48:51], v108 offset:31744
    s_waitcnt lgkmcnt(5)
    v_mfma_f32_32x32x16_bf16 v[76:91], a[120:123], v[52:55], v[76:91]
    ds_read_b128 v[52:55], v108 offset:32768
    s_waitcnt lgkmcnt(5)
    v_mfma_f32_32x32x16_bf16 v[76:91], a[124:127], v[56:59], v[76:91]
    ds_read_b128 v[56:59], v108 offset:33792
    s_waitcnt lgkmcnt(5)
    v_mfma_f32_32x32x16_bf16 v[76:91], a[128:131], v[60:63], v[76:91]
    v_dot2_f32_bf16 v92, v60, v94, v92
    v_dot2_f32_bf16 v93, v60, v60, v93
    v_dot2_f32_bf16 v92, v61, v94, v92
    v_dot2_f32_bf16 v93, v61, v61, v93
    v_dot2_f32_bf16 v92, v62, v94, v92
    v_dot2_f32_bf16 v93, v62, v62, v93
    v_dot2_f32_bf16 v92, v63, v94, v92
    v_dot2_f32_bf16 v93, v63, v63, v93
    ds_read_b128 v[60:63], v108 offset:34816
    s_waitcnt lgkmcnt(5)
    v_mfma_f32_32x32x16_bf16 v[76:91], a[132:135], v[64:67], v[76:91]
    ds_read_b128 v[64:67], v108 offset:35840
    s_waitcnt lgkmcnt(5)
    v_mfma_f32_32x32x16_bf16 v[76:91], a[136:139], v[44:47], v[76:91]
    ds_read_b128 v[44:47], v108 offset:36864
    s_waitcnt lgkmcnt(5)
    v_mfma_f32_32x32x16_bf16 v[76:91], a[140:143], v[48:51], v[76:91]
    ds_read_b128 v[48:51], v108 offset:37888
    s_waitcnt lgkmcnt(5)
    v_mfma_f32_32x32x16_bf16 v[76:91], a[144:147], v[52:55], v[76:91]
    v_dot2_f32_bf16 v92, v52, v94, v92
    v_dot2_f32_bf16 v93, v52, v52, v93
    v_dot2_f32_bf16 v92, v53, v94, v92
    v_dot2_f32_bf16 v93, v53, v53, v93
    v_dot2_f32_bf16 v92, v54, v94, v92
    v_dot2_f32_bf16 v93, v54, v54, v93
    v_dot2_f32_bf16 v92, v55, v94, v92
    v_dot2_f32_bf16 v93, v55, v55, v93
    ds_read_b128 v[52:55], v108 offset:38912
    s_waitcnt lgkmcnt(5)
    v_mfma_f32_32x32x16_bf16 v[76:91], a[148:151], v[56:59], v[76:91]
    ds_read_b128 v[56:59], v108 offset:39936
    s_waitcnt lgkmcnt(5)
    v_mfma_f32_32x32x16_bf16 v[76:91], a[152:155], v[60:63], v[76:91]
    s_waitcnt lgkmcnt(4)
    v_mfma_f32_32x32x16_bf16 v[76:91], a[156:159], v[64:67], v[76:91]
    s_waitcnt lgkmcnt(3)
    v_mfma_f32_32x32x16_bf16 v[76:91], a[160:163], v[44:47], v[76:91]
    v_dot2_f32_bf16 v92, v44, v94, v92
    v_dot2_f32_bf16 v93, v44, v44, v93
    v_dot2_f32_bf16 v92, v45, v94, v92
    v_dot2_f32_bf16 v93, v45, v45, v93
    v_dot2_f32_bf16 v92, v46, v94, v92
    v_dot2_f32_bf16 v93, v46, v46, v93
    v_dot2_f32_bf16 v92, v47, v94, v92
    v_dot2_f32_bf16 v93, v47, v47, v93
    s_waitcnt lgkmcnt(2)
    v_mfma_f32_32x32x16_bf16 v[76:91], a[164:167], v[48:51], v[76:91]
    s_waitcnt lgkmcnt(1)
    v_mfma_f32_32x32x16_bf16 v[76:91], a[168:171], v[52:55], v[76:91]
    s_waitcnt lgkmcnt(0)
    v_mfma_f32_32x32x16_bf16 v[76:91], a[172:175], v[56:59], v[76:91]
    s_branch L_po_f1_done_f
L_po_f1_1_f:
    s_cmp_lg_u32 s3, 1
    s_cbranch_scc1 L_po_f1_2_f
    ds_read_b128 v[64:67], v108 offset:5120
    s_waitcnt lgkmcnt(5)
    v_mfma_f32_32x32x16_bf16 v[76:91], a[16:19], v[44:47], 0
    ds_read_b128 v[44:47], v108 offset:6144
    s_waitcnt lgkmcnt(5)
    v_mfma_f32_32x32x16_bf16 v[76:91], a[20:23], v[48:51], v[76:91]
    v_dot2_f32_bf16 v92, v48, v94, v92
    v_dot2_f32_bf16 v93, v48, v48, v93
    v_dot2_f32_bf16 v92, v49, v94, v92
    v_dot2_f32_bf16 v93, v49, v49, v93
    v_dot2_f32_bf16 v92, v50, v94, v92
    v_dot2_f32_bf16 v93, v50, v50, v93
    v_dot2_f32_bf16 v92, v51, v94, v92
    v_dot2_f32_bf16 v93, v51, v51, v93
    ds_read_b128 v[48:51], v108 offset:7168
    s_waitcnt lgkmcnt(5)
    v_mfma_f32_32x32x16_bf16 v[76:91], a[24:27], v[52:55], v[76:91]
    ds_read_b128 v[52:55], v108 offset:8192
    s_waitcnt lgkmcnt(5)
    v_mfma_f32_32x32x16_bf16 v[76:91], a[28:31], v[56:59], v[76:91]
    ds_read_b128 v[56:59], v108 offset:9216
    s_waitcnt lgkmcnt(5)
    v_mfma_f32_32x32x16_bf16 v[76:91], a[32:35], v[60:63], v[76:91]
    ds_read_b128 v[60:63], v108 offset:10240
    s_waitcnt lgkmcnt(5)
    v_mfma_f32_32x32x16_bf16 v[76:91], a[36:39], v[64:67], v[76:91]
    v_dot2_f32_bf16 v92, v64, v94, v92
    v_dot2_f32_bf16 v93, v64, v64, v93
    v_dot2_f32_bf16 v92, v65, v94, v92
    v_dot2_f32_bf16 v93, v65, v65, v93
    v_dot2_f32_bf16 v92, v66, v94, v92
    v_dot2_f32_bf16 v93, v66, v66, v93
    v_dot2_f32_bf16 v92, v67, v94, v92
    v_dot2_f32_bf16 v93, v67, v67, v93
    ds_read_b128 v[64:67], v108 offset:11264
    s_waitcnt lgkmcnt(5)
    v_mfma_f32_32x32x16_bf16 v[76:91], a[40:43], v[44:47], v[76:91]
    ds_read_b128 v[44:47], v108 offset:12288
    s_waitcnt lgkmcnt(5)
    v_mfma_f32_32x32x16_bf16 v[76:91], a[44:47], v[48:51], v[76:91]
    ds_read_b128 v[48:51], v108 offset:13312
    s_waitcnt lgkmcnt(5)
    v_mfma_f32_32x32x16_bf16 v[76:91], a[48:51], v[52:55], v[76:91]
    ds_read_b128 v[52:55], v108 offset:14336
    s_waitcnt lgkmcnt(5)
    v_mfma_f32_32x32x16_bf16 v[76:91], a[52:55], v[56:59], v[76:91]
    v_dot2_f32_bf16 v92, v56, v94, v92
    v_dot2_f32_bf16 v93, v56, v56, v93
    v_dot2_f32_bf16 v92, v57, v94, v92
    v_dot2_f32_bf16 v93, v57, v57, v93
    v_dot2_f32_bf16 v92, v58, v94, v92
    v_dot2_f32_bf16 v93, v58, v58, v93
    v_dot2_f32_bf16 v92, v59, v94, v92
    v_dot2_f32_bf16 v93, v59, v59, v93
    ds_read_b128 v[56:59], v108 offset:15360
    s_waitcnt lgkmcnt(5)
    v_mfma_f32_32x32x16_bf16 v[76:91], a[56:59], v[60:63], v[76:91]
    ds_read_b128 v[60:63], v108 offset:16384
    s_waitcnt lgkmcnt(5)
    v_mfma_f32_32x32x16_bf16 v[76:91], a[60:63], v[64:67], v[76:91]
    ds_read_b128 v[64:67], v108 offset:17408
    s_waitcnt lgkmcnt(5)
    v_mfma_f32_32x32x16_bf16 v[76:91], a[64:67], v[44:47], v[76:91]
    ds_read_b128 v[44:47], v108 offset:18432
    s_waitcnt lgkmcnt(5)
    v_mfma_f32_32x32x16_bf16 v[76:91], a[68:71], v[48:51], v[76:91]
    v_dot2_f32_bf16 v92, v48, v94, v92
    v_dot2_f32_bf16 v93, v48, v48, v93
    v_dot2_f32_bf16 v92, v49, v94, v92
    v_dot2_f32_bf16 v93, v49, v49, v93
    v_dot2_f32_bf16 v92, v50, v94, v92
    v_dot2_f32_bf16 v93, v50, v50, v93
    v_dot2_f32_bf16 v92, v51, v94, v92
    v_dot2_f32_bf16 v93, v51, v51, v93
    ds_read_b128 v[48:51], v108 offset:19456
    s_waitcnt lgkmcnt(5)
    v_mfma_f32_32x32x16_bf16 v[76:91], a[72:75], v[52:55], v[76:91]
    ds_read_b128 v[52:55], v108 offset:20480
    s_waitcnt lgkmcnt(5)
    v_mfma_f32_32x32x16_bf16 v[76:91], a[76:79], v[56:59], v[76:91]
    ds_read_b128 v[56:59], v108 offset:21504
    s_waitcnt lgkmcnt(5)
    v_mfma_f32_32x32x16_bf16 v[76:91], a[80:83], v[60:63], v[76:91]
    ds_read_b128 v[60:63], v108 offset:22528
    s_waitcnt lgkmcnt(5)
    v_mfma_f32_32x32x16_bf16 v[76:91], a[84:87], v[64:67], v[76:91]
    v_dot2_f32_bf16 v92, v64, v94, v92
    v_dot2_f32_bf16 v93, v64, v64, v93
    v_dot2_f32_bf16 v92, v65, v94, v92
    v_dot2_f32_bf16 v93, v65, v65, v93
    v_dot2_f32_bf16 v92, v66, v94, v92
    v_dot2_f32_bf16 v93, v66, v66, v93
    v_dot2_f32_bf16 v92, v67, v94, v92
    v_dot2_f32_bf16 v93, v67, v67, v93
    ds_read_b128 v[64:67], v108 offset:23552
    s_waitcnt lgkmcnt(5)
    v_mfma_f32_32x32x16_bf16 v[76:91], a[88:91], v[44:47], v[76:91]
    ds_read_b128 v[44:47], v108 offset:24576
    s_waitcnt lgkmcnt(5)
    v_mfma_f32_32x32x16_bf16 v[76:91], a[92:95], v[48:51], v[76:91]
    ds_read_b128 v[48:51], v108 offset:25600
    s_waitcnt lgkmcnt(5)
    v_mfma_f32_32x32x16_bf16 v[76:91], a[96:99], v[52:55], v[76:91]
    ds_read_b128 v[52:55], v108 offset:26624
    s_waitcnt lgkmcnt(5)
    v_mfma_f32_32x32x16_bf16 v[76:91], a[100:103], v[56:59], v[76:91]
    v_dot2_f32_bf16 v92, v56, v94, v92
    v_dot2_f32_bf16 v93, v56, v56, v93
    v_dot2_f32_bf16 v92, v57, v94, v92
    v_dot2_f32_bf16 v93, v57, v57, v93
    v_dot2_f32_bf16 v92, v58, v94, v92
    v_dot2_f32_bf16 v93, v58, v58, v93
    v_dot2_f32_bf16 v92, v59, v94, v92
    v_dot2_f32_bf16 v93, v59, v59, v93
    ds_read_b128 v[56:59], v108 offset:27648
    s_waitcnt lgkmcnt(5)
    v_mfma_f32_32x32x16_bf16 v[76:91], a[104:107], v[60:63], v[76:91]
    ds_read_b128 v[60:63], v108 offset:28672
    s_waitcnt lgkmcnt(5)
    v_mfma_f32_32x32x16_bf16 v[76:91], a[108:111], v[64:67], v[76:91]
    ds_read_b128 v[64:67], v108 offset:29696
    s_waitcnt lgkmcnt(5)
    v_mfma_f32_32x32x16_bf16 v[76:91], a[112:115], v[44:47], v[76:91]
    ds_read_b128 v[44:47], v108 offset:30720
    s_waitcnt lgkmcnt(5)
    v_mfma_f32_32x32x16_bf16 v[76:91], a[116:119], v[48:51], v[76:91]
    v_dot2_f32_bf16 v92, v48, v94, v92
    v_dot2_f32_bf16 v93, v48, v48, v93
    v_dot2_f32_bf16 v92, v49, v94, v92
    v_dot2_f32_bf16 v93, v49, v49, v93
    v_dot2_f32_bf16 v92, v50, v94, v92
    v_dot2_f32_bf16 v93, v50, v50, v93
    v_dot2_f32_bf16 v92, v51, v94, v92
    v_dot2_f32_bf16 v93, v51, v51, v93
    ds_read_b128 v[48:51], v108 offset:31744
    s_waitcnt lgkmcnt(5)
    v_mfma_f32_32x32x16_bf16 v[76:91], a[120:123], v[52:55], v[76:91]
    ds_read_b128 v[52:55], v108 offset:32768
    s_waitcnt lgkmcnt(5)
    v_mfma_f32_32x32x16_bf16 v[76:91], a[124:127], v[56:59], v[76:91]
    ds_read_b128 v[56:59], v108 offset:33792
    s_waitcnt lgkmcnt(5)
    v_mfma_f32_32x32x16_bf16 v[76:91], a[128:131], v[60:63], v[76:91]
    ds_read_b128 v[60:63], v108 offset:34816
    s_waitcnt lgkmcnt(5)
    v_mfma_f32_32x32x16_bf16 v[76:91], a[132:135], v[64:67], v[76:91]
    v_dot2_f32_bf16 v92, v64, v94, v92
    v_dot2_f32_bf16 v93, v64, v64, v93
    v_dot2_f32_bf16 v92, v65, v94, v92
    v_dot2_f32_bf16 v93, v65, v65, v93
    v_dot2_f32_bf16 v92, v66, v94, v92
    v_dot2_f32_bf16 v93, v66, v66, v93
    v_dot2_f32_bf16 v92, v67, v94, v92
    v_dot2_f32_bf16 v93, v67, v67, v93
    ds_read_b128 v[64:67], v108 offset:35840
    s_waitcnt lgkmcnt(5)
    v_mfma_f32_32x32x16_bf16 v[76:91], a[136:139], v[44:47], v[76:91]
    ds_read_b128 v[44:47], v108 offset:36864
    s_waitcnt lgkmcnt(5)
    v_mfma_f32_32x32x16_bf16 v[76:91], a[140:143], v[48:51], v[76:91]
    ds_read_b128 v[48:51], v108 offset:37888
    s_waitcnt lgkmcnt(5)
    v_mfma_f32_32x32x16_bf16 v[76:91], a[144:147], v[52:55], v[76:91]
    ds_read_b128 v[52:55], v108 offset:38912
    s_waitcnt lgkmcnt(5)
    v_mfma_f32_32x32x16_bf16 v[76:91], a[148:151], v[56:59], v[76:91]
    v_dot2_f32_bf16 v92, v56, v94, v92
    v_dot2_f32_bf16 v93, v56, v56, v93
    v_dot2_f32_bf16 v92, v57, v94, v92
    v_dot2_f32_bf16 v93, v57, v57, v93
    v_dot2_f32_bf16 v92, v58, v94, v92
    v_dot2_f32_bf16 v93, v58, v58, v93
    v_dot2_f32_bf16 v92, v59, v94, v92
    v_dot2_f32_bf16 v93, v59, v59, v93
    ds_read_b128 v[56:59], v108 offset:39936
    s_waitcnt lgkmcnt(5)
    v_mfma_f32_32x32x16_bf16 v[76:91], a[152:155], v[60:63], v[76:91]
    s_waitcnt lgkmcnt(4)
    v_mfma_f32_32x32x16_bf16 v[76:91], a[156:159], v[64:67], v[76:91]
    s_waitcnt lgkmcnt(3)
    v_mfma_f32_32x32x16_bf16 v[76:91], a[160:163], v[44:47], v[76:91]
    s_waitcnt lgkmcnt(2)
    v_mfma_f32_32x32x16_bf16 v[76:91], a[164:167], v[48:51], v[76:91]
    v_dot2_f32_bf16 v92, v48, v94, v92
    v_dot2_f32_bf16 v93, v48, v48, v93
    v_dot2_f32_bf16 v92, v49, v94, v92
    v_dot2_f32_bf16 v93, v49, v49, v93
    v_dot2_f32_bf16 v92, v50, v94, v92
    v_dot2_f32_bf16 v93, v50, v50, v93
    v_dot2_f32_bf16 v92, v51, v94, v92
    v_dot2_f32_bf16 v93, v51, v51, v93
    s_waitcnt lgkmcnt(1)
    v_mfma_f32_32x32x16_bf16 v[76:91], a[168:171], v[52:55], v[76:91]
    s_waitcnt lgkmcnt(0)
    v_mfma_f32_32x32x16_bf16 v[76:91], a[172:175], v[56:59], v[76:91]
    s_branch L_po_f1_done_f
L_po_f1_2_f:
    s_cmp_lg_u32 s3, 2
    s_cbranch_scc1 L_po_f1_3_f
    ds_read_b128 v[64:67], v108 offset:5120
    s_waitcnt lgkmcnt(5)
    v_mfma_f32_32x32x16_bf16 v[76:91], a[16:19], v[44:47], 0
    ds_read_b128 v[44:47], v108 offset:6144
    s_waitcnt lgkmcnt(5)
    v_mfma_f32_32x32x16_bf16 v[76:91], a[20:23], v[48:51], v[76:91]
    ds_read_b128 v[48:51], v108 offset:7168
    s_waitcnt lgkmcnt(5)
    v_mfma_f32_32x32x16_bf16 v[76:91], a[24:27], v[52:55], v[76:91]
    v_dot2_f32_bf16 v92, v52, v94, v92
    v_dot2_f32_bf16 v93, v52, v52, v93
    v_dot2_f32_bf16 v92, v53, v94, v92
    v_dot2_f32_bf16 v93, v53, v53, v93
    v_dot2_f32_bf16 v92, v54, v94, v92
    v_dot2_f32_bf16 v93, v54, v54, v93
    v_dot2_f32_bf16 v92, v55, v94, v92
    v_dot2_f32_bf16 v93, v55, v55, v93
    ds_read_b128 v[52:55], v108 offset:8192
    s_waitcnt lgkmcnt(5)
    v_mfma_f32_32x32x16_bf16 v[76:91], a[28:31], v[56:59], v[76:91]
    ds_read_b128 v[56:59], v108 offset:9216
    s_waitcnt lgkmcnt(5)
    v_mfma_f32_32x32x16_bf16 v[76:91], a[32:35], v[60:63], v[76:91]
    ds_read_b128 v[60:63], v108 offset:10240
    s_waitcnt lgkmcnt(5)
    v_mfma_f32_32x32x16_bf16 v[76:91], a[36:39], v[64:67], v[76:91]
    ds_read_b128 v[64:67], v108 offset:11264
    s_waitcnt lgkmcnt(5)
    v_mfma_f32_32x32x16_bf16 v[76:91], a[40:43], v[44:47], v[76:91]
    v_dot2_f32_bf16 v92, v44, v94, v92
    v_dot2_f32_bf16 v93, v44, v44, v93
    v_dot2_f32_bf16 v92, v45, v94, v92
    v_dot2_f32_bf16 v93, v45, v45, v93
    v_dot2_f32_bf16 v92, v46, v94, v92
    v_dot2_f32_bf16 v93, v46, v46, v93
    v_dot2_f32_bf16 v92, v47, v94, v92
    v_dot2_f32_bf16 v93, v47, v47, v93
    ds_read_b128 v[44:47], v108 offset:12288
    s_waitcnt lgkmcnt(5)
    v_mfma_f32_32x32x16_bf16 v[76:91], a[44:47], v[48:51], v[76:91]
    ds_read_b128 v[48:51], v108 offset:13312
    s_waitcnt lgkmcnt(5)
    v_mfma_f32_32x32x16_bf16 v[76:91], a[48:51], v[52:55], v[76:91]
    ds_read_b128 v[52:55], v108 offset:14336
    s_waitcnt lgkmcnt(5)
    v_mfma_f32_32x32x16_bf16 v[76:91], a[52:55], v[56:59], v[76:91]
    ds_read_b128 v[56:59], v108 offset:15360
    s_waitcnt lgkmcnt(5)
    v_mfma_f32_32x32x16_bf16 v[76:91], a[56:59], v[60:63], v[76:91]
    v_dot2_f32_bf16 v92, v60, v94, v92
    v_dot2_f32_bf16 v93, v60, v60, v93
    v_dot2_f32_bf16 v92, v61, v94, v92
    v_dot2_f32_bf16 v93, v61, v61, v93
    v_dot2_f32_bf16 v92, v62, v94, v92
    v_dot2_f32_bf16 v93, v62, v62, v93
    v_dot2_f32_bf16 v92, v63, v94, v92
    v_dot2_f32_bf16 v93, v63, v63, v93
    ds_read_b128 v[60:63], v108 offset:16384
    s_waitcnt lgkmcnt(5)
    v_mfma_f32_32x32x16_bf16 v[76:91], a[60:63], v[64:67], v[76:91]
    ds_read_b128 v[64:67], v108 offset:17408
    s_waitcnt lgkmcnt(5)
    v_mfma_f32_32x32x16_bf16 v[76:91], a[64:67], v[44:47], v[76:91]
    ds_read_b128 v[44:47], v108 offset:18432
    s_waitcnt lgkmcnt(5)
    v_mfma_f32_32x32x16_bf16 v[76:91], a[68:71], v[48:51], v[76:91]
    ds_read_b128 v[48:51], v108 offset:19456
    s_waitcnt lgkmcnt(5)
    v_mfma_f32_32x32x16_bf16 v[76:91], a[72:75], v[52:55], v[76:91]
    v_dot2_f32_bf16 v92, v52, v94, v92
    v_dot2_f32_bf16 v93, v52, v52, v93
    v_dot2_f32_bf16 v92, v53, v94, v92
    v_dot2_f32_bf16 v93, v53, v53, v93
    v_dot2_f32_bf16 v92, v54, v94, v92
    v_dot2_f32_bf16 v93, v54, v54, v93
    v_dot2_f32_bf16 v92, v55, v94, v92
    v_dot2_f32_bf16 v93, v55, v55, v93
    ds_read_b128 v[52:55], v108 offset:20480
    s_waitcnt lgkmcnt(5)
    v_mfma_f32_32x32x16_bf16 v[76:91], a[76:79], v[56:59], v[76:91]
    ds_read_b128 v[56:59], v108 offset:21504
    s_waitcnt lgkmcnt(5)
    v_mfma_f32_32x32x16_bf16 v[76:91], a[80:83], v[60:63], v[76:91]
    ds_read_b128 v[60:63], v108 offset:22528
    s_waitcnt lgkmcnt(5)
    v_mfma_f32_32x32x16_bf16 v[76:91], a[84:87], v[64:67], v[76:91]
    ds_read_b128 v[64:67], v108 offset:23552
    s_waitcnt lgkmcnt(5)
    v_mfma_f32_32x32x16_bf16 v[76:91], a[88:91], v[44:47], v[76:91]
    v_dot2_f32_bf16 v92, v44, v94, v92
    v_dot2_f32_bf16 v93, v44, v44, v93
    v_dot2_f32_bf16 v92, v45, v94, v92
    v_dot2_f32_bf16 v93, v45, v45, v93
    v_dot2_f32_bf16 v92, v46, v94, v92
    v_dot2_f32_bf16 v93, v46, v46, v93
    v_dot2_f32_bf16 v92, v47, v94, v92
    v_dot2_f32_bf16 v93, v47, v47, v93
    ds_read_b128 v[44:47], v108 offset:24576
    s_waitcnt lgkmcnt(5)
    v_mfma_f32_32x32x16_bf16 v[76:91], a[92:95], v[48:51], v[76:91]
    ds_read_b128 v[48:51], v108 offset:25600
    s_waitcnt lgkmcnt(5)
    v_mfma_f32_32x32x16_bf16 v[76:91], a[96:99], v[52:55], v[76:91]
    ds_read_b128 v[52:55], v108 offset:26624
    s_waitcnt lgkmcnt(5)
    v_mfma_f32_32x32x16_bf16 v[76:91], a[100:103], v[56:59], v[76:91]
    ds_read_b128 v[56:59], v108 offset:27648
    s_waitcnt lgkmcnt(5)
    v_mfma_f32_32x32x16_bf16 v[76:91], a[104:107], v[60:63], v[76:91]
    v_dot2_f32_bf16 v92, v60, v94, v92
    v_dot2_f32_bf16 v93, v60, v60, v93
    v_dot2_f32_bf16 v92, v61, v94, v92
    v_dot2_f32_bf16 v93, v61, v61, v93
    v_dot2_f32_bf16 v92, v62, v94, v92
    v_dot2_f32_bf16 v93, v62, v62, v93
    v_dot2_f32_bf16 v92, v63, v94, v92
    v_dot2_f32_bf16 v93, v63, v63, v93
    ds_read_b128 v[60:63], v108 offset:28672
    s_waitcnt lgkmcnt(5)
    v_mfma_f32_32x32x16_bf16 v[76:91], a[108:111], v[64:67], v[76:91]
    ds_read_b128 v[64:67], v108 offset:29696
    s_waitcnt lgkmcnt(5)
    v_mfma_f32_32x32x16_bf16 v[76:91], a[112:115], v[44:47], v[76:91]
    ds_read_b128 v[44:47], v108 offset:30720
    s_waitcnt lgkmcnt(5)
    v_mfma_f32_32x32x16_bf16 v[76:91], a[116:119], v[48:51], v[76:91]
    ds_read_b128 v[48:51], v108 offset:31744
    s_waitcnt lgkmcnt(5)
    v_mfma_f32_32x32x16_bf16 v[76:91], a[120:123], v[52:55], v[76:91]
    v_dot2_f32_bf16 v92, v52, v94, v92
    v_dot2_f32_bf16 v93, v52, v52, v93
    v_dot2_f32_bf16 v92, v53, v94, v92
    v_dot2_f32_bf16 v93, v53, v53, v93
    v_dot2_f32_bf16 v92, v54, v94, v92
    v_dot2_f32_bf16 v93, v54, v54, v93
    v_dot2_f32_bf16 v92, v55, v94, v92
    v_dot2_f32_bf16 v93, v55, v55, v93
    ds_read_b128 v[52:55], v108 offset:32768
    s_waitcnt lgkmcnt(5)
    v_mfma_f32_32x32x16_bf16 v[76:91], a[124:127], v[56:59], v[76:91]
    ds_read_b128 v[56:59], v108 offset:33792
    s_waitcnt lgkmcnt(5)
    v_mfma_f32_32x32x16_bf16 v[76:91], a[128:131], v[60:63], v[76:91]
    ds_read_b128 v[60:63], v108 offset:34816
    s_waitcnt lgkmcnt(5)
    v_mfma_f32_32x32x16_bf16 v[76:91], a[132:135], v[64:67], v[76:91]
    ds_read_b128 v[64:67], v108 offset:35840
    s_waitcnt lgkmcnt(5)
    v_mfma_f32_32x32x16_bf16 v[76:91], a[136:139], v[44:47], v[76:91]
    v_dot2_f32_bf16 v92, v44, v94, v92
    v_dot2_f32_bf16 v93, v44, v44, v93
    v_dot2_f32_bf16 v92, v45, v94, v92
    v_dot2_f32_bf16 v93, v45, v45, v93
    v_dot2_f32_bf16 v92, v46, v94, v92
    v_dot2_f32_bf16 v93, v46, v46, v93
    v_dot2_f32_bf16 v92, v47, v94, v92
    v_dot2_f32_bf16 v93, v47, v47, v93
    ds_read_b128 v[44:47], v108 offset:36864
    s_waitcnt lgkmcnt(5)
    v_mfma_f32_32x32x16_bf16 v[76:91], a[140:143], v[48:51], v[76:91]
    ds_read_b128 v[48:51], v108 offset:37888
    s_waitcnt lgkmcnt(5)
    v_mfma_f32_32x32x16_bf16 v[76:91], a[144:147], v[52:55], v[76:91]
    ds_read_b128 v[52:55], v108 offset:38912
    s_waitcnt lgkmcnt(5)
    v_mfma_f32_32x32x16_bf16 v[76:91], a[148:151], v[56:59], v[76:91]
    ds_read_b128 v[56:59], v108 offset:39936
    s_waitcnt lgkmcnt(5)
    v_mfma_f32_32x32x16_bf16 v[76:91], a[152:155], v[60:63], v[76:91]
    v_dot2_f32_bf16 v92, v60, v94, v92
    v_dot2_f32_bf16 v93, v60, v60, v93
    v_dot2_f32_bf16 v92, v61, v94, v92
    v_dot2_f32_bf16 v93, v61, v61, v93
    v_dot2_f32_bf16 v92, v62, v94, v92
    v_dot2_f32_bf16 v93, v62, v62, v93
    v_dot2_f32_bf16 v92, v63, v94, v92
    v_dot2_f32_bf16 v93, v63, v63, v93
    s_waitcnt lgkmcnt(4)
    v_mfma_f32_32x32x16_bf16 v[76:91], a[156:159], v[64:67], v[76:91]
    s_waitcnt lgkmcnt(3)
    v_mfma_f32_32x32x16_bf16 v[76:91], a[160:163], v[44:47], v[76:91]
    s_waitcnt lgkmcnt(2)
    v_mfma_f32_32x32x16_bf16 v[76:91], a[164:167], v[48:51], v[76:91]
    s_waitcnt lgkmcnt(1)
    v_mfma_f32_32x32x16_bf16 v[76:91], a[168:171], v[52:55], v[76:91]
    v_dot2_f32_bf16 v92, v52, v94, v92
    v_dot2_f32_bf16 v93, v52, v52, v93
    v_dot2_f32_bf16 v92, v53, v94, v92
    v_dot2_f32_bf16 v93, v53, v53, v93
    v_dot2_f32_bf16 v92, v54, v94, v92
    v_dot2_f32_bf16 v93, v54, v54, v93
    v_dot2_f32_bf16 v92, v55, v94, v92
    v_dot2_f32_bf16 v93, v55, v55, v93
    s_waitcnt lgkmcnt(0)
    v_mfma_f32_32x32x16_bf16 v[76:91], a[172:175], v[56:59], v[76:91]
    s_branch L_po_f1_done_f
L_po_f1_3_f:
    ds_read_b128 v[64:67], v108 offset:5120
    s_waitcnt lgkmcnt(5)
    v_mfma_f32_32x32x16_bf16 v[76:91], a[16:19], v[44:47], 0
    ds_read_b128 v[44:47], v108 offset:6144
    s_waitcnt lgkmcnt(5)
    v_mfma_f32_32x32x16_bf16 v[76:91], a[20:23], v[48:51], v[76:91]
    ds_read_b128 v[48:51], v108 offset:7168
    s_waitcnt lgkmcnt(5)
    v_mfma_f32_32x32x16_bf16 v[76:91], a[24:27], v[52:55], v[76:91]
    ds_read_b128 v[52:55], v108 offset:8192
    s_waitcnt lgkmcnt(5)
    v_mfma_f32_32x32x16_bf16 v[76:91], a[28:31], v[56:59], v[76:91]
    v_dot2_f32_bf16 v92, v56, v94, v92
    v_dot2_f32_bf16 v93, v56, v56, v93
    v_dot2_f32_bf16 v92, v57, v94, v92
    v_dot2_f32_bf16 v93, v57, v57, v93
    v_dot2_f32_bf16 v92, v58, v94, v92
    v_dot2_f32_bf16 v93, v58, v58, v93
    v_dot2_f32_bf16 v92, v59, v94, v92
    v_dot2_f32_bf16 v93, v59, v59, v93
    ds_read_b128 v[56:59], v108 offset:9216
    s_waitcnt lgkmcnt(5)
    v_mfma_f32_32x32x16_bf16 v[76:91], a[32:35], v[60:63], v[76:91]
    ds_read_b128 v[60:63], v108 offset:10240
    s_waitcnt lgkmcnt(5)
    v_mfma_f32_32x32x16_bf16 v[76:91], a[36:39], v[64:67], v[76:91]
    ds_read_b128 v[64:67], v108 offset:11264
    s_waitcnt lgkmcnt(5)
    v_mfma_f32_32x32x16_bf16 v[76:91], a[40:43], v[44:47], v[76:91]
    ds_read_b128 v[44:47], v108 offset:12288
    s_waitcnt lgkmcnt(5)
    v_mfma_f32_32x32x16_bf16 v[76:91], a[44:47], v[48:51], v[76:91]
    v_dot2_f32_bf16 v92, v48, v94, v92
    v_dot2_f32_bf16 v93, v48, v48, v93
    v_dot2_f32_bf16 v92, v49, v94, v92
    v_dot2_f32_bf16 v93, v49, v49, v93
    v_dot2_f32_bf16 v92, v50, v94, v92
    v_dot2_f32_bf16 v93, v50, v50, v93
    v_dot2_f32_bf16 v92, v51, v94, v92
    v_dot2_f32_bf16 v93, v51, v51, v93
    ds_read_b128 v[48:51], v108 offset:13312
    s_waitcnt lgkmcnt(5)
    v_mfma_f32_32x32x16_bf16 v[76:91], a[48:51], v[52:55], v[76:91]
    ds_read_b128 v[52:55], v108 offset:14336
    s_waitcnt lgkmcnt(5)
    v_mfma_f32_32x32x16_bf16 v[76:91], a[52:55], v[56:59], v[76:91]
    ds_read_b128 v[56:59], v108 offset:15360
    s_waitcnt lgkmcnt(5)
    v_mfma_f32_32x32x16_bf16 v[76:91], a[56:59], v[60:63], v[76:91]
    ds_read_b128 v[60:63], v108 offset:16384
    s_waitcnt lgkmcnt(5)
    v_mfma_f32_32x32x16_bf16 v[76:91], a[60:63], v[64:67], v[76:91]
    v_dot2_f32_bf16 v92, v64, v94, v92
    v_dot2_f32_bf16 v93, v64, v64, v93
    v_dot2_f32_bf16 v92, v65, v94, v92
    v_dot2_f32_bf16 v93, v65, v65, v93
    v_dot2_f32_bf16 v92, v66, v94, v92
    v_dot2_f32_bf16 v93, v66, v66, v93
    v_dot2_f32_bf16 v92, v67, v94, v92
    v_dot2_f32_bf16 v93, v67, v67, v93
    ds_read_b128 v[64:67], v108 offset:17408
    s_waitcnt lgkmcnt(5)
    v_mfma_f32_32x32x16_bf16 v[76:91], a[64:67], v[44:47], v[76:91]
    ds_read_b128 v[44:47], v108 offset:18432
    s_waitcnt lgkmcnt(5)
    v_mfma_f32_32x32x16_bf16 v[76:91], a[68:71], v[48:51], v[76:91]
    ds_read_b128 v[48:51], v108 offset:19456
    s_waitcnt lgkmcnt(5)
    v_mfma_f32_32x32x16_bf16 v[76:91], a[72:75], v[52:55], v[76:91]
    ds_read_b128 v[52:55], v108 offset:20480
    s_waitcnt lgkmcnt(5)
    v_mfma_f32_32x32x16_bf16 v[76:91], a[76:79], v[56:59], v[76:91]
    v_dot2_f32_bf16 v92, v56, v94, v92
    v_dot2_f32_bf16 v93, v56, v56, v93
    v_dot2_f32_bf16 v92, v57, v94, v92
    v_dot2_f32_bf16 v93, v57, v57, v93
    v_dot2_f32_bf16 v92, v58, v94, v92
    v_dot2_f32_bf16 v93, v58, v58, v93
    v_dot2_f32_bf16 v92, v59, v94, v92
    v_dot2_f32_bf16 v93, v59, v59, v93
    ds_read_b128 v[56:59], v108 offset:21504
    s_waitcnt lgkmcnt(5)
    v_mfma_f32_32x32x16_bf16 v[76:91], a[80:83], v[60:63], v[76:91]
    ds_read_b128 v[60:63], v108 offset:22528
    s_waitcnt lgkmcnt(5)
    v_mfma_f32_32x32x16_bf16 v[76:91], a[84:87], v[64:67], v[76:91]
    ds_read_b128 v[64:67], v108 offset:23552
    s_waitcnt lgkmcnt(5)
    v_mfma_f32_32x32x16_bf16 v[76:91], a[88:91], v[44:47], v[76:91]
    ds_read_b128 v[44:47], v108 offset:24576
    s_waitcnt lgkmcnt(5)
    v_mfma_f32_32x32x16_bf16 v[76:91], a[92:95], v[48:51], v[76:91]
    v_dot2_f32_bf16 v92, v48, v94, v92
    v_dot2_f32_bf16 v93, v48, v48, v93
    v_dot2_f32_bf16 v92, v49, v94, v92
    v_dot2_f32_bf16 v93, v49, v49, v93
    v_dot2_f32_bf16 v92, v50, v94, v92
    v_dot2_f32_bf16 v93, v50, v50, v93
    v_dot2_f32_bf16 v92, v51, v94, v92
    v_dot2_f32_bf16 v93, v51, v51, v93
    ds_read_b128 v[48:51], v108 offset:25600
    s_waitcnt lgkmcnt(5)
    v_mfma_f32_32x32x16_bf16 v[76:91], a[96:99], v[52:55], v[76:91]
    ds_read_b128 v[52:55], v108 offset:26624
    s_waitcnt lgkmcnt(5)
    v_mfma_f32_32x32x16_bf16 v[76:91], a[100:103], v[56:59], v[76:91]
    ds_read_b128 v[56:59], v108 offset:27648
    s_waitcnt lgkmcnt(5)
    v_mfma_f32_32x32x16_bf16 v[76:91], a[104:107], v[60:63], v[76:91]
    ds_read_b128 v[60:63], v108 offset:28672
    s_waitcnt lgkmcnt(5)
    v_mfma_f32_32x32x16_bf16 v[76:91], a[108:111], v[64:67], v[76:91]
    v_dot2_f32_bf16 v92, v64, v94, v92
    v_dot2_f32_bf16 v93, v64, v64, v93
    v_dot2_f32_bf16 v92, v65, v94, v92
    v_dot2_f32_bf16 v93, v65, v65, v93
    v_dot2_f32_bf16 v92, v66, v94, v92
    v_dot2_f32_bf16 v93, v66, v66, v93
    v_dot2_f32_bf16 v92, v67, v94, v92
    v_dot2_f32_bf16 v93, v67, v67, v93
    ds_read_b128 v[64:67], v108 offset:29696
    s_waitcnt lgkmcnt(5)
    v_mfma_f32_32x32x16_bf16 v[76:91], a[112:115], v[44:47], v[76:91]
    ds_read_b128 v[44:47], v108 offset:30720
    s_waitcnt lgkmcnt(5)
    v_mfma_f32_32x32x16_bf16 v[76:91], a[116:119], v[48:51], v[76:91]
    ds_read_b128 v[48:51], v108 offset:31744
    s_waitcnt lgkmcnt(5)
    v_mfma_f32_32x32x16_bf16 v[76:91], a[120:123], v[52:55], v[76:91]
    ds_read_b128 v[52:55], v108 offset:32768
    s_waitcnt lgkmcnt(5)
    v_mfma_f32_32x32x16_bf16 v[76:91], a[124:127], v[56:59], v[76:91]
    v_dot2_f32_bf16 v92, v56, v94, v92
    v_dot2_f32_bf16 v93, v56, v56, v93
    v_dot2_f32_bf16 v92, v57, v94, v92
    v_dot2_f32_bf16 v93, v57, v57, v93
    v_dot2_f32_bf16 v92, v58, v94, v92
    v_dot2_f32_bf16 v93, v58, v58, v93
    v_dot2_f32_bf16 v92, v59, v94, v92
    v_dot2_f32_bf16 v93, v59, v59, v93
    ds_read_b128 v[56:59], v108 offset:33792
    s_waitcnt lgkmcnt(5)
    v_mfma_f32_32x32x16_bf16 v[76:91], a[128:131], v[60:63], v[76:91]
    ds_read_b128 v[60:63], v108 offset:34816
    s_waitcnt lgkmcnt(5)
    v_mfma_f32_32x32x16_bf16 v[76:91], a[132:135], v[64:67], v[76:91]
    ds_read_b128 v[64:67], v108 offset:35840
    s_waitcnt lgkmcnt(5)
    v_mfma_f32_32x32x16_bf16 v[76:91], a[136:139], v[44:47], v[76:91]
    ds_read_b128 v[44:47], v108 offset:36864
    s_waitcnt lgkmcnt(5)
    v_mfma_f32_32x32x16_bf16 v[76:91], a[140:143], v[48:51], v[76:91]
    v_dot2_f32_bf16 v92, v48, v94, v92
    v_dot2_f32_bf16 v93, v48, v48, v93
    v_dot2_f32_bf16 v92, v49, v94, v92
    v_dot2_f32_bf16 v93, v49, v49, v93
    v_dot2_f32_bf16 v92, v50, v94, v92
    v_dot2_f32_bf16 v93, v50, v50, v93
    v_dot2_f32_bf16 v92, v51, v94, v92
    v_dot2_f32_bf16 v93, v51, v51, v93
    ds_read_b128 v[48:51], v108 offset:37888
    s_waitcnt lgkmcnt(5)
    v_mfma_f32_32x32x16_bf16 v[76:91], a[144:147], v[52:55], v[76:91]
    ds_read_b128 v[52:55], v108 offset:38912
    s_waitcnt lgkmcnt(5)
    v_mfma_f32_32x32x16_bf16 v[76:91], a[148:151], v[56:59], v[76:91]
    ds_read_b128 v[56:59], v108 offset:39936
    s_waitcnt lgkmcnt(5)
    v_mfma_f32_32x32x16_bf16 v[76:91], a[152:155], v[60:63], v[76:91]
    s_waitcnt lgkmcnt(4)
    v_mfma_f32_32x32x16_bf16 v[76:91], a[156:159], v[64:67], v[76:91]
    v_dot2_f32_bf16 v92, v64, v94, v92
    v_dot2_f32_bf16 v93, v64, v64, v93
    v_dot2_f32_bf16 v92, v65, v94, v92
    v_dot2_f32_bf16 v93, v65, v65, v93
    v_dot2_f32_bf16 v92, v66, v94, v92
    v_dot2_f32_bf16 v93, v66, v66, v93
    v_dot2_f32_bf16 v92, v67, v94, v92
    v_dot2_f32_bf16 v93, v67, v67, v93
    s_waitcnt lgkmcnt(3)
    v_mfma_f32_32x32x16_bf16 v[76:91], a[160:163], v[44:47], v[76:91]
    s_waitcnt lgkmcnt(2)
    v_mfma_f32_32x32x16_bf16 v[76:91], a[164:167], v[48:51], v[76:91]
    s_waitcnt lgkmcnt(1)
    v_mfma_f32_32x32x16_bf16 v[76:91], a[168:171], v[52:55], v[76:91]
    s_waitcnt lgkmcnt(0)
    v_mfma_f32_32x32x16_bf16 v[76:91], a[172:175], v[56:59], v[76:91]
    v_dot2_f32_bf16 v92, v56, v94, v92
    v_dot2_f32_bf16 v93, v56, v56, v93
    v_dot2_f32_bf16 v92, v57, v94, v92
    v_dot2_f32_bf16 v93, v57, v57, v93
    v_dot2_f32_bf16 v92, v58, v94, v92
    v_dot2_f32_bf16 v93, v58, v58, v93
    v_dot2_f32_bf16 v92, v59, v94, v92
    v_dot2_f32_bf16 v93, v59, v59, v93
L_po_f1_done_f:
    s_nop 3
    v_mov_b32 v94, v92
    v_mov_b32 v95, v93
    s_nop 0
    v_permlane32_swap_b32 v92, v94
    v_permlane32_swap_b32 v93, v95
    v_add_f32 v92, v92, v94
    v_add_f32 v93, v93, v95
    v_lshrrev_b32 v94, 1, v0
    v_and_b32 v94, 0xff, v94
    s_lshl_b32 s72, s3, 8
    v_add_u32 v95, s72, v94
    ds_write_b64 v95, v[92:93] offset:61440
    s_waitcnt lgkmcnt(0)
    s_barrier
    ds_read_b64 v[44:45], v94 offset:61440
    ds_read_b64 v[46:47], v94 offset:61696
    ds_read_b64 v[48:49], v94 offset:61952
    ds_read_b64 v[50:51], v94 offset:62208
    s_waitcnt lgkmcnt(0)
    v_add_f32 v44, v44, v46
    v_add_f32 v45, v45, v47
    v_add_f32 v48, v48, v50
    v_add_f32 v49, v49, v51
    v_add_f32 v44, v44, v48
    v_add_f32 v45, v45, v49
    v_mul_f32 v44, 0x3acccccd, v44
    v_mul_f32 v45, 0x3acccccd, v45
    v_fma_f32 v45, -v44, v44, v45
    v_max_f32 v45, 0, v45
    v_add_f32 v45, 0x3727c5ac, v45
    v_rsq_f32 v45, v45
    s_nop 0
    v_fma_f32 v76, -v44, v14, v76
    v_mul_f32 v76, v76, v45
    v_fma_f32 v77, -v44, v15, v77
    v_mul_f32 v77, v77, v45
    v_fma_f32 v78, -v44, v16, v78
    v_mul_f32 v78, v78, v45
    v_fma_f32 v79, -v44, v17, v79
    v_mul_f32 v79, v79, v45
    v_fma_f32 v80, -v44, v18, v80
    v_mul_f32 v80, v80, v45
    v_fma_f32 v81, -v44, v19, v81
    v_mul_f32 v81, v81, v45
    v_fma_f32 v82, -v44, v20, v82
    v_mul_f32 v82, v82, v45
    v_fma_f32 v83, -v44, v21, v83
    v_mul_f32 v83, v83, v45
    v_fma_f32 v84, -v44, v22, v84
    v_mul_f32 v84, v84, v45
    v_fma_f32 v85, -v44, v23, v85
    v_mul_f32 v85, v85, v45
    v_fma_f32 v86, -v44, v24, v86
    v_mul_f32 v86, v86, v45
    v_fma_f32 v87, -v44, v25, v87
    v_mul_f32 v87, v87, v45
    v_fma_f32 v88, -v44, v26, v88
    v_mul_f32 v88, v88, v45
    v_fma_f32 v89, -v44, v27, v89
    v_mul_f32 v89, v89, v45
    v_fma_f32 v90, -v44, v28, v90
    v_mul_f32 v90, v90, v45
    v_fma_f32 v91, -v44, v29, v91
    v_mul_f32 v91, v91, v45
    v_mul_f32 v76, 0xbfb8aa3b, v76
    v_mul_f32 v77, 0xbfb8aa3b, v77
    v_mul_f32 v78, 0xbfb8aa3b, v78
    v_mul_f32 v79, 0xbfb8aa3b, v79
    v_mul_f32 v80, 0xbfb8aa3b, v80
    v_mul_f32 v81, 0xbfb8aa3b, v81
    v_mul_f32 v82, 0xbfb8aa3b, v82
    v_mul_f32 v83, 0xbfb8aa3b, v83
    v_exp_f32 v76, v76
    v_exp_f32 v77, v77
    v_exp_f32 v78, v78
    v_exp_f32 v79, v79
    v_exp_f32 v80, v80
    v_exp_f32 v81, v81
    v_exp_f32 v82, v82
    v_exp_f32 v83, v83
    s_nop 0
    v_add_f32 v76, 1.0, v76
    v_add_f32 v77, 1.0, v77
    v_add_f32 v78, 1.0, v78
    v_add_f32 v79, 1.0, v79
    v_add_f32 v80, 1.0, v80
    v_add_f32 v81, 1.0, v81
    v_add_f32 v82, 1.0, v82
    v_add_f32 v83, 1.0, v83
    v_rcp_f32 v76, v76
    v_rcp_f32 v77, v77
    v_rcp_f32 v78, v78
    v_rcp_f32 v79, v79
    v_rcp_f32 v80, v80
    v_rcp_f32 v81, v81
    v_rcp_f32 v82, v82
    v_rcp_f32 v83, v83
    s_nop 0
    v_mul_f32 v76, v76, v84
    v_mul_f32 v77, v77, v85
    v_mul_f32 v78, v78, v86
    v_mul_f32 v79, v79, v87
    v_mul_f32 v80, v80, v88
    v_mul_f32 v81, v81, v89
    v_mul_f32 v82, v82, v90
    v_mul_f32 v83, v83, v91
    v_cvt_pk_bf16_f32 v44, v76, v77
    v_cvt_pk_bf16_f32 v45, v78, v79
    v_cvt_pk_bf16_f32 v46, v80, v81
    v_cvt_pk_bf16_f32 v47, v82, v83
    s_lshl_b32 s72, s3, 10
    v_add_u32 v95, s72, v0
    v_add_u32 v95, 103424, v95
    ds_write_b128 v95, v[44:47]
    s_waitcnt lgkmcnt(0)
    s_barrier
    v_add_u32 v95, 103424, v0
    ds_read_b128 v[44:47], v95 offset:0
    ds_read_b128 v[48:51], v95 offset:1024
    ds_read_b128 v[52:55], v95 offset:2048
    ds_read_b128 v[56:59], v95 offset:3072
    s_waitcnt lgkmcnt(0)
    v_mfma_f32_32x32x16_bf16 v[76:91], a[176:179], v[44:47], 0
    v_mfma_f32_32x32x16_bf16 v[76:91], a[180:183], v[48:51], v[76:91]
    v_mfma_f32_32x32x16_bf16 v[76:91], a[184:187], v[52:55], v[76:91]
    v_mfma_f32_32x32x16_bf16 v[76:91], a[188:191], v[56:59], v[76:91]
    v_mfma_f32_32x32x16_bf16 v[60:75], a[192:195], v[44:47], 0
    v_mfma_f32_32x32x16_bf16 v[60:75], a[196:199], v[48:51], v[60:75]
    v_mfma_f32_32x32x16_bf16 v[60:75], a[200:203], v[52:55], v[60:75]
    s_nop 8
    v_cvt_pk_bf16_f32 v92, v76, v77
    v_cvt_pk_bf16_f32 v93, v78, v79
    v_cvt_pk_bf16_f32 v94, v80, v81
    v_cvt_pk_bf16_f32 v95, v82, v83
    s_add_u32 s72, s68, 1310720
    buffer_store_dwordx4 v[92:95], v4, s[44:47], s72 offen sc1
    v_mfma_f32_32x32x16_bf16 v[60:75], a[204:207], v[56:59], v[60:75]
    v_cvt_pk_bf16_f32 v96, v84, v85
    v_cvt_pk_bf16_f32 v97, v86, v87
    v_cvt_pk_bf16_f32 v98, v88, v89
    v_cvt_pk_bf16_f32 v99, v90, v91
    s_add_u32 s73, s68, 1343488
    buffer_store_dwordx4 v[96:99], v4, s[44:47], s73 offen sc1
    v_mfma_f32_32x32x16_bf16 v[76:91], a[208:211], v[44:47], 0
    v_mfma_f32_32x32x16_bf16 v[76:91], a[212:215], v[48:51], v[76:91]
    v_mfma_f32_32x32x16_bf16 v[76:91], a[216:219], v[52:55], v[76:91]
    s_nop 2
    v_cvt_pk_bf16_f32 v92, v60, v61
    v_cvt_pk_bf16_f32 v93, v62, v63
    v_cvt_pk_bf16_f32 v94, v64, v65
    v_cvt_pk_bf16_f32 v95, v66, v67
    s_add_u32 s72, s68, 1376256
    buffer_store_dwordx4 v[92:95], v4, s[44:47], s72 offen sc1
    v_mfma_f32_32x32x16_bf16 v[76:91], a[220:223], v[56:59], v[76:91]
    v_cvt_pk_bf16_f32 v96, v68, v69
    v_cvt_pk_bf16_f32 v97, v70, v71
    v_cvt_pk_bf16_f32 v98, v72, v73
    v_cvt_pk_bf16_f32 v99, v74, v75
    s_add_u32 s73, s68, 1409024
    buffer_store_dwordx4 v[96:99], v4, s[44:47], s73 offen sc1
    v_mfma_f32_32x32x16_bf16 v[60:75], a[224:227], v[44:47], 0
    v_mfma_f32_32x32x16_bf16 v[60:75], a[228:231], v[48:51], v[60:75]
    v_mfma_f32_32x32x16_bf16 v[60:75], a[232:235], v[52:55], v[60:75]
    s_nop 2
    v_cvt_pk_bf16_f32 v92, v76, v77
    v_cvt_pk_bf16_f32 v93, v78, v79
    v_cvt_pk_bf16_f32 v94, v80, v81
    v_cvt_pk_bf16_f32 v95, v82, v83
    s_add_u32 s72, s68, 1441792
    buffer_store_dwordx4 v[92:95], v4, s[44:47], s72 offen sc1
    v_mfma_f32_32x32x16_bf16 v[60:75], a[236:239], v[56:59], v[60:75]
    v_cvt_pk_bf16_f32 v96, v84, v85
    v_cvt_pk_bf16_f32 v97, v86, v87
    v_cvt_pk_bf16_f32 v98, v88, v89
    v_cvt_pk_bf16_f32 v99, v90, v91
    s_add_u32 s73, s68, 1474560
    buffer_store_dwordx4 v[96:99], v4, s[44:47], s73 offen sc1
    v_mfma_f32_32x32x16_bf16 v[76:91], a[240:243], v[44:47], 0
    v_mfma_f32_32x32x16_bf16 v[76:91], a[244:247], v[48:51], v[76:91]
    v_mfma_f32_32x32x16_bf16 v[76:91], a[248:251], v[52:55], v[76:91]
    s_nop 2
    v_cvt_pk_bf16_f32 v92, v60, v61
    v_cvt_pk_bf16_f32 v93, v62, v63
    v_cvt_pk_bf16_f32 v94, v64, v65
    v_cvt_pk_bf16_f32 v95, v66, v67
    s_add_u32 s72, s68, 1507328
    buffer_store_dwordx4 v[92:95], v4, s[44:47], s72 offen sc1
    v_mfma_f32_32x32x16_bf16 v[76:91], a[252:255], v[56:59], v[76:91]
    v_cvt_pk_bf16_f32 v96, v68, v69
    v_cvt_pk_bf16_f32 v97, v70, v71
    v_cvt_pk_bf16_f32 v98, v72, v73
    v_cvt_pk_bf16_f32 v99, v74, v75
    s_add_u32 s73, s68, 1540096
    buffer_store_dwordx4 v[96:99], v4, s[44:47], s73 offen sc1
    s_nop 11
    v_cvt_pk_bf16_f32 v92, v76, v77
    v_cvt_pk_bf16_f32 v93, v78, v79
    v_cvt_pk_bf16_f32 v94, v80, v81
    v_cvt_pk_bf16_f32 v95, v82, v83
    s_add_u32 s72, s68, 1572864
    buffer_store_dwordx4 v[92:95], v4, s[44:47], s72 offen sc1
    v_cvt_pk_bf16_f32 v96, v84, v85
    v_cvt_pk_bf16_f32 v97, v86, v87
    v_cvt_pk_bf16_f32 v98, v88, v89
    v_cvt_pk_bf16_f32 v99, v90, v91
    s_add_u32 s73, s68, 1605632
    buffer_store_dwordx4 v[96:99], v4, s[44:47], s73 offen sc1
    s_branch L_po_ffn_done_f
L_po_noffn_f:
L_po_ffn_done_f:
    s_waitcnt vmcnt(0)
    s_barrier
    s_cmp_lg_u32 s3, 0
    s_cbranch_scc1 L_fs_13_f
    s_lshl_b32 s72, s65, 2
    s_add_u32 s72, s72, s69
    s_add_u32 s72, s72, 256
    v_mov_b32 v40, s67
    v_mov_b32 v41, 0
    s_mov_b64 exec, 1
    buffer_store_dword v40, v41, s[44:47], s72 offen sc1
    s_mov_b64 exec, -1
L_fs_13_f:
    v_lshrrev_b32 v41, 2, v0
    v_mov_b32 v42, 0x7fffff00
    v_cmp_gt_u32 vcc, 112, v41
    s_add_u32 s72, s69, 256
    s_nop 0
    v_cndmask_b32 v41, v42, v41, vcc
    s_mov_b64 s[6:7], vcc
    s_mov_b32 s12, 0
L_fw_14_f:
    buffer_load_dword v42, v41, s[44:47], s72 offen sc1
    s_waitcnt vmcnt(0)
    v_cmp_gt_u32 vcc, s67, v42
    s_add_u32 s12, s12, 1
    s_and_b64 vcc, vcc, s[6:7]
    s_cmp_gt_u32 s12, 100000
    s_cbranch_scc1 L_fw_14_out_f
    s_cbranch_vccnz L_fw_14_f
L_fw_14_out_f:
    s_add_u32 s72, s68, 1310720
    s_add_u32 s73, s72, 4096
    buffer_load_dwordx4 v[44:47], v5, s[44:47], s72 offen offset:0 sc1
    buffer_load_dwordx4 v[48:51], v5, s[44:47], s72 offen offset:1024 sc1
    buffer_load_dwordx4 v[52:55], v5, s[44:47], s72 offen offset:2048 sc1
    buffer_load_dwordx4 v[56:59], v5, s[44:47], s72 offen offset:3072 sc1
    buffer_load_dwordx4 v[60:63], v5, s[44:47], s73 offen offset:0 sc1
    buffer_load_dwordx4 v[64:67], v5, s[44:47], s73 offen offset:1024 sc1
    buffer_load_dwordx4 v[68:71], v5, s[44:47], s73 offen offset:2048 sc1
    s_waitcnt vmcnt(6)
    v_mfma_f32_16x16x32_bf16 v[104:107], v[10:13], v[44:47], 0
    s_waitcnt vmcnt(5)
    v_mfma_f32_16x16x32_bf16 v[104:107], v[10:13], v[48:51], v[104:107]
    s_waitcnt vmcnt(4)
    v_mfma_f32_16x16x32_bf16 v[104:107], v[10:13], v[52:55], v[104:107]
    s_waitcnt vmcnt(3)
    v_mfma_f32_16x16x32_bf16 v[104:107], v[10:13], v[56:59], v[104:107]
    s_waitcnt vmcnt(2)
    v_mfma_f32_16x16x32_bf16 v[104:107], v[10:13], v[60:63], v[104:107]
    s_waitcnt vmcnt(1)
    v_mfma_f32_16x16x32_bf16 v[104:107], v[10:13], v[64:67], v[104:107]
    s_waitcnt vmcnt(0)
    v_mfma_f32_16x16x32_bf16 v[104:107], v[10:13], v[68:71], v[104:107]
    s_nop 7
    v_add_f32 v76, v30, v104
    v_add_f32 v77, v31, v105
    v_add_f32 v78, v32, v106
    v_add_f32 v79, v33, v107
    v_cvt_pk_bf16_f32 v80, v76, v77
    v_cvt_pk_bf16_f32 v81, v78, v79
    s_mul_i32 s72, s66, 40960
    buffer_store_dwordx2 v[80:81], v8, s[52:55], s72 offen
    s_cmp_lg_u32 s3, 0
    s_cbranch_scc1 L_po_r2done_f
    s_add_u32 s72, s68, 1343488
    s_add_u32 s73, s72, 4096
    buffer_load_dwordx4 v[44:47], v5, s[44:47], s72 offen offset:0 sc1
    buffer_load_dwordx4 v[48:51], v5, s[44:47], s72 offen offset:1024 sc1
    buffer_load_dwordx4 v[52:55], v5, s[44:47], s72 offen offset:2048 sc1
    buffer_load_dwordx4 v[56:59], v5, s[44:47], s72 offen offset:3072 sc1
    buffer_load_dwordx4 v[60:63], v5, s[44:47], s73 offen offset:0 sc1
    buffer_load_dwordx4 v[64:67], v5, s[44:47], s73 offen offset:1024 sc1
    buffer_load_dwordx4 v[68:71], v5, s[44:47], s73 offen offset:2048 sc1
    s_waitcnt vmcnt(6)
    v_mfma_f32_16x16x32_bf16 v[104:107], v[10:13], v[44:47], 0
    s_waitcnt vmcnt(5)
    v_mfma_f32_16x16x32_bf16 v[104:107], v[10:13], v[48:51], v[104:107]
    s_waitcnt vmcnt(4)
    v_mfma_f32_16x16x32_bf16 v[104:107], v[10:13], v[52:55], v[104:107]
    s_waitcnt vmcnt(3)
    v_mfma_f32_16x16x32_bf16 v[104:107], v[10:13], v[56:59], v[104:107]
    s_waitcnt vmcnt(2)
    v_mfma_f32_16x16x32_bf16 v[104:107], v[10:13], v[60:63], v[104:107]
    s_waitcnt vmcnt(1)
    v_mfma_f32_16x16x32_bf16 v[104:107], v[10:13], v[64:67], v[104:107]
    s_waitcnt vmcnt(0)
    v_mfma_f32_16x16x32_bf16 v[104:107], v[10:13], v[68:71], v[104:107]
    s_nop 7
    v_add_f32 v76, v34, v104
    v_add_f32 v77, v35, v105
    v_add_f32 v78, v36, v106
    v_add_f32 v79, v37, v107
    v_cvt_pk_bf16_f32 v80, v76, v77
    v_cvt_pk_bf16_f32 v81, v78, v79
    s_mul_i32 s72, s66, 40960
    buffer_store_dwordx2 v[80:81], v9, s[52:55], s72 offen
L_po_r2done_f:
    s_xor_b32 s78, s78, 24576
    s_add_u32 s66, s66, 4
    s_add_u32 s67, s67, 1
    s_waitcnt vmcnt(0)
    s_barrier
    s_cmp_lt_u32 s66, 64
    s_cbranch_scc1 L_po_loop_f
    s_branch L_po_fin
L_po_fin:
    s_branch L_end
L_bulk:
    s_cmp_lg_u32 s3, 0
    s_cbranch_scc1 L_cnt_18
    s_lshl_b32 s6, s11, 2
    s_add_u32 s6, s6, 128
    v_mov_b32 v2, s6
    v_mov_b32 v3, 1
    s_mov_b64 exec, 1
    global_atomic_add v2, v3, s[40:41] sc1
    s_mov_b64 exec, -1
L_cnt_18:
    s_sub_u32 s60, s4, 5
    s_mov_b32 s61, s5
    s_mov_b32 s14, s22
    s_mov_b32 s15, s23
    s_cmp_eq_u32 s60, 1
    s_cselect_b32 s14, s24, s14
    s_cselect_b32 s15, s25, s15
    s_cmp_eq_u32 s60, 2
    s_cselect_b32 s14, s20, s14
    s_cselect_b32 s15, s21, s15
    s_lshl_b32 s6, s61, 8
    s_add_u32 s48, s14, s6
    s_addc_u32 s49, s15, 0
    s_sub_u32 s50, 5242880, s6
    s_mov_b32 s51, 0x20000
    v_and_b32 v1, 63, v0
    v_lshrrev_b32 v2, 4, v1
    v_and_b32 v3, 15, v1
    v_lshlrev_b32 v6, 2, v2
    v_xor_b32 v6, v6, v3
    v_lshlrev_b32 v6, 4, v6
    v_lshl_add_u32 v4, v2, 13, v6
    v_xor_b32 v5, 0x80, v4
    v_lshrrev_b32 v8, 2, v3
    v_and_b32 v9, 3, v3
    v_lshrrev_b32 v10, 1, v2
    v_lshl_add_u32 v11, v10, 3, v8
    v_lshlrev_b32 v11, 8, v11
    v_xor_b32 v12, s3, v8
    v_lshlrev_b32 v12, 2, v12
    v_and_b32 v13, 1, v2
    v_lshl_add_u32 v12, v13, 1, v12
    v_lshrrev_b32 v13, 1, v9
    v_add_u32 v12, v12, v13
    v_lshl_add_u32 v11, v12, 4, v11
    v_and_b32 v13, 1, v9
    v_lshl_add_u32 v6, v13, 3, v11
    v_xor_b32 v7, 0x80, v6
    s_lshl_b32 s6, s3, 3
    s_lshl_b32 s7, s6, 15
    s_add_u32 s7, s7, 0
    s_lshl_b32 s8, s6, 10
    s_add_u32 s8, s8, 0
    s_mov_b32 m0, s8
    s_add_u32 s8, s8, 1024
    buffer_load_dwordx4 v4, s[48:51], s7 offen lds
    s_add_u32 s7, s7, 32768
    s_mov_b32 m0, s8
    s_add_u32 s8, s8, 1024
    buffer_load_dwordx4 v4, s[48:51], s7 offen lds
    s_add_u32 s7, s7, 32768
    s_mov_b32 m0, s8
    s_add_u32 s8, s8, 1024
    buffer_load_dwordx4 v4, s[48:51], s7 offen lds
    s_add_u32 s7, s7, 32768
    s_mov_b32 m0, s8
    s_add_u32 s8, s8, 1024
    buffer_load_dwordx4 v4, s[48:51], s7 offen lds
    s_add_u32 s7, s7, 32768
    s_mov_b32 m0, s8
    s_add_u32 s8, s8, 1024
    buffer_load_dwordx4 v5, s[48:51], s7 offen lds
    s_add_u32 s7, s7, 32768
    s_mov_b32 m0, s8
    s_add_u32 s8, s8, 1024
    buffer_load_dwordx4 v5, s[48:51], s7 offen lds
    s_add_u32 s7, s7, 32768
    s_mov_b32 m0, s8
    s_add_u32 s8, s8, 1024
    buffer_load_dwordx4 v5, s[48:51], s7 offen lds
    s_add_u32 s7, s7, 32768
    s_mov_b32 m0, s8
    s_add_u32 s8, s8, 1024
    buffer_load_dwordx4 v5, s[48:51], s7 offen lds
    s_add_u32 s7, s7, 32768
    s_lshl_b32 s6, s3, 3
    s_lshl_b32 s7, s6, 15
    s_add_u32 s7, s7, 1048576
    s_lshl_b32 s8, s6, 10
    s_add_u32 s8, s8, 32768
    s_mov_b32 m0, s8
    s_add_u32 s8, s8, 1024
    buffer_load_dwordx4 v4, s[48:51], s7 offen lds
    s_add_u32 s7, s7, 32768
    s_mov_b32 m0, s8
    s_add_u32 s8, s8, 1024
    buffer_load_dwordx4 v4, s[48:51], s7 offen lds
    s_add_u32 s7, s7, 32768
    s_mov_b32 m0, s8
    s_add_u32 s8, s8, 1024
    buffer_load_dwordx4 v4, s[48:51], s7 offen lds
    s_add_u32 s7, s7, 32768
    s_mov_b32 m0, s8
    s_add_u32 s8, s8, 1024
    buffer_load_dwordx4 v4, s[48:51], s7 offen lds
    s_add_u32 s7, s7, 32768
    s_mov_b32 m0, s8
    s_add_u32 s8, s8, 1024
    buffer_load_dwordx4 v5, s[48:51], s7 offen lds
    s_add_u32 s7, s7, 32768
    s_mov_b32 m0, s8
    s_add_u32 s8, s8, 1024
    buffer_load_dwordx4 v5, s[48:51], s7 offen lds
    s_add_u32 s7, s7, 32768
    s_mov_b32 m0, s8
    s_add_u32 s8, s8, 1024
    buffer_load_dwordx4 v5, s[48:51], s7 offen lds
    s_add_u32 s7, s7, 32768
    s_mov_b32 m0, s8
    s_add_u32 s8, s8, 1024
    buffer_load_dwordx4 v5, s[48:51], s7 offen lds
    s_add_u32 s7, s7, 32768
    s_waitcnt vmcnt(8)
    s_barrier
    ds_read_b64_tr_b16 v[96:97], v6 offset:0
    ds_read_b64_tr_b16 v[98:99], v6 offset:1024
    ds_read_b64_tr_b16 v[100:101], v7 offset:4096
    ds_read_b64_tr_b16 v[102:103], v7 offset:5120
    ds_read_b64_tr_b16 v[104:105], v6 offset:8192
    ds_read_b64_tr_b16 v[106:107], v6 offset:9216
    ds_read_b64_tr_b16 v[108:109], v7 offset:12288
    ds_read_b64_tr_b16 v[110:111], v7 offset:13312
    s_waitcnt lgkmcnt(0)
    ds_read_b64_tr_b16 v[112:113], v6 offset:16384
    ds_read_b64_tr_b16 v[114:115], v6 offset:17408
    ds_read_b64_tr_b16 v[116:117], v7 offset:20480
    ds_read_b64_tr_b16 v[118:119], v7 offset:21504
    ds_read_b64_tr_b16 v[120:121], v6 offset:24576
    ds_read_b64_tr_b16 v[122:123], v6 offset:25600
    ds_read_b64_tr_b16 v[124:125], v7 offset:28672
    ds_read_b64_tr_b16 v[126:127], v7 offset:29696
    s_waitcnt lgkmcnt(0)
    s_barrier
    s_lshl_b32 s6, s3, 3
    s_lshl_b32 s7, s6, 15
    s_add_u32 s7, s7, 2097152
    s_lshl_b32 s8, s6, 10
    s_add_u32 s8, s8, 0
    s_mov_b32 m0, s8
    s_add_u32 s8, s8, 1024
    buffer_load_dwordx4 v4, s[48:51], s7 offen lds
    s_add_u32 s7, s7, 32768
    s_mov_b32 m0, s8
    s_add_u32 s8, s8, 1024
    buffer_load_dwordx4 v4, s[48:51], s7 offen lds
    s_add_u32 s7, s7, 32768
    s_mov_b32 m0, s8
    s_add_u32 s8, s8, 1024
    buffer_load_dwordx4 v4, s[48:51], s7 offen lds
    s_add_u32 s7, s7, 32768
    s_mov_b32 m0, s8
    s_add_u32 s8, s8, 1024
    buffer_load_dwordx4 v4, s[48:51], s7 offen lds
    s_add_u32 s7, s7, 32768
    s_mov_b32 m0, s8
    s_add_u32 s8, s8, 1024
    buffer_load_dwordx4 v5, s[48:51], s7 offen lds
    s_add_u32 s7, s7, 32768
    s_mov_b32 m0, s8
    s_add_u32 s8, s8, 1024
    buffer_load_dwordx4 v5, s[48:51], s7 offen lds
    s_add_u32 s7, s7, 32768
    s_mov_b32 m0, s8
    s_add_u32 s8, s8, 1024
    buffer_load_dwordx4 v5, s[48:51], s7 offen lds
    s_add_u32 s7, s7, 32768
    s_mov_b32 m0, s8
    s_add_u32 s8, s8, 1024
    buffer_load_dwordx4 v5, s[48:51], s7 offen lds
    s_add_u32 s7, s7, 32768
    s_waitcnt vmcnt(8)
    s_barrier
    ds_read_b64_tr_b16 v[128:129], v6 offset:32768
    ds_read_b64_tr_b16 v[130:131], v6 offset:33792
    ds_read_b64_tr_b16 v[132:133], v7 offset:36864
    ds_read_b64_tr_b16 v[134:135], v7 offset:37888
    ds_read_b64_tr_b16 v[136:137], v6 offset:40960
    ds_read_b64_tr_b16 v[138:139], v6 offset:41984
    ds_read_b64_tr_b16 v[140:141], v7 offset:45056
    ds_read_b64_tr_b16 v[142:143], v7 offset:46080
    s_waitcnt lgkmcnt(0)
    ds_read_b64_tr_b16 v[144:145], v6 offset:49152
    ds_read_b64_tr_b16 v[146:147], v6 offset:50176
    ds_read_b64_tr_b16 v[148:149], v7 offset:53248
    ds_read_b64_tr_b16 v[150:151], v7 offset:54272
    ds_read_b64_tr_b16 v[152:153], v6 offset:57344
    ds_read_b64_tr_b16 v[154:155], v6 offset:58368
    ds_read_b64_tr_b16 v[156:157], v7 offset:61440
    ds_read_b64_tr_b16 v[158:159], v7 offset:62464
    s_waitcnt lgkmcnt(0)
    s_barrier
    s_lshl_b32 s6, s3, 3
    s_lshl_b32 s7, s6, 15
    s_add_u32 s7, s7, 3145728
    s_lshl_b32 s8, s6, 10
    s_add_u32 s8, s8, 32768
    s_mov_b32 m0, s8
    s_add_u32 s8, s8, 1024
    buffer_load_dwordx4 v4, s[48:51], s7 offen lds
    s_add_u32 s7, s7, 32768
    s_mov_b32 m0, s8
    s_add_u32 s8, s8, 1024
    buffer_load_dwordx4 v4, s[48:51], s7 offen lds
    s_add_u32 s7, s7, 32768
    s_mov_b32 m0, s8
    s_add_u32 s8, s8, 1024
    buffer_load_dwordx4 v4, s[48:51], s7 offen lds
    s_add_u32 s7, s7, 32768
    s_mov_b32 m0, s8
    s_add_u32 s8, s8, 1024
    buffer_load_dwordx4 v4, s[48:51], s7 offen lds
    s_add_u32 s7, s7, 32768
    s_mov_b32 m0, s8
    s_add_u32 s8, s8, 1024
    buffer_load_dwordx4 v5, s[48:51], s7 offen lds
    s_add_u32 s7, s7, 32768
    s_mov_b32 m0, s8
    s_add_u32 s8, s8, 1024
    buffer_load_dwordx4 v5, s[48:51], s7 offen lds
    s_add_u32 s7, s7, 32768
    s_mov_b32 m0, s8
    s_add_u32 s8, s8, 1024
    buffer_load_dwordx4 v5, s[48:51], s7 offen lds
    s_add_u32 s7, s7, 32768
    s_mov_b32 m0, s8
    s_add_u32 s8, s8, 1024
    buffer_load_dwordx4 v5, s[48:51], s7 offen lds
    s_add_u32 s7, s7, 32768
    s_waitcnt vmcnt(8)
    s_barrier
    ds_read_b64_tr_b16 v[160:161], v6 offset:0
    ds_read_b64_tr_b16 v[162:163], v6 offset:1024
    ds_read_b64_tr_b16 v[164:165], v7 offset:4096
    ds_read_b64_tr_b16 v[166:167], v7 offset:5120
    ds_read_b64_tr_b16 v[168:169], v6 offset:8192
    ds_read_b64_tr_b16 v[170:171], v6 offset:9216
    ds_read_b64_tr_b16 v[172:173], v7 offset:12288
    ds_read_b64_tr_b16 v[174:175], v7 offset:13312
    s_waitcnt lgkmcnt(0)
    ds_read_b64_tr_b16 v[176:177], v6 offset:16384
    ds_read_b64_tr_b16 v[178:179], v6 offset:17408
    ds_read_b64_tr_b16 v[180:181], v7 offset:20480
    ds_read_b64_tr_b16 v[182:183], v7 offset:21504
    ds_read_b64_tr_b16 v[184:185], v6 offset:24576
    ds_read_b64_tr_b16 v[186:187], v6 offset:25600
    ds_read_b64_tr_b16 v[188:189], v7 offset:28672
    ds_read_b64_tr_b16 v[190:191], v7 offset:29696
    s_waitcnt lgkmcnt(0)
    s_barrier
    s_lshl_b32 s6, s3, 3
    s_lshl_b32 s7, s6, 15
    s_add_u32 s7, s7, 4194304
    s_lshl_b32 s8, s6, 10
    s_add_u32 s8, s8, 0
    s_mov_b32 m0, s8
    s_add_u32 s8, s8, 1024
    buffer_load_dwordx4 v4, s[48:51], s7 offen lds
    s_add_u32 s7, s7, 32768
    s_mov_b32 m0, s8
    s_add_u32 s8, s8, 1024
    buffer_load_dwordx4 v4, s[48:51], s7 offen lds
    s_add_u32 s7, s7, 32768
    s_mov_b32 m0, s8
    s_add_u32 s8, s8, 1024
    buffer_load_dwordx4 v4, s[48:51], s7 offen lds
    s_add_u32 s7, s7, 32768
    s_mov_b32 m0, s8
    s_add_u32 s8, s8, 1024
    buffer_load_dwordx4 v4, s[48:51], s7 offen lds
    s_add_u32 s7, s7, 32768
    s_mov_b32 m0, s8
    s_add_u32 s8, s8, 1024
    buffer_load_dwordx4 v5, s[48:51], s7 offen lds
    s_add_u32 s7, s7, 32768
    s_mov_b32 m0, s8
    s_add_u32 s8, s8, 1024
    buffer_load_dwordx4 v5, s[48:51], s7 offen lds
    s_add_u32 s7, s7, 32768
    s_mov_b32 m0, s8
    s_add_u32 s8, s8, 1024
    buffer_load_dwordx4 v5, s[48:51], s7 offen lds
    s_add_u32 s7, s7, 32768
    s_mov_b32 m0, s8
    s_add_u32 s8, s8, 1024
    buffer_load_dwordx4 v5, s[48:51], s7 offen lds
    s_add_u32 s7, s7, 32768
    s_waitcnt vmcnt(8)
    s_barrier
    ds_read_b64_tr_b16 v[192:193], v6 offset:32768
    ds_read_b64_tr_b16 v[194:195], v6 offset:33792
    ds_read_b64_tr_b16 v[196:197], v7 offset:36864
    ds_read_b64_tr_b16 v[198:199], v7 offset:37888
    ds_read_b64_tr_b16 v[200:201], v6 offset:40960
    ds_read_b64_tr_b16 v[202:203], v6 offset:41984
    ds_read_b64_tr_b16 v[204:205], v7 offset:45056
    ds_read_b64_tr_b16 v[206:207], v7 offset:46080
    s_waitcnt lgkmcnt(0)
    ds_read_b64_tr_b16 v[208:209], v6 offset:49152
    ds_read_b64_tr_b16 v[210:211], v6 offset:50176
    ds_read_b64_tr_b16 v[212:213], v7 offset:53248
    ds_read_b64_tr_b16 v[214:215], v7 offset:54272
    ds_read_b64_tr_b16 v[216:217], v6 offset:57344
    ds_read_b64_tr_b16 v[218:219], v6 offset:58368
    ds_read_b64_tr_b16 v[220:221], v7 offset:61440
    ds_read_b64_tr_b16 v[222:223], v7 offset:62464
    s_waitcnt lgkmcnt(0)
    s_barrier
    s_waitcnt vmcnt(0)
    s_barrier
    ds_read_b64_tr_b16 v[224:225], v6 offset:0
    ds_read_b64_tr_b16 v[226:227], v6 offset:1024
    ds_read_b64_tr_b16 v[228:229], v7 offset:4096
    ds_read_b64_tr_b16 v[230:231], v7 offset:5120
    ds_read_b64_tr_b16 v[232:233], v6 offset:8192
    ds_read_b64_tr_b16 v[234:235], v6 offset:9216
    ds_read_b64_tr_b16 v[236:237], v7 offset:12288
    ds_read_b64_tr_b16 v[238:239], v7 offset:13312
    s_waitcnt lgkmcnt(0)
    ds_read_b64_tr_b16 v[240:241], v6 offset:16384
    ds_read_b64_tr_b16 v[242:243], v6 offset:17408
    ds_read_b64_tr_b16 v[244:245], v7 offset:20480
    ds_read_b64_tr_b16 v[246:247], v7 offset:21504
    ds_read_b64_tr_b16 v[248:249], v6 offset:24576
    ds_read_b64_tr_b16 v[250:251], v6 offset:25600
    ds_read_b64_tr_b16 v[252:253], v7 offset:28672
    ds_read_b64_tr_b16 v[254:255], v7 offset:29696
    s_waitcnt lgkmcnt(0)
    s_barrier
    v_and_b32 v8, 31, v1
    v_lshrrev_b32 v9, 5, v1
    v_lshrrev_b32 v10, 4, v8
    v_and_b32 v11, 15, v8
    v_lshlrev_b32 v12, 10, v10
    v_lshl_add_u32 v12, v11, 4, v12
    v_lshl_add_u32 v12, v9, 8, v12
    s_lshl_b32 s6, s3, 11
    v_add_u32 v8, s6, v12
    s_mov_b32 s64, 0x2000000
    s_cmp_eq_u32 s60, 1
    s_cselect_b32 s64, 0x3000000, s64
    s_cmp_eq_u32 s60, 2
    s_cselect_b32 s64, 0x1000000, s64
    s_lshl_b32 s6, s61, 13
    s_add_u32 s64, s64, s6
    s_add_u32 s6, s60, 1
    s_cmp_eq_u32 s60, 2
    s_cselect_b32 s6, 0, s6
    s_lshl_b32 s6, s6, 2
    s_lshl_b32 s66, s61, 7
    s_add_u32 s66, s66, s6
    s_add_u32 s66, s66, 0x400
    v_lshlrev_b32 v9, 4, v1
    v_mov_b32 v10, 0
    s_lshl_b32 s6, s11, 2
    s_add_u32 s6, s6, 128
    v_mov_b32 v2, s6
    s_mov_b32 s12, 0
L_winit_19:
    global_load_dword v3, v2, s[40:41] sc1
    s_waitcnt vmcnt(0)
    v_readfirstlane_b32 s6, v3
    s_add_u32 s12, s12, 1
    s_cmp_ge_u32 s6, 256
    s_cbranch_scc1 L_winit_19_out
    s_sleep 4
    s_cmp_lt_u32 s12, 100000
    s_cbranch_scc1 L_winit_19
L_winit_19_out:
    s_cmp_lg_u32 s11, 0
    s_cbranch_scc1 L_winit_19_ok
    v_mbcnt_lo_u32_b32 v2, -1, 0
    v_mbcnt_hi_u32_b32 v2, -1, v2
    v_and_b32 v2, 7, v2
    v_lshlrev_b32 v2, 2, v2
    global_load_dword v3, v2, s[40:41] sc1
    s_waitcnt vmcnt(0)
    v_cmp_ne_u32 vcc, 32, v3
    s_nop 4
    s_cbranch_vccnz L_fallback
L_winit_19_ok:
    v_lshlrev_b32 v2, 3, v1
    s_mov_b32 s12, 0
L_bulk_wxn:
    buffer_load_dwordx2 v[12:13], v2, s[44:47], 0 offen offset:0 sc1
    s_waitcnt vmcnt(0)
    v_and_b32 v12, v12, v13
    v_cmp_ne_u32 vcc, 1, v12
    s_add_u32 s12, s12, 1
    s_cmp_ge_u32 s12, 100000
    s_cbranch_scc1 L_bulk_wxn_out
    s_sleep 2
    s_cbranch_vccnz L_bulk_wxn
L_bulk_wxn_out:
    s_mov_b32 s62, 0
    s_mov_b32 s63, 0
    s_mul_i32 s7, s62, 40960
    s_mul_i32 s8, s3, 10240
    s_add_u32 s7, s7, s8
    s_add_u32 s7, s7, 0x300000
    s_add_u32 s8, s8, s63
    s_mov_b32 m0, s8
    s_add_u32 s8, s8, 1024
    buffer_load_dwordx4 v9, s[44:47], s7 offen lds
    s_add_u32 s7, s7, 1024
    s_mov_b32 m0, s8
    s_add_u32 s8, s8, 1024
    buffer_load_dwordx4 v9, s[44:47], s7 offen lds
    s_add_u32 s7, s7, 1024
    s_mov_b32 m0, s8
    s_add_u32 s8, s8, 1024
    buffer_load_dwordx4 v9, s[44:47], s7 offen lds
    s_add_u32 s7, s7, 1024
    s_mov_b32 m0, s8
    s_add_u32 s8, s8, 1024
    buffer_load_dwordx4 v9, s[44:47], s7 offen lds
    s_add_u32 s7, s7, 1024
    s_mov_b32 m0, s8
    s_add_u32 s8, s8, 1024
    buffer_load_dwordx4 v9, s[44:47], s7 offen lds
    s_add_u32 s7, s7, 1024
    s_mov_b32 m0, s8
    s_add_u32 s8, s8, 1024
    buffer_load_dwordx4 v9, s[44:47], s7 offen lds
    s_add_u32 s7, s7, 1024
    s_mov_b32 m0, s8
    s_add_u32 s8, s8, 1024
    buffer_load_dwordx4 v9, s[44:47], s7 offen lds
    s_add_u32 s7, s7, 1024
    s_mov_b32 m0, s8
    s_add_u32 s8, s8, 1024
    buffer_load_dwordx4 v9, s[44:47], s7 offen lds
    s_add_u32 s7, s7, 1024
    s_mov_b32 m0, s8
    s_add_u32 s8, s8, 1024
    buffer_load_dwordx4 v9, s[44:47], s7 offen lds
    s_add_u32 s7, s7, 1024
    s_mov_b32 m0, s8
    s_add_u32 s8, s8, 1024
    buffer_load_dwordx4 v9, s[44:47], s7 offen lds
    s_add_u32 s7, s7, 1024
    s_mov_b32 s9, 1
    s_mov_b32 s67, 40960
    s_mul_i32 s7, s9, 40960
    s_mul_i32 s8, s3, 10240
    s_add_u32 s7, s7, s8
    s_add_u32 s7, s7, 0x300000
    s_add_u32 s8, s8, s67
    s_mov_b32 m0, s8
    s_add_u32 s8, s8, 1024
    buffer_load_dwordx4 v9, s[44:47], s7 offen lds
    s_add_u32 s7, s7, 1024
    s_mov_b32 m0, s8
    s_add_u32 s8, s8, 1024
    buffer_load_dwordx4 v9, s[44:47], s7 offen lds
    s_add_u32 s7, s7, 1024
    s_mov_b32 m0, s8
    s_add_u32 s8, s8, 1024
    buffer_load_dwordx4 v9, s[44:47], s7 offen lds
    s_add_u32 s7, s7, 1024
    s_mov_b32 m0, s8
    s_add_u32 s8, s8, 1024
    buffer_load_dwordx4 v9, s[44:47], s7 offen lds
    s_add_u32 s7, s7, 1024
    s_mov_b32 m0, s8
    s_add_u32 s8, s8, 1024
    buffer_load_dwordx4 v9, s[44:47], s7 offen lds
    s_add_u32 s7, s7, 1024
    s_mov_b32 m0, s8
    s_add_u32 s8, s8, 1024
    buffer_load_dwordx4 v9, s[44:47], s7 offen lds
    s_add_u32 s7, s7, 1024
    s_mov_b32 m0, s8
    s_add_u32 s8, s8, 1024
    buffer_load_dwordx4 v9, s[44:47], s7 offen lds
    s_add_u32 s7, s7, 1024
    s_mov_b32 m0, s8
    s_add_u32 s8, s8, 1024
    buffer_load_dwordx4 v9, s[44:47], s7 offen lds
    s_add_u32 s7, s7, 1024
    s_mov_b32 m0, s8
    s_add_u32 s8, s8, 1024
    buffer_load_dwordx4 v9, s[44:47], s7 offen lds
    s_add_u32 s7, s7, 1024
    s_mov_b32 m0, s8
    s_add_u32 s8, s8, 1024
    buffer_load_dwordx4 v9, s[44:47], s7 offen lds
    s_add_u32 s7, s7, 1024
    s_mov_b32 s67, 81920
    s_waitcnt vmcnt(10)
    s_branch L_bulk_first
L_bulk_loop:
    s_waitcnt vmcnt(12)
L_bulk_first:
    s_barrier
    s_sub_u32 s6, s62, 1
    s_max_i32 s6, s6, 0
    v_mov_b32 v11, s6
    s_cmp_eq_u32 s3, 0
    s_cselect_b64 exec, 1, 0
    s_cbranch_scc0 L_bulk_noprog
    buffer_store_dword v11, v10, s[44:47], s66 offen sc1
L_bulk_noprog:
    s_mov_b64 exec, -1
    s_add_u32 s9, s62, 2
    s_min_u32 s9, s9, 63
    s_mul_i32 s7, s9, 40960
    s_mul_i32 s8, s3, 10240
    s_add_u32 s7, s7, s8
    s_add_u32 s7, s7, 0x300000
    s_add_u32 s8, s8, s67
    s_mov_b32 m0, s8
    s_add_u32 s8, s8, 1024
    buffer_load_dwordx4 v9, s[44:47], s7 offen lds
    s_add_u32 s7, s7, 1024
    s_mov_b32 m0, s8
    s_add_u32 s8, s8, 1024
    buffer_load_dwordx4 v9, s[44:47], s7 offen lds
    s_add_u32 s7, s7, 1024
    s_mov_b32 m0, s8
    s_add_u32 s8, s8, 1024
    buffer_load_dwordx4 v9, s[44:47], s7 offen lds
    s_add_u32 s7, s7, 1024
    s_mov_b32 m0, s8
    s_add_u32 s8, s8, 1024
    buffer_load_dwordx4 v9, s[44:47], s7 offen lds
    s_add_u32 s7, s7, 1024
    s_mov_b32 m0, s8
    s_add_u32 s8, s8, 1024
    buffer_load_dwordx4 v9, s[44:47], s7 offen lds
    s_add_u32 s7, s7, 1024
    s_mov_b32 m0, s8
    s_add_u32 s8, s8, 1024
    buffer_load_dwordx4 v9, s[44:47], s7 offen lds
    s_add_u32 s7, s7, 1024
    s_mov_b32 m0, s8
    s_add_u32 s8, s8, 1024
    buffer_load_dwordx4 v9, s[44:47], s7 offen lds
    s_add_u32 s7, s7, 1024
    s_mov_b32 m0, s8
    s_add_u32 s8, s8, 1024
    buffer_load_dwordx4 v9, s[44:47], s7 offen lds
    s_add_u32 s7, s7, 1024
    s_mov_b32 m0, s8
    s_add_u32 s8, s8, 1024
    buffer_load_dwordx4 v9, s[44:47], s7 offen lds
    s_add_u32 s7, s7, 1024
    s_mov_b32 m0, s8
    s_add_u32 s8, s8, 1024
    buffer_load_dwordx4 v9, s[44:47], s7 offen lds
    s_add_u32 s7, s7, 1024
    v_add_u32 v12, s63, v9
    ds_read_b128 v[16:19], v12 offset:0
    ds_read_b128 v[20:23], v12 offset:1024
    ds_read_b128 v[24:27], v12 offset:2048
    ds_read_b128 v[28:31], v12 offset:3072
    ds_read_b128 v[32:35], v12 offset:4096
    s_cmp_eq_u32 s60, 1
    s_cbranch_scc1 L_bulk_vpath
    ds_read_b128 v[36:39], v12 offset:5120
    s_waitcnt lgkmcnt(5)
    v_mfma_f32_32x32x16_bf16 v[48:63], v[96:99], v[16:19], 0
    ds_read_b128 v[16:19], v12 offset:6144
    s_waitcnt lgkmcnt(5)
    v_mfma_f32_32x32x16_bf16 v[48:63], v[100:103], v[20:23], v[48:63]
    ds_read_b128 v[20:23], v12 offset:7168
    s_waitcnt lgkmcnt(5)
    v_mfma_f32_32x32x16_bf16 v[48:63], v[104:107], v[24:27], v[48:63]
    ds_read_b128 v[24:27], v12 offset:8192
    s_waitcnt lgkmcnt(5)
    v_mfma_f32_32x32x16_bf16 v[48:63], v[108:111], v[28:31], v[48:63]
    ds_read_b128 v[28:31], v12 offset:9216
    s_waitcnt lgkmcnt(5)
    v_mfma_f32_32x32x16_bf16 v[48:63], v[112:115], v[32:35], v[48:63]
    ds_read_b128 v[32:35], v12 offset:10240
    s_waitcnt lgkmcnt(5)
    v_mfma_f32_32x32x16_bf16 v[48:63], v[116:119], v[36:39], v[48:63]
    ds_read_b128 v[36:39], v12 offset:11264
    s_waitcnt lgkmcnt(5)
    v_mfma_f32_32x32x16_bf16 v[48:63], v[120:123], v[16:19], v[48:63]
    ds_read_b128 v[16:19], v12 offset:12288
    s_waitcnt lgkmcnt(5)
    v_mfma_f32_32x32x16_bf16 v[48:63], v[124:127], v[20:23], v[48:63]
    ds_read_b128 v[20:23], v12 offset:13312
    s_waitcnt lgkmcnt(5)
    v_mfma_f32_32x32x16_bf16 v[48:63], v[128:131], v[24:27], v[48:63]
    ds_read_b128 v[24:27], v12 offset:14336
    s_waitcnt lgkmcnt(5)
    v_mfma_f32_32x32x16_bf16 v[48:63], v[132:135], v[28:31], v[48:63]
    ds_read_b128 v[28:31], v12 offset:15360
    s_waitcnt lgkmcnt(5)
    v_mfma_f32_32x32x16_bf16 v[48:63], v[136:139], v[32:35], v[48:63]
    ds_read_b128 v[32:35], v12 offset:16384
    s_waitcnt lgkmcnt(5)
    v_mfma_f32_32x32x16_bf16 v[48:63], v[140:143], v[36:39], v[48:63]
    ds_read_b128 v[36:39], v12 offset:17408
    s_waitcnt lgkmcnt(5)
    v_mfma_f32_32x32x16_bf16 v[48:63], v[144:147], v[16:19], v[48:63]
    ds_read_b128 v[16:19], v12 offset:18432
    s_waitcnt lgkmcnt(5)
    v_mfma_f32_32x32x16_bf16 v[48:63], v[148:151], v[20:23], v[48:63]
    ds_read_b128 v[20:23], v12 offset:19456
    s_waitcnt lgkmcnt(5)
    v_mfma_f32_32x32x16_bf16 v[48:63], v[152:155], v[24:27], v[48:63]
    ds_read_b128 v[24:27], v12 offset:20480
    s_waitcnt lgkmcnt(5)
    v_mfma_f32_32x32x16_bf16 v[48:63], v[156:159], v[28:31], v[48:63]
    ds_read_b128 v[28:31], v12 offset:21504
    s_waitcnt lgkmcnt(5)
    v_mfma_f32_32x32x16_bf16 v[48:63], v[160:163], v[32:35], v[48:63]
    ds_read_b128 v[32:35], v12 offset:22528
    s_waitcnt lgkmcnt(5)
    v_mfma_f32_32x32x16_bf16 v[48:63], v[164:167], v[36:39], v[48:63]
    ds_read_b128 v[36:39], v12 offset:23552
    s_waitcnt lgkmcnt(5)
    v_mfma_f32_32x32x16_bf16 v[48:63], v[168:171], v[16:19], v[48:63]
    ds_read_b128 v[16:19], v12 offset:24576
    s_waitcnt lgkmcnt(5)
    v_mfma_f32_32x32x16_bf16 v[48:63], v[172:175], v[20:23], v[48:63]
    ds_read_b128 v[20:23], v12 offset:25600
    s_waitcnt lgkmcnt(5)
    v_mfma_f32_32x32x16_bf16 v[48:63], v[176:179], v[24:27], v[48:63]
    ds_read_b128 v[24:27], v12 offset:26624
    s_waitcnt lgkmcnt(5)
    v_mfma_f32_32x32x16_bf16 v[48:63], v[180:183], v[28:31], v[48:63]
    ds_read_b128 v[28:31], v12 offset:27648
    s_waitcnt lgkmcnt(5)
    v_mfma_f32_32x32x16_bf16 v[48:63], v[184:187], v[32:35], v[48:63]
    ds_read_b128 v[32:35], v12 offset:28672
    s_waitcnt lgkmcnt(5)
    v_mfma_f32_32x32x16_bf16 v[48:63], v[188:191], v[36:39], v[48:63]
    ds_read_b128 v[36:39], v12 offset:29696
    s_waitcnt lgkmcnt(5)
    v_mfma_f32_32x32x16_bf16 v[48:63], v[192:195], v[16:19], v[48:63]
    ds_read_b128 v[16:19], v12 offset:30720
    s_waitcnt lgkmcnt(5)
    v_mfma_f32_32x32x16_bf16 v[48:63], v[196:199], v[20:23], v[48:63]
    ds_read_b128 v[20:23], v12 offset:31744
    s_waitcnt lgkmcnt(5)
    v_mfma_f32_32x32x16_bf16 v[48:63], v[200:203], v[24:27], v[48:63]
    ds_read_b128 v[24:27], v12 offset:32768
    s_waitcnt lgkmcnt(5)
    v_mfma_f32_32x32x16_bf16 v[48:63], v[204:207], v[28:31], v[48:63]
    ds_read_b128 v[28:31], v12 offset:33792
    s_waitcnt lgkmcnt(5)
    v_mfma_f32_32x32x16_bf16 v[48:63], v[208:211], v[32:35], v[48:63]
    ds_read_b128 v[32:35], v12 offset:34816
    s_waitcnt lgkmcnt(5)
    v_mfma_f32_32x32x16_bf16 v[48:63], v[212:215], v[36:39], v[48:63]
    ds_read_b128 v[36:39], v12 offset:35840
    s_waitcnt lgkmcnt(5)
    v_mfma_f32_32x32x16_bf16 v[48:63], v[216:219], v[16:19], v[48:63]
    ds_read_b128 v[16:19], v12 offset:36864
    s_waitcnt lgkmcnt(5)
    v_mfma_f32_32x32x16_bf16 v[48:63], v[220:223], v[20:23], v[48:63]
    ds_read_b128 v[20:23], v12 offset:37888
    s_waitcnt lgkmcnt(5)
    v_mfma_f32_32x32x16_bf16 v[48:63], v[224:227], v[24:27], v[48:63]
    ds_read_b128 v[24:27], v12 offset:38912
    s_waitcnt lgkmcnt(5)
    v_mfma_f32_32x32x16_bf16 v[48:63], v[228:231], v[28:31], v[48:63]
    ds_read_b128 v[28:31], v12 offset:39936
    s_waitcnt lgkmcnt(5)
    v_mfma_f32_32x32x16_bf16 v[48:63], v[232:235], v[32:35], v[48:63]
    s_waitcnt lgkmcnt(4)
    v_mfma_f32_32x32x16_bf16 v[48:63], v[236:239], v[36:39], v[48:63]
    s_waitcnt lgkmcnt(3)
    v_mfma_f32_32x32x16_bf16 v[48:63], v[240:243], v[16:19], v[48:63]
    s_waitcnt lgkmcnt(2)
    v_mfma_f32_32x32x16_bf16 v[48:63], v[244:247], v[20:23], v[48:63]
    s_waitcnt lgkmcnt(1)
    v_mfma_f32_32x32x16_bf16 v[48:63], v[248:251], v[24:27], v[48:63]
    s_waitcnt lgkmcnt(0)
    v_mfma_f32_32x32x16_bf16 v[48:63], v[252:255], v[28:31], v[48:63]
    s_mul_i32 s6, s62, 262144
    s_add_u32 s6, s6, s64
    s_nop 10
    v_cvt_pk_bf16_f32 v64, v48, v49
    v_cvt_pk_bf16_f32 v65, v50, v51
    v_cvt_pk_bf16_f32 v66, v52, v53
    v_cvt_pk_bf16_f32 v67, v54, v55
    v_cvt_pk_bf16_f32 v68, v56, v57
    v_cvt_pk_bf16_f32 v69, v58, v59
    v_cvt_pk_bf16_f32 v70, v60, v61
    v_cvt_pk_bf16_f32 v71, v62, v63
    buffer_store_dwordx4 v[64:67], v8, s[44:47], s6 offen sc1
    buffer_store_dwordx4 v[68:71], v8, s[44:47], s6 offen offset:512 sc1
    s_branch L_bulk_next
L_bulk_vpath:
    ds_read_b128 v[36:39], v12 offset:5120
    s_waitcnt lgkmcnt(5)
    v_mfma_f32_32x32x16_bf16 v[48:63], v[16:19], v[96:99], 0
    ds_read_b128 v[16:19], v12 offset:6144
    s_waitcnt lgkmcnt(5)
    v_mfma_f32_32x32x16_bf16 v[48:63], v[20:23], v[100:103], v[48:63]
    ds_read_b128 v[20:23], v12 offset:7168
    s_waitcnt lgkmcnt(5)
    v_mfma_f32_32x32x16_bf16 v[48:63], v[24:27], v[104:107], v[48:63]
    ds_read_b128 v[24:27], v12 offset:8192
    s_waitcnt lgkmcnt(5)
    v_mfma_f32_32x32x16_bf16 v[48:63], v[28:31], v[108:111], v[48:63]
    ds_read_b128 v[28:31], v12 offset:9216
    s_waitcnt lgkmcnt(5)
    v_mfma_f32_32x32x16_bf16 v[48:63], v[32:35], v[112:115], v[48:63]
    ds_read_b128 v[32:35], v12 offset:10240
    s_waitcnt lgkmcnt(5)
    v_mfma_f32_32x32x16_bf16 v[48:63], v[36:39], v[116:119], v[48:63]
    ds_read_b128 v[36:39], v12 offset:11264
    s_waitcnt lgkmcnt(5)
    v_mfma_f32_32x32x16_bf16 v[48:63], v[16:19], v[120:123], v[48:63]
    ds_read_b128 v[16:19], v12 offset:12288
    s_waitcnt lgkmcnt(5)
    v_mfma_f32_32x32x16_bf16 v[48:63], v[20:23], v[124:127], v[48:63]
    ds_read_b128 v[20:23], v12 offset:13312
    s_waitcnt lgkmcnt(5)
    v_mfma_f32_32x32x16_bf16 v[48:63], v[24:27], v[128:131], v[48:63]
    ds_read_b128 v[24:27], v12 offset:14336
    s_waitcnt lgkmcnt(5)
    v_mfma_f32_32x32x16_bf16 v[48:63], v[28:31], v[132:135], v[48:63]
    ds_read_b128 v[28:31], v12 offset:15360
    s_waitcnt lgkmcnt(5)
    v_mfma_f32_32x32x16_bf16 v[48:63], v[32:35], v[136:139], v[48:63]
    ds_read_b128 v[32:35], v12 offset:16384
    s_waitcnt lgkmcnt(5)
    v_mfma_f32_32x32x16_bf16 v[48:63], v[36:39], v[140:143], v[48:63]
    ds_read_b128 v[36:39], v12 offset:17408
    s_waitcnt lgkmcnt(5)
    v_mfma_f32_32x32x16_bf16 v[48:63], v[16:19], v[144:147], v[48:63]
    ds_read_b128 v[16:19], v12 offset:18432
    s_waitcnt lgkmcnt(5)
    v_mfma_f32_32x32x16_bf16 v[48:63], v[20:23], v[148:151], v[48:63]
    ds_read_b128 v[20:23], v12 offset:19456
    s_waitcnt lgkmcnt(5)
    v_mfma_f32_32x32x16_bf16 v[48:63], v[24:27], v[152:155], v[48:63]
    ds_read_b128 v[24:27], v12 offset:20480
    s_waitcnt lgkmcnt(5)
    v_mfma_f32_32x32x16_bf16 v[48:63], v[28:31], v[156:159], v[48:63]
    ds_read_b128 v[28:31], v12 offset:21504
    s_waitcnt lgkmcnt(5)
    v_mfma_f32_32x32x16_bf16 v[48:63], v[32:35], v[160:163], v[48:63]
    ds_read_b128 v[32:35], v12 offset:22528
    s_waitcnt lgkmcnt(5)
    v_mfma_f32_32x32x16_bf16 v[48:63], v[36:39], v[164:167], v[48:63]
    ds_read_b128 v[36:39], v12 offset:23552
    s_waitcnt lgkmcnt(5)
    v_mfma_f32_32x32x16_bf16 v[48:63], v[16:19], v[168:171], v[48:63]
    ds_read_b128 v[16:19], v12 offset:24576
    s_waitcnt lgkmcnt(5)
    v_mfma_f32_32x32x16_bf16 v[48:63], v[20:23], v[172:175], v[48:63]
    ds_read_b128 v[20:23], v12 offset:25600
    s_waitcnt lgkmcnt(5)
    v_mfma_f32_32x32x16_bf16 v[48:63], v[24:27], v[176:179], v[48:63]
    ds_read_b128 v[24:27], v12 offset:26624
    s_waitcnt lgkmcnt(5)
    v_mfma_f32_32x32x16_bf16 v[48:63], v[28:31], v[180:183], v[48:63]
    ds_read_b128 v[28:31], v12 offset:27648
    s_waitcnt lgkmcnt(5)
    v_mfma_f32_32x32x16_bf16 v[48:63], v[32:35], v[184:187], v[48:63]
    ds_read_b128 v[32:35], v12 offset:28672
    s_waitcnt lgkmcnt(5)
    v_mfma_f32_32x32x16_bf16 v[48:63], v[36:39], v[188:191], v[48:63]
    ds_read_b128 v[36:39], v12 offset:29696
    s_waitcnt lgkmcnt(5)
    v_mfma_f32_32x32x16_bf16 v[48:63], v[16:19], v[192:195], v[48:63]
    ds_read_b128 v[16:19], v12 offset:30720
    s_waitcnt lgkmcnt(5)
    v_mfma_f32_32x32x16_bf16 v[48:63], v[20:23], v[196:199], v[48:63]
    ds_read_b128 v[20:23], v12 offset:31744
    s_waitcnt lgkmcnt(5)
    v_mfma_f32_32x32x16_bf16 v[48:63], v[24:27], v[200:203], v[48:63]
    ds_read_b128 v[24:27], v12 offset:32768
    s_waitcnt lgkmcnt(5)
    v_mfma_f32_32x32x16_bf16 v[48:63], v[28:31], v[204:207], v[48:63]
    ds_read_b128 v[28:31], v12 offset:33792
    s_waitcnt lgkmcnt(5)
    v_mfma_f32_32x32x16_bf16 v[48:63], v[32:35], v[208:211], v[48:63]
    ds_read_b128 v[32:35], v12 offset:34816
    s_waitcnt lgkmcnt(5)
    v_mfma_f32_32x32x16_bf16 v[48:63], v[36:39], v[212:215], v[48:63]
    ds_read_b128 v[36:39], v12 offset:35840
    s_waitcnt lgkmcnt(5)
    v_mfma_f32_32x32x16_bf16 v[48:63], v[16:19], v[216:219], v[48:63]
    ds_read_b128 v[16:19], v12 offset:36864
    s_waitcnt lgkmcnt(5)
    v_mfma_f32_32x32x16_bf16 v[48:63], v[20:23], v[220:223], v[48:63]
    ds_read_b128 v[20:23], v12 offset:37888
    s_waitcnt lgkmcnt(5)
    v_mfma_f32_32x32x16_bf16 v[48:63], v[24:27], v[224:227], v[48:63]
    ds_read_b128 v[24:27], v12 offset:38912
    s_waitcnt lgkmcnt(5)
    v_mfma_f32_32x32x16_bf16 v[48:63], v[28:31], v[228:231], v[48:63]
    ds_read_b128 v[28:31], v12 offset:39936
    s_waitcnt lgkmcnt(5)
    v_mfma_f32_32x32x16_bf16 v[48:63], v[32:35], v[232:235], v[48:63]
    s_waitcnt lgkmcnt(4)
    v_mfma_f32_32x32x16_bf16 v[48:63], v[36:39], v[236:239], v[48:63]
    s_waitcnt lgkmcnt(3)
    v_mfma_f32_32x32x16_bf16 v[48:63], v[16:19], v[240:243], v[48:63]
    s_waitcnt lgkmcnt(2)
    v_mfma_f32_32x32x16_bf16 v[48:63], v[20:23], v[244:247], v[48:63]
    s_waitcnt lgkmcnt(1)
    v_mfma_f32_32x32x16_bf16 v[48:63], v[24:27], v[248:251], v[48:63]
    s_waitcnt lgkmcnt(0)
    v_mfma_f32_32x32x16_bf16 v[48:63], v[28:31], v[252:255], v[48:63]
    s_mul_i32 s6, s62, 262144
    s_add_u32 s6, s6, s64
    s_nop 10
    v_cvt_pk_bf16_f32 v64, v48, v49
    v_cvt_pk_bf16_f32 v65, v50, v51
    v_cvt_pk_bf16_f32 v66, v56, v57
    v_cvt_pk_bf16_f32 v67, v58, v59
    v_cvt_pk_bf16_f32 v68, v52, v53
    v_cvt_pk_bf16_f32 v69, v54, v55
    v_cvt_pk_bf16_f32 v70, v60, v61
    v_cvt_pk_bf16_f32 v71, v62, v63
    buffer_store_dwordx4 v[64:67], v8, s[44:47], s6 offen sc1
    buffer_store_dwordx4 v[68:71], v8, s[44:47], s6 offen offset:512 sc1
L_bulk_next:
    s_mov_b32 s6, s63
    s_add_u32 s63, s63, 40960
    s_cmp_eq_u32 s63, 122880
    s_cselect_b32 s63, 0, s63
    s_mov_b32 s67, s6
    s_add_u32 s62, s62, 1
    s_cmp_lt_u32 s62, 64
    s_cbranch_scc1 L_bulk_loop
    s_waitcnt vmcnt(0)
    s_barrier
    s_cmp_lg_u32 s3, 0
    s_cbranch_scc1 L_end
    v_mov_b32 v11, 64
    s_mov_b64 exec, 1
    buffer_store_dword v11, v10, s[44:47], s66 offen sc1
    s_waitcnt vmcnt(0)
    s_branch L_end
L_chain:
    s_cmp_lg_u32 s3, 0
    s_cbranch_scc1 L_cnt_20
    s_lshl_b32 s6, s11, 2
    s_add_u32 s6, s6, 128
    v_mov_b32 v2, s6
    v_mov_b32 v3, 1
    s_mov_b64 exec, 1
    global_atomic_add v2, v3, s[40:41] sc1
    s_mov_b64 exec, -1
L_cnt_20:
    s_mov_b32 s64, s5
    v_and_b32 v16, 63, v0
    v_and_b32 v17, 15, v16
    v_lshrrev_b32 v18, 4, v16
    v_lshlrev_b32 v19, 4, v16
    s_lshl_b32 s77, s64, 8
    s_add_u32 s48, s20, s77
    s_addc_u32 s49, s21, 0
    s_sub_u32 s50, 5242880, s77
    s_mov_b32 s51, 0x20000
    s_lshl_b32 s77, s64, 8
    s_add_u32 s52, s22, s77
    s_addc_u32 s53, s23, 0
    s_sub_u32 s54, 5242880, s77
    s_mov_b32 s55, 0x20000
    s_lshl_b32 s77, s64, 8
    s_add_u32 s56, s24, s77
    s_addc_u32 s57, s25, 0
    s_sub_u32 s58, 5242880, s77
    s_mov_b32 s59, 0x20000
    s_mul_i32 s77, s64, 163840
    s_add_u32 s60, s26, s77
    s_addc_u32 s61, s27, 0
    s_mov_b32 s62, 163840
    s_mov_b32 s63, 0x20000
    s_lshr_b32 s77, s3, 1
    s_lshl_b32 s77, s77, 1
    v_xor_b32 v20, s77, v18
    v_lshlrev_b32 v21, 2, v20
    v_xor_b32 v21, v21, v17
    v_lshlrev_b32 v21, 4, v21
    v_lshl_add_u32 v24, v18, 13, v21
    v_lshrrev_b32 v21, 2, v17
    v_xor_b32 v21, v21, v20
    v_mul_u32_u24 v21, 320, v21
    v_and_b32 v22, 3, v17
    v_lshl_add_u32 v21, v22, 4, v21
    v_mul_u32_u24 v22, 1280, v18
    v_add_u32 v25, v21, v22
    v_and_b32 v20, 1, v18
    v_lshrrev_b32 v21, 1, v18
    v_lshrrev_b32 v22, 2, v17
    v_and_b32 v23, 3, v17
    v_and_b32 v28, 1, v22
    v_lshlrev_b32 v29, 4, v20
    v_lshl_add_u32 v29, v21, 2, v29
    v_add_u32 v29, v29, v28
    v_lshlrev_b32 v29, 8, v29
    v_lshlrev_b32 v30, 1, v20
    v_xor_b32 v30, v30, v28
    v_xor_b32 v30, s3, v30
    v_lshlrev_b32 v30, 2, v30
    v_lshrrev_b32 v31, 1, v22
    v_lshl_add_u32 v30, v31, 1, v30
    v_lshrrev_b32 v31, 1, v23
    v_add_u32 v30, v30, v31
    v_lshl_add_u32 v29, v30, 4, v29
    v_and_b32 v31, 1, v23
    v_lshl_add_u32 v26, v31, 3, v29
    v_xor_b32 v27, 0x80, v26
    v_add_u32 v28, 131072, v26
    v_add_u32 v29, 131072, v27
    v_add_u32 v30, 65536, v26
    v_add_u32 v31, 65536, v27
    s_lshl_b32 s6, s3, 16
    s_mul_i32 s9, s3, 10240
    s_mov_b32 s13, 32768
    s_mov_b32 s81, 5120
    s_movk_i32 s28, 1024
    s_movk_i32 s29, 7168
    s_lshl_b32 s78, s3, 11
    s_lshl_b32 s79, s3, 15
    s_add_u32 m0, s78, 0
    s_add_u32 s30, s6, 0
    buffer_load_dwordx4 v24, s[48:51], s30 offen lds
    s_add_u32 m0, m0, s28
    s_add_u32 s30, s30, s13
    buffer_load_dwordx4 v24, s[48:51], s30 offen lds
    s_add_u32 m0, m0, s29
    s_add_u32 s30, s6, 262144
    buffer_load_dwordx4 v24, s[48:51], s30 offen lds
    s_add_u32 m0, m0, s28
    s_add_u32 s30, s30, s13
    buffer_load_dwordx4 v24, s[48:51], s30 offen lds
    s_add_u32 m0, m0, s29
    s_add_u32 s30, s6, 524288
    buffer_load_dwordx4 v24, s[48:51], s30 offen lds
    s_add_u32 m0, m0, s28
    s_add_u32 s30, s30, s13
    buffer_load_dwordx4 v24, s[48:51], s30 offen lds
    s_add_u32 m0, m0, s29
    s_add_u32 s30, s6, 786432
    buffer_load_dwordx4 v24, s[48:51], s30 offen lds
    s_add_u32 m0, m0, s28
    s_add_u32 s30, s30, s13
    buffer_load_dwordx4 v24, s[48:51], s30 offen lds
    s_add_u32 m0, m0, s29
    s_add_u32 s30, s6, 1048576
    buffer_load_dwordx4 v24, s[48:51], s30 offen lds
    s_add_u32 m0, m0, s28
    s_add_u32 s30, s30, s13
    buffer_load_dwordx4 v24, s[48:51], s30 offen lds
    s_add_u32 m0, m0, s29
    s_add_u32 s30, s6, 1310720
    buffer_load_dwordx4 v24, s[48:51], s30 offen lds
    s_add_u32 m0, m0, s28
    s_add_u32 s30, s30, s13
    buffer_load_dwordx4 v24, s[48:51], s30 offen lds
    s_add_u32 m0, m0, s29
    s_add_u32 s30, s6, 1572864
    buffer_load_dwordx4 v24, s[48:51], s30 offen lds
    s_add_u32 m0, m0, s28
    s_add_u32 s30, s30, s13
    buffer_load_dwordx4 v24, s[48:51], s30 offen lds
    s_add_u32 m0, m0, s29
    s_add_u32 s30, s6, 1835008
    buffer_load_dwordx4 v24, s[48:51], s30 offen lds
    s_add_u32 m0, m0, s28
    s_add_u32 s30, s30, s13
    buffer_load_dwordx4 v24, s[48:51], s30 offen lds
    s_add_u32 m0, m0, s29
    s_add_u32 s30, s6, 2097152
    buffer_load_dwordx4 v24, s[48:51], s30 offen lds
    s_add_u32 m0, m0, s28
    s_add_u32 s30, s30, s13
    buffer_load_dwordx4 v24, s[48:51], s30 offen lds
    s_add_u32 m0, m0, s29
    s_add_u32 s30, s6, 2359296
    buffer_load_dwordx4 v24, s[48:51], s30 offen lds
    s_add_u32 m0, m0, s28
    s_add_u32 s30, s30, s13
    buffer_load_dwordx4 v24, s[48:51], s30 offen lds
    s_add_u32 m0, m0, s29
    s_add_u32 s30, s6, 2621440
    buffer_load_dwordx4 v24, s[48:51], s30 offen lds
    s_add_u32 m0, m0, s28
    s_add_u32 s30, s30, s13
    buffer_load_dwordx4 v24, s[48:51], s30 offen lds
    s_add_u32 m0, m0, s29
    s_add_u32 s30, s6, 2883584
    buffer_load_dwordx4 v24, s[48:51], s30 offen lds
    s_add_u32 m0, m0, s28
    s_add_u32 s30, s30, s13
    buffer_load_dwordx4 v24, s[48:51], s30 offen lds
    s_add_u32 m0, m0, s29
    s_add_u32 s30, s6, 3145728
    buffer_load_dwordx4 v24, s[48:51], s30 offen lds
    s_add_u32 m0, m0, s28
    s_add_u32 s30, s30, s13
    buffer_load_dwordx4 v24, s[48:51], s30 offen lds
    s_add_u32 m0, m0, s29
    s_add_u32 s30, s6, 3407872
    buffer_load_dwordx4 v24, s[48:51], s30 offen lds
    s_add_u32 m0, m0, s28
    s_add_u32 s30, s30, s13
    buffer_load_dwordx4 v24, s[48:51], s30 offen lds
    v_add_u32 v2, 131072, v19
    s_lshl_b32 s77, s3, 10
    v_add_u32 v3, s77, v2
    s_lshl_b32 s77, s3, 15
    v_add_u32 v4, s77, v19
    v_and_b32 v20, 7, v17
    v_lshlrev_b32 v20, 4, v20
    v_lshl_add_u32 v20, v18, 7, v20
    v_add_u32 v1, 131072, v20
    v_lshrrev_b32 v20, 1, v18
    v_lshl_add_u32 v20, v20, 4, v17
    s_lshl_b32 s77, s3, 5
    v_add_u32 v20, s77, v20
    v_lshlrev_b32 v20, 4, v20
    v_and_b32 v21, 1, v18
    v_lshl_add_u32 v20, v21, 3, v20
    v_add_u32 v5, 131072, v20
    v_lshrrev_b32 v20, 1, v18
    v_lshlrev_b32 v20, 4, v20
    v_lshl_add_u32 v20, v21, 2, v20
    v_lshrrev_b32 v22, 2, v17
    v_add_u32 v20, v20, v22
    v_lshlrev_b32 v20, 4, v20
    v_and_b32 v22, 1, v17
    v_lshl_add_u32 v20, v22, 3, v20
    v_add_u32 v6, 131072, v20
    v_lshrrev_b32 v20, 1, v18
    v_lshlrev_b32 v20, 13, v20
    v_lshl_add_u32 v20, v17, 4, v20
    v_lshl_add_u32 v20, v21, 3, v20
    s_mul_i32 s77, s3, 81920
    s_lshl_b32 s78, s64, 8
    s_add_u32 s77, s77, s78
    v_add_u32 v7, s77, v20
    s_mov_b32 s66, -1
    s_cmp_eq_u32 s3, 0
    s_cselect_b32 s66, s64, s66
    s_add_u32 s77, s64, 32
    s_cmp_lt_u32 s64, 8
    s_cselect_b32 s77, s77, -1
    s_cmp_eq_u32 s3, 1
    s_cselect_b32 s66, s77, s66
    s_max_i32 s78, s66, 0
    s_lshl_b32 s7, s78, 13
    s_sub_u32 s7, s7, 131072
    s_lshr_b32 s77, s78, 1
    s_lshl_b32 s77, s77, 9
    s_and_b32 s78, s78, 1
    s_lshl_b32 s78, s78, 3
    s_add_u32 s77, s77, s78
    s_sub_u32 s8, s77, 131072
    v_cmp_gt_u32 vcc, 8, v17
    s_nop 1
    s_mov_b64 s[82:83], vcc
    v_mov_b32 v20, 0x4444
    v_mov_b32 v21, 0xeeee
    v_cndmask_b32 v0, v21, v20, vcc
    v_cmp_gt_u32 vcc, 2, v18
    s_nop 0
    s_mov_b64 s[84:85], vcc
    s_mov_b32 s14, 0x3e0293ee
    s_mov_b32 s15, s14
    s_lshl_b32 s72, s64, 16
    s_lshl_b32 s77, s3, 14
    s_add_u32 s72, s72, s77
    s_add_u32 s72, s72, 0xe0000
    s_lshl_b32 s86, s64, 7
    s_add_u32 s86, s86, 0x404
    s_lshl_b32 s78, s3, 11
    s_lshl_b32 s79, s3, 15
    s_waitcnt vmcnt(26) lgkmcnt(0)
    s_barrier
    s_add_u32 m0, m0, s29
    s_add_u32 s30, s6, 3670016
    buffer_load_dwordx4 v24, s[48:51], s30 offen lds
    s_add_u32 m0, m0, s28
    s_add_u32 s30, s30, s13
    buffer_load_dwordx4 v24, s[48:51], s30 offen lds
    ds_read_b64_tr_b16 v[32:33], v26 offset:0
    ds_read_b64_tr_b16 v[34:35], v27 offset:512
    ds_read_b64_tr_b16 v[36:37], v26 offset:2048
    ds_read_b64_tr_b16 v[38:39], v27 offset:2560
    s_waitcnt lgkmcnt(0)
    s_add_u32 s77, s72, 0
    buffer_store_dwordx4 v[32:35], v2, s[44:47], s77 offen
    buffer_store_dwordx4 v[36:39], v2, s[44:47], s77 offen offset:1024
    s_nop 1
    s_waitcnt vmcnt(28) lgkmcnt(0)
    s_barrier
    s_add_u32 m0, m0, s29
    s_add_u32 s30, s6, 3932160
    buffer_load_dwordx4 v24, s[48:51], s30 offen lds
    s_add_u32 m0, m0, s28
    s_add_u32 s30, s30, s13
    buffer_load_dwordx4 v24, s[48:51], s30 offen lds
    ds_read_b64_tr_b16 v[32:33], v26 offset:8192
    ds_read_b64_tr_b16 v[34:35], v27 offset:8704
    ds_read_b64_tr_b16 v[36:37], v26 offset:10240
    ds_read_b64_tr_b16 v[38:39], v27 offset:10752
    s_waitcnt lgkmcnt(0)
    s_add_u32 s77, s72, 2048
    buffer_store_dwordx4 v[32:35], v2, s[44:47], s77 offen
    buffer_store_dwordx4 v[36:39], v2, s[44:47], s77 offen offset:1024
    s_nop 1
    s_waitcnt vmcnt(30) lgkmcnt(0)
    s_barrier
    s_add_u32 m0, s78, 0
    s_add_u32 s30, s6, 4194304
    buffer_load_dwordx4 v24, s[48:51], s30 offen lds
    s_add_u32 m0, m0, s28
    s_add_u32 s30, s30, s13
    buffer_load_dwordx4 v24, s[48:51], s30 offen lds
    ds_read_b64_tr_b16 v[64:65], v26 offset:16384
    ds_read_b64_tr_b16 v[66:67], v27 offset:16896
    ds_read_b64_tr_b16 v[68:69], v26 offset:18432
    ds_read_b64_tr_b16 v[70:71], v27 offset:18944
    s_waitcnt vmcnt(30) lgkmcnt(0)
    s_barrier
    s_add_u32 m0, m0, s29
    s_add_u32 s30, s6, 4456448
    buffer_load_dwordx4 v24, s[48:51], s30 offen lds
    s_add_u32 m0, m0, s28
    s_add_u32 s30, s30, s13
    buffer_load_dwordx4 v24, s[48:51], s30 offen lds
    ds_read_b64_tr_b16 v[72:73], v26 offset:24576
    ds_read_b64_tr_b16 v[74:75], v27 offset:25088
    ds_read_b64_tr_b16 v[76:77], v26 offset:26624
    ds_read_b64_tr_b16 v[78:79], v27 offset:27136
    s_waitcnt vmcnt(30) lgkmcnt(0)
    s_barrier
    s_add_u32 m0, m0, s29
    s_add_u32 s30, s6, 4718592
    buffer_load_dwordx4 v24, s[48:51], s30 offen lds
    s_add_u32 m0, m0, s28
    s_add_u32 s30, s30, s13
    buffer_load_dwordx4 v24, s[48:51], s30 offen lds
    ds_read_b64_tr_b16 v[32:33], v26 offset:32768
    ds_read_b64_tr_b16 v[34:35], v27 offset:33280
    ds_read_b64_tr_b16 v[36:37], v26 offset:34816
    ds_read_b64_tr_b16 v[38:39], v27 offset:35328
    s_waitcnt lgkmcnt(0)
    s_add_u32 s77, s72, 4096
    buffer_store_dwordx4 v[32:35], v2, s[44:47], s77 offen
    buffer_store_dwordx4 v[36:39], v2, s[44:47], s77 offen offset:1024
    s_nop 1
    s_waitcnt vmcnt(32) lgkmcnt(0)
    s_barrier
    s_add_u32 m0, m0, s29
    s_add_u32 s30, s6, 4980736
    buffer_load_dwordx4 v24, s[48:51], s30 offen lds
    s_add_u32 m0, m0, s28
    s_add_u32 s30, s30, s13
    buffer_load_dwordx4 v24, s[48:51], s30 offen lds
    ds_read_b64_tr_b16 v[80:81], v26 offset:40960
    ds_read_b64_tr_b16 v[82:83], v27 offset:41472
    ds_read_b64_tr_b16 v[84:85], v26 offset:43008
    ds_read_b64_tr_b16 v[86:87], v27 offset:43520
    s_waitcnt vmcnt(32) lgkmcnt(0)
    s_barrier
    s_add_u32 m0, m0, s29
    s_add_u32 s30, s6, 0
    buffer_load_dwordx4 v24, s[52:55], s30 offen lds
    s_add_u32 m0, m0, s28
    s_add_u32 s30, s30, s13
    buffer_load_dwordx4 v24, s[52:55], s30 offen lds
    ds_read_b64_tr_b16 v[88:89], v26 offset:49152
    ds_read_b64_tr_b16 v[90:91], v27 offset:49664
    ds_read_b64_tr_b16 v[92:93], v26 offset:51200
    ds_read_b64_tr_b16 v[94:95], v27 offset:51712
    s_waitcnt vmcnt(32) lgkmcnt(0)
    s_barrier
    s_add_u32 m0, m0, s29
    s_add_u32 s30, s6, 262144
    buffer_load_dwordx4 v24, s[52:55], s30 offen lds
    s_add_u32 m0, m0, s28
    s_add_u32 s30, s30, s13
    buffer_load_dwordx4 v24, s[52:55], s30 offen lds
    ds_read_b64_tr_b16 v[96:97], v26 offset:57344
    ds_read_b64_tr_b16 v[98:99], v27 offset:57856
    ds_read_b64_tr_b16 v[100:101], v26 offset:59392
    ds_read_b64_tr_b16 v[102:103], v27 offset:59904
    s_waitcnt vmcnt(32) lgkmcnt(0)
    s_barrier
    s_add_u32 m0, m0, s29
    s_add_u32 s30, s6, 524288
    buffer_load_dwordx4 v24, s[52:55], s30 offen lds
    s_add_u32 m0, m0, s28
    s_add_u32 s30, s30, s13
    buffer_load_dwordx4 v24, s[52:55], s30 offen lds
    ds_read_b64_tr_b16 v[104:105], v30 offset:0
    ds_read_b64_tr_b16 v[106:107], v31 offset:512
    ds_read_b64_tr_b16 v[108:109], v30 offset:2048
    ds_read_b64_tr_b16 v[110:111], v31 offset:2560
    s_waitcnt vmcnt(32) lgkmcnt(0)
    s_barrier
    s_add_u32 m0, m0, s29
    s_add_u32 s30, s6, 786432
    buffer_load_dwordx4 v24, s[52:55], s30 offen lds
    s_add_u32 m0, m0, s28
    s_add_u32 s30, s30, s13
    buffer_load_dwordx4 v24, s[52:55], s30 offen lds
    ds_read_b64_tr_b16 v[32:33], v30 offset:8192
    ds_read_b64_tr_b16 v[34:35], v31 offset:8704
    ds_read_b64_tr_b16 v[36:37], v30 offset:10240
    ds_read_b64_tr_b16 v[38:39], v31 offset:10752
    s_waitcnt lgkmcnt(0)
    s_add_u32 s77, s72, 6144
    buffer_store_dwordx4 v[32:35], v2, s[44:47], s77 offen
    buffer_store_dwordx4 v[36:39], v2, s[44:47], s77 offen offset:1024
    s_nop 1
    s_waitcnt vmcnt(34) lgkmcnt(0)
    s_barrier
    s_add_u32 m0, m0, s29
    s_add_u32 s30, s6, 1048576
    buffer_load_dwordx4 v24, s[52:55], s30 offen lds
    s_add_u32 m0, m0, s28
    s_add_u32 s30, s30, s13
    buffer_load_dwordx4 v24, s[52:55], s30 offen lds
    ds_read_b64_tr_b16 v[32:33], v30 offset:16384
    ds_read_b64_tr_b16 v[34:35], v31 offset:16896
    ds_read_b64_tr_b16 v[36:37], v30 offset:18432
    ds_read_b64_tr_b16 v[38:39], v31 offset:18944
    s_waitcnt lgkmcnt(0)
    s_add_u32 s77, s72, 8192
    buffer_store_dwordx4 v[32:35], v2, s[44:47], s77 offen
    buffer_store_dwordx4 v[36:39], v2, s[44:47], s77 offen offset:1024
    s_nop 1
    s_waitcnt vmcnt(36) lgkmcnt(0)
    s_barrier
    s_add_u32 m0, m0, s29
    s_add_u32 s30, s6, 1310720
    buffer_load_dwordx4 v24, s[52:55], s30 offen lds
    s_add_u32 m0, m0, s28
    s_add_u32 s30, s30, s13
    buffer_load_dwordx4 v24, s[52:55], s30 offen lds
    ds_read_b64_tr_b16 v[112:113], v30 offset:24576
    ds_read_b64_tr_b16 v[114:115], v31 offset:25088
    ds_read_b64_tr_b16 v[116:117], v30 offset:26624
    ds_read_b64_tr_b16 v[118:119], v31 offset:27136
    s_waitcnt vmcnt(36) lgkmcnt(0)
    s_barrier
    s_add_u32 m0, m0, s29
    s_add_u32 s30, s6, 1572864
    buffer_load_dwordx4 v24, s[52:55], s30 offen lds
    s_add_u32 m0, m0, s28
    s_add_u32 s30, s30, s13
    buffer_load_dwordx4 v24, s[52:55], s30 offen lds
    ds_read_b64_tr_b16 v[120:121], v30 offset:32768
    ds_read_b64_tr_b16 v[122:123], v31 offset:33280
    ds_read_b64_tr_b16 v[124:125], v30 offset:34816
    ds_read_b64_tr_b16 v[126:127], v31 offset:35328
    s_waitcnt vmcnt(36) lgkmcnt(0)
    s_barrier
    s_add_u32 m0, m0, s29
    s_add_u32 s30, s6, 1835008
    buffer_load_dwordx4 v24, s[52:55], s30 offen lds
    s_add_u32 m0, m0, s28
    s_add_u32 s30, s30, s13
    buffer_load_dwordx4 v24, s[52:55], s30 offen lds
    ds_read_b64_tr_b16 v[32:33], v30 offset:40960
    ds_read_b64_tr_b16 v[34:35], v31 offset:41472
    ds_read_b64_tr_b16 v[36:37], v30 offset:43008
    ds_read_b64_tr_b16 v[38:39], v31 offset:43520
    s_waitcnt lgkmcnt(0)
    s_add_u32 s77, s72, 10240
    buffer_store_dwordx4 v[32:35], v2, s[44:47], s77 offen
    buffer_store_dwordx4 v[36:39], v2, s[44:47], s77 offen offset:1024
    s_nop 1
    s_waitcnt vmcnt(38) lgkmcnt(0)
    s_barrier
    s_add_u32 m0, m0, s29
    s_add_u32 s30, s6, 2097152
    buffer_load_dwordx4 v24, s[52:55], s30 offen lds
    s_add_u32 m0, m0, s28
    s_add_u32 s30, s30, s13
    buffer_load_dwordx4 v24, s[52:55], s30 offen lds
    ds_read_b64_tr_b16 v[128:129], v30 offset:49152
    ds_read_b64_tr_b16 v[130:131], v31 offset:49664
    ds_read_b64_tr_b16 v[132:133], v30 offset:51200
    ds_read_b64_tr_b16 v[134:135], v31 offset:51712
    s_waitcnt vmcnt(36) lgkmcnt(0)
    s_barrier
    s_add_u32 m0, m0, s29
    s_add_u32 s30, s6, 2359296
    buffer_load_dwordx4 v24, s[52:55], s30 offen lds
    s_add_u32 m0, m0, s28
    s_add_u32 s30, s30, s13
    buffer_load_dwordx4 v24, s[52:55], s30 offen lds
    ds_read_b64_tr_b16 v[136:137], v30 offset:57344
    ds_read_b64_tr_b16 v[138:139], v31 offset:57856
    ds_read_b64_tr_b16 v[140:141], v30 offset:59392
    ds_read_b64_tr_b16 v[142:143], v31 offset:59904
    s_waitcnt vmcnt(34) lgkmcnt(0)
    s_barrier
    s_add_u32 m0, m0, s29
    s_add_u32 s30, s6, 2621440
    buffer_load_dwordx4 v24, s[52:55], s30 offen lds
    s_add_u32 m0, m0, s28
    s_add_u32 s30, s30, s13
    buffer_load_dwordx4 v24, s[52:55], s30 offen lds
    ds_read_b64_tr_b16 v[144:145], v26 offset:0
    ds_read_b64_tr_b16 v[146:147], v27 offset:512
    ds_read_b64_tr_b16 v[148:149], v26 offset:2048
    ds_read_b64_tr_b16 v[150:151], v27 offset:2560
    s_waitcnt vmcnt(34) lgkmcnt(0)
    s_barrier
    s_add_u32 m0, m0, s29
    s_add_u32 s30, s6, 2883584
    buffer_load_dwordx4 v24, s[52:55], s30 offen lds
    s_add_u32 m0, m0, s28
    s_add_u32 s30, s30, s13
    buffer_load_dwordx4 v24, s[52:55], s30 offen lds
    ds_read_b64_tr_b16 v[152:153], v26 offset:8192
    ds_read_b64_tr_b16 v[154:155], v27 offset:8704
    ds_read_b64_tr_b16 v[156:157], v26 offset:10240
    ds_read_b64_tr_b16 v[158:159], v27 offset:10752
    s_waitcnt vmcnt(34) lgkmcnt(0)
    s_barrier
    s_add_u32 m0, s78, 0
    s_add_u32 s30, s6, 3145728
    buffer_load_dwordx4 v24, s[52:55], s30 offen lds
    s_add_u32 m0, m0, s28
    s_add_u32 s30, s30, s13
    buffer_load_dwordx4 v24, s[52:55], s30 offen lds
    ds_read_b64_tr_b16 v[32:33], v26 offset:16384
    ds_read_b64_tr_b16 v[34:35], v27 offset:16896
    ds_read_b64_tr_b16 v[36:37], v26 offset:18432
    ds_read_b64_tr_b16 v[38:39], v27 offset:18944
    s_waitcnt lgkmcnt(0)
    s_add_u32 s77, s72, 12288
    buffer_store_dwordx4 v[32:35], v2, s[44:47], s77 offen
    buffer_store_dwordx4 v[36:39], v2, s[44:47], s77 offen offset:1024
    s_nop 1
    s_waitcnt vmcnt(34) lgkmcnt(0)
    s_barrier
    s_add_u32 m0, m0, s29
    s_add_u32 s30, s6, 3407872
    buffer_load_dwordx4 v24, s[52:55], s30 offen lds
    s_add_u32 m0, m0, s28
    s_add_u32 s30, s30, s13
    buffer_load_dwordx4 v24, s[52:55], s30 offen lds
    ds_read_b64_tr_b16 v[32:33], v26 offset:24576
    ds_read_b64_tr_b16 v[34:35], v27 offset:25088
    ds_read_b64_tr_b16 v[36:37], v26 offset:26624
    ds_read_b64_tr_b16 v[38:39], v27 offset:27136
    s_waitcnt lgkmcnt(0)
    s_add_u32 s77, s72, 14336
    buffer_store_dwordx4 v[32:35], v2, s[44:47], s77 offen
    buffer_store_dwordx4 v[36:39], v2, s[44:47], s77 offen offset:1024
    s_nop 1
    s_waitcnt vmcnt(36) lgkmcnt(0)
    s_barrier
    s_add_u32 m0, m0, s29
    s_add_u32 s30, s6, 3670016
    buffer_load_dwordx4 v24, s[52:55], s30 offen lds
    s_add_u32 m0, m0, s28
    s_add_u32 s30, s30, s13
    buffer_load_dwordx4 v24, s[52:55], s30 offen lds
    ds_read_b64_tr_b16 v[160:161], v26 offset:32768
    ds_read_b64_tr_b16 v[162:163], v27 offset:33280
    ds_read_b64_tr_b16 v[164:165], v26 offset:34816
    ds_read_b64_tr_b16 v[166:167], v27 offset:35328
    s_waitcnt vmcnt(36) lgkmcnt(0)
    s_barrier
    s_add_u32 m0, m0, s29
    s_add_u32 s30, s6, 3932160
    buffer_load_dwordx4 v24, s[52:55], s30 offen lds
    s_add_u32 m0, m0, s28
    s_add_u32 s30, s30, s13
    buffer_load_dwordx4 v24, s[52:55], s30 offen lds
    ds_read_b64_tr_b16 v[168:169], v26 offset:40960
    ds_read_b64_tr_b16 v[170:171], v27 offset:41472
    ds_read_b64_tr_b16 v[172:173], v26 offset:43008
    ds_read_b64_tr_b16 v[174:175], v27 offset:43520
    s_waitcnt vmcnt(36) lgkmcnt(0)
    s_barrier
    s_add_u32 m0, m0, s29
    s_add_u32 s30, s6, 4194304
    buffer_load_dwordx4 v24, s[52:55], s30 offen lds
    s_add_u32 m0, m0, s28
    s_add_u32 s30, s30, s13
    buffer_load_dwordx4 v24, s[52:55], s30 offen lds
    ds_read_b64_tr_b16 v[176:177], v26 offset:49152
    ds_read_b64_tr_b16 v[178:179], v27 offset:49664
    ds_read_b64_tr_b16 v[180:181], v26 offset:51200
    ds_read_b64_tr_b16 v[182:183], v27 offset:51712
    s_waitcnt vmcnt(36) lgkmcnt(0)
    s_barrier
    s_add_u32 m0, m0, s29
    s_add_u32 s30, s6, 4456448
    buffer_load_dwordx4 v24, s[52:55], s30 offen lds
    s_add_u32 m0, m0, s28
    s_add_u32 s30, s30, s13
    buffer_load_dwordx4 v24, s[52:55], s30 offen lds
    ds_read_b64_tr_b16 v[184:185], v26 offset:57344
    ds_read_b64_tr_b16 v[186:187], v27 offset:57856
    ds_read_b64_tr_b16 v[188:189], v26 offset:59392
    ds_read_b64_tr_b16 v[190:191], v27 offset:59904
    s_waitcnt vmcnt(34) lgkmcnt(0)
    s_barrier
    s_add_u32 m0, m0, s29
    s_add_u32 s30, s6, 4718592
    buffer_load_dwordx4 v24, s[52:55], s30 offen lds
    s_add_u32 m0, m0, s28
    s_add_u32 s30, s30, s13
    buffer_load_dwordx4 v24, s[52:55], s30 offen lds
    ds_read_b64_tr_b16 v[192:193], v30 offset:0
    ds_read_b64_tr_b16 v[194:195], v31 offset:512
    ds_read_b64_tr_b16 v[196:197], v30 offset:2048
    ds_read_b64_tr_b16 v[198:199], v31 offset:2560
    s_waitcnt vmcnt(32) lgkmcnt(0)
    s_barrier
    s_add_u32 m0, m0, s29
    s_add_u32 s30, s6, 4980736
    buffer_load_dwordx4 v24, s[52:55], s30 offen lds
    s_add_u32 m0, m0, s28
    s_add_u32 s30, s30, s13
    buffer_load_dwordx4 v24, s[52:55], s30 offen lds
    ds_read_b64_tr_b16 v[200:201], v30 offset:8192
    ds_read_b64_tr_b16 v[202:203], v31 offset:8704
    ds_read_b64_tr_b16 v[204:205], v30 offset:10240
    ds_read_b64_tr_b16 v[206:207], v31 offset:10752
    s_waitcnt vmcnt(32) lgkmcnt(0)
    s_barrier
    s_add_u32 m0, m0, s29
    s_add_u32 s30, s6, 0
    buffer_load_dwordx4 v24, s[56:59], s30 offen lds
    s_add_u32 m0, m0, s28
    s_add_u32 s30, s30, s13
    buffer_load_dwordx4 v24, s[56:59], s30 offen lds
    ds_read_b64_tr_b16 v[208:209], v30 offset:16384
    ds_read_b64_tr_b16 v[210:211], v31 offset:16896
    ds_read_b64_tr_b16 v[212:213], v30 offset:18432
    ds_read_b64_tr_b16 v[214:215], v31 offset:18944
    s_waitcnt vmcnt(32) lgkmcnt(0)
    s_barrier
    s_add_u32 m0, m0, s29
    s_add_u32 s30, s6, 524288
    buffer_load_dwordx4 v24, s[56:59], s30 offen lds
    s_add_u32 m0, m0, s28
    s_add_u32 s30, s30, s13
    buffer_load_dwordx4 v24, s[56:59], s30 offen lds
    ds_read_b64_tr_b16 v[216:217], v30 offset:24576
    ds_read_b64_tr_b16 v[218:219], v31 offset:25088
    ds_read_b64_tr_b16 v[220:221], v30 offset:26624
    ds_read_b64_tr_b16 v[222:223], v31 offset:27136
    s_waitcnt vmcnt(30) lgkmcnt(0)
    s_barrier
    s_add_u32 m0, m0, s29
    s_add_u32 s30, s6, 1048576
    buffer_load_dwordx4 v24, s[56:59], s30 offen lds
    s_add_u32 m0, m0, s28
    s_add_u32 s30, s30, s13
    buffer_load_dwordx4 v24, s[56:59], s30 offen lds
    ds_read_b64_tr_b16 v[224:225], v30 offset:32768
    ds_read_b64_tr_b16 v[226:227], v31 offset:33280
    ds_read_b64_tr_b16 v[228:229], v30 offset:34816
    ds_read_b64_tr_b16 v[230:231], v31 offset:35328
    s_waitcnt vmcnt(30) lgkmcnt(0)
    s_barrier
    s_add_u32 m0, m0, s29
    s_add_u32 s30, s6, 1572864
    buffer_load_dwordx4 v24, s[56:59], s30 offen lds
    s_add_u32 m0, m0, s28
    s_add_u32 s30, s30, s13
    buffer_load_dwordx4 v24, s[56:59], s30 offen lds
    ds_read_b64_tr_b16 v[232:233], v30 offset:40960
    ds_read_b64_tr_b16 v[234:235], v31 offset:41472
    ds_read_b64_tr_b16 v[236:237], v30 offset:43008
    ds_read_b64_tr_b16 v[238:239], v31 offset:43520
    s_waitcnt vmcnt(30) lgkmcnt(0)
    s_barrier
    s_add_u32 m0, m0, s29
    s_add_u32 s30, s6, 2097152
    buffer_load_dwordx4 v24, s[56:59], s30 offen lds
    s_add_u32 m0, m0, s28
    s_add_u32 s30, s30, s13
    buffer_load_dwordx4 v24, s[56:59], s30 offen lds
    ds_read_b64_tr_b16 v[240:241], v30 offset:49152
    ds_read_b64_tr_b16 v[242:243], v31 offset:49664
    ds_read_b64_tr_b16 v[244:245], v30 offset:51200
    ds_read_b64_tr_b16 v[246:247], v31 offset:51712
    s_waitcnt vmcnt(30) lgkmcnt(0)
    s_barrier
    s_add_u32 m0, m0, s29
    s_add_u32 s30, s6, 2621440
    buffer_load_dwordx4 v24, s[56:59], s30 offen lds
    s_add_u32 m0, m0, s28
    s_add_u32 s30, s30, s13
    buffer_load_dwordx4 v24, s[56:59], s30 offen lds
    ds_read_b64_tr_b16 v[248:249], v30 offset:57344
    ds_read_b64_tr_b16 v[250:251], v31 offset:57856
    ds_read_b64_tr_b16 v[252:253], v30 offset:59392
    ds_read_b64_tr_b16 v[254:255], v31 offset:59904
    s_waitcnt vmcnt(30) lgkmcnt(0)
    s_barrier
    s_add_u32 m0, m0, s29
    s_add_u32 s30, s6, 3145728
    buffer_load_dwordx4 v24, s[56:59], s30 offen lds
    s_add_u32 m0, m0, s28
    s_add_u32 s30, s30, s13
    buffer_load_dwordx4 v24, s[56:59], s30 offen lds
    ds_read_b64_tr_b16 a[0:1], v26 offset:0
    ds_read_b64_tr_b16 a[2:3], v27 offset:512
    ds_read_b64_tr_b16 a[4:5], v26 offset:2048
    ds_read_b64_tr_b16 a[6:7], v27 offset:2560
    s_waitcnt vmcnt(28) lgkmcnt(0)
    s_barrier
    s_add_u32 m0, m0, s29
    s_add_u32 s30, s6, 3670016
    buffer_load_dwordx4 v24, s[56:59], s30 offen lds
    s_add_u32 m0, m0, s28
    s_add_u32 s30, s30, s13
    buffer_load_dwordx4 v24, s[56:59], s30 offen lds
    ds_read_b64_tr_b16 a[8:9], v26 offset:8192
    ds_read_b64_tr_b16 a[10:11], v27 offset:8704
    ds_read_b64_tr_b16 a[12:13], v26 offset:10240
    ds_read_b64_tr_b16 a[14:15], v27 offset:10752
    s_waitcnt vmcnt(26) lgkmcnt(0)
    s_barrier
    s_add_u32 m0, s78, 0
    s_add_u32 s30, s6, 4194304
    buffer_load_dwordx4 v24, s[56:59], s30 offen lds
    s_add_u32 m0, m0, s28
    s_add_u32 s30, s30, s13
    buffer_load_dwordx4 v24, s[56:59], s30 offen lds
    ds_read_b64_tr_b16 a[16:17], v26 offset:16384
    ds_read_b64_tr_b16 a[18:19], v27 offset:16896
    ds_read_b64_tr_b16 a[20:21], v26 offset:18432
    ds_read_b64_tr_b16 a[22:23], v27 offset:18944
    s_waitcnt vmcnt(26) lgkmcnt(0)
    s_barrier
    s_add_u32 m0, m0, s29
    s_add_u32 s30, s6, 4718592
    buffer_load_dwordx4 v24, s[56:59], s30 offen lds
    s_add_u32 m0, m0, s28
    s_add_u32 s30, s30, s13
    buffer_load_dwordx4 v24, s[56:59], s30 offen lds
    ds_read_b64_tr_b16 a[24:25], v26 offset:24576
    ds_read_b64_tr_b16 a[26:27], v27 offset:25088
    ds_read_b64_tr_b16 a[28:29], v26 offset:26624
    ds_read_b64_tr_b16 a[30:31], v27 offset:27136
    s_waitcnt vmcnt(26) lgkmcnt(0)
    s_barrier
    s_add_u32 m0, m0, s29
    s_add_u32 s30, s9, 64
    buffer_load_dwordx4 v25, s[60:63], s30 offen lds
    s_add_u32 m0, m0, s28
    s_add_u32 s30, s30, s81
    buffer_load_dwordx4 v25, s[60:63], s30 offen lds
    ds_read_b64_tr_b16 a[32:33], v26 offset:32768
    ds_read_b64_tr_b16 a[34:35], v27 offset:33280
    ds_read_b64_tr_b16 a[36:37], v26 offset:34816
    ds_read_b64_tr_b16 a[38:39], v27 offset:35328
    s_waitcnt vmcnt(26) lgkmcnt(0)
    s_barrier
    s_add_u32 m0, m0, s29
    s_add_u32 s30, s9, 192
    buffer_load_dwordx4 v25, s[60:63], s30 offen lds
    s_add_u32 m0, m0, s28
    s_add_u32 s30, s30, s81
    buffer_load_dwordx4 v25, s[60:63], s30 offen lds
    ds_read_b64_tr_b16 a[40:41], v26 offset:40960
    ds_read_b64_tr_b16 a[42:43], v27 offset:41472
    ds_read_b64_tr_b16 a[44:45], v26 offset:43008
    ds_read_b64_tr_b16 a[46:47], v27 offset:43520
    s_waitcnt vmcnt(26) lgkmcnt(0)
    s_barrier
    s_add_u32 m0, m0, s29
    s_add_u32 s30, s9, 256
    buffer_load_dwordx4 v25, s[60:63], s30 offen lds
    s_add_u32 m0, m0, s28
    s_add_u32 s30, s30, s81
    buffer_load_dwordx4 v25, s[60:63], s30 offen lds
    ds_read_b64_tr_b16 a[48:49], v26 offset:49152
    ds_read_b64_tr_b16 a[50:51], v27 offset:49664
    ds_read_b64_tr_b16 a[52:53], v26 offset:51200
    ds_read_b64_tr_b16 a[54:55], v27 offset:51712
    s_waitcnt vmcnt(26) lgkmcnt(0)
    s_barrier
    s_add_u32 m0, m0, s29
    s_add_u32 s30, s9, 41024
    buffer_load_dwordx4 v25, s[60:63], s30 offen lds
    s_add_u32 m0, m0, s28
    s_add_u32 s30, s30, s81
    buffer_load_dwordx4 v25, s[60:63], s30 offen lds
    ds_read_b64_tr_b16 a[56:57], v26 offset:57344
    ds_read_b64_tr_b16 a[58:59], v27 offset:57856
    ds_read_b64_tr_b16 a[60:61], v26 offset:59392
    ds_read_b64_tr_b16 a[62:63], v27 offset:59904
    s_waitcnt vmcnt(26) lgkmcnt(0)
    s_barrier
    s_add_u32 m0, m0, s29
    s_add_u32 s30, s9, 41152
    buffer_load_dwordx4 v25, s[60:63], s30 offen lds
    s_add_u32 m0, m0, s28
    s_add_u32 s30, s30, s81
    buffer_load_dwordx4 v25, s[60:63], s30 offen lds
    ds_read_b64_tr_b16 a[64:65], v30 offset:0
    ds_read_b64_tr_b16 a[66:67], v31 offset:512
    ds_read_b64_tr_b16 a[68:69], v30 offset:2048
    ds_read_b64_tr_b16 a[70:71], v31 offset:2560
    s_waitcnt vmcnt(26) lgkmcnt(0)
    s_barrier
    s_add_u32 m0, m0, s29
    s_add_u32 s30, s9, 41216
    buffer_load_dwordx4 v25, s[60:63], s30 offen lds
    s_add_u32 m0, m0, s28
    s_add_u32 s30, s30, s81
    buffer_load_dwordx4 v25, s[60:63], s30 offen lds
    ds_read_b64_tr_b16 a[72:73], v30 offset:8192
    ds_read_b64_tr_b16 a[74:75], v31 offset:8704
    ds_read_b64_tr_b16 a[76:77], v30 offset:10240
    ds_read_b64_tr_b16 a[78:79], v31 offset:10752
    s_waitcnt vmcnt(26) lgkmcnt(0)
    s_barrier
    s_add_u32 m0, m0, s29
    s_add_u32 s30, s9, 81984
    buffer_load_dwordx4 v25, s[60:63], s30 offen lds
    s_add_u32 m0, m0, s28
    s_add_u32 s30, s30, s81
    buffer_load_dwordx4 v25, s[60:63], s30 offen lds
    ds_read_b64_tr_b16 a[80:81], v30 offset:16384
    ds_read_b64_tr_b16 a[82:83], v31 offset:16896
    ds_read_b64_tr_b16 a[84:85], v30 offset:18432
    ds_read_b64_tr_b16 a[86:87], v31 offset:18944
    s_waitcnt vmcnt(26) lgkmcnt(0)
    s_barrier
    s_add_u32 m0, m0, s29
    s_add_u32 s30, s9, 82112
    buffer_load_dwordx4 v25, s[60:63], s30 offen lds
    s_add_u32 m0, m0, s28
    s_add_u32 s30, s30, s81
    buffer_load_dwordx4 v25, s[60:63], s30 offen lds
    ds_read_b64_tr_b16 a[88:89], v30 offset:24576
    ds_read_b64_tr_b16 a[90:91], v31 offset:25088
    ds_read_b64_tr_b16 a[92:93], v30 offset:26624
    ds_read_b64_tr_b16 a[94:95], v31 offset:27136
    s_waitcnt vmcnt(26) lgkmcnt(0)
    s_barrier
    s_add_u32 m0, m0, s29
    s_add_u32 s30, s9, 82176
    buffer_load_dwordx4 v25, s[60:63], s30 offen lds
    s_add_u32 m0, m0, s28
    s_add_u32 s30, s30, s81
    buffer_load_dwordx4 v25, s[60:63], s30 offen lds
    ds_read_b64_tr_b16 a[96:97], v30 offset:32768
    ds_read_b64_tr_b16 a[98:99], v31 offset:33280
    ds_read_b64_tr_b16 a[100:101], v30 offset:34816
    ds_read_b64_tr_b16 a[102:103], v31 offset:35328
    s_waitcnt vmcnt(26) lgkmcnt(0)
    s_barrier
    s_add_u32 m0, m0, s29
    s_add_u32 s30, s9, 122880
    buffer_load_dwordx4 v25, s[60:63], s30 offen lds
    s_add_u32 m0, m0, s28
    s_add_u32 s30, s30, s81
    buffer_load_dwordx4 v25, s[60:63], s30 offen lds
    ds_read_b64_tr_b16 a[104:105], v30 offset:40960
    ds_read_b64_tr_b16 a[106:107], v31 offset:41472
    ds_read_b64_tr_b16 a[108:109], v30 offset:43008
    ds_read_b64_tr_b16 a[110:111], v31 offset:43520
    s_waitcnt vmcnt(26) lgkmcnt(0)
    s_barrier
    s_add_u32 m0, s78, 131072
    s_add_u32 s30, s9, 122944
    buffer_load_dwordx4 v25, s[60:63], s30 offen lds
    s_add_u32 m0, m0, s28
    s_add_u32 s30, s30, s81
    buffer_load_dwordx4 v25, s[60:63], s30 offen lds
    ds_read_b64_tr_b16 a[112:113], v30 offset:49152
    ds_read_b64_tr_b16 a[114:115], v31 offset:49664
    ds_read_b64_tr_b16 a[116:117], v30 offset:51200
    ds_read_b64_tr_b16 a[118:119], v31 offset:51712
    s_waitcnt vmcnt(26) lgkmcnt(0)
    s_barrier
    s_add_u32 m0, m0, s29
    s_add_u32 s30, s9, 123008
    buffer_load_dwordx4 v25, s[60:63], s30 offen lds
    s_add_u32 m0, m0, s28
    s_add_u32 s30, s30, s81
    buffer_load_dwordx4 v25, s[60:63], s30 offen lds
    ds_read_b64_tr_b16 a[120:121], v30 offset:57344
    ds_read_b64_tr_b16 a[122:123], v31 offset:57856
    ds_read_b64_tr_b16 a[124:125], v30 offset:59392
    ds_read_b64_tr_b16 a[126:127], v31 offset:59904
    s_waitcnt vmcnt(26) lgkmcnt(0)
    s_barrier
    s_add_u32 m0, m0, s29
    s_add_u32 s30, s9, 123072
    buffer_load_dwordx4 v25, s[60:63], s30 offen lds
    s_add_u32 m0, m0, s28
    s_add_u32 s30, s30, s81
    buffer_load_dwordx4 v25, s[60:63], s30 offen lds
    ds_read_b64_tr_b16 a[128:129], v26 offset:0
    ds_read_b64_tr_b16 a[130:131], v27 offset:512
    ds_read_b64_tr_b16 a[132:133], v26 offset:2048
    ds_read_b64_tr_b16 a[134:135], v27 offset:2560
    s_waitcnt vmcnt(26) lgkmcnt(0)
    s_barrier
    s_add_u32 m0, m0, s29
    s_add_u32 s30, s9, 123136
    buffer_load_dwordx4 v25, s[60:63], s30 offen lds
    s_add_u32 m0, m0, s28
    s_add_u32 s30, s30, s81
    buffer_load_dwordx4 v25, s[60:63], s30 offen lds
    ds_read_b64_tr_b16 a[136:137], v26 offset:8192
    ds_read_b64_tr_b16 a[138:139], v27 offset:8704
    ds_read_b64_tr_b16 a[140:141], v26 offset:10240
    ds_read_b64_tr_b16 a[142:143], v27 offset:10752
    s_waitcnt vmcnt(26) lgkmcnt(0)
    s_barrier
    ds_read_b64_tr_b16 a[152:153], v26 offset:16384
    ds_read_b64_tr_b16 a[154:155], v27 offset:16896
    ds_read_b64_tr_b16 a[156:157], v26 offset:18432
    ds_read_b64_tr_b16 a[158:159], v27 offset:18944
    s_waitcnt vmcnt(24) lgkmcnt(0)
    s_barrier
    ds_read_b64_tr_b16 a[192:193], v26 offset:24576
    ds_read_b64_tr_b16 a[194:195], v27 offset:25088
    ds_read_b64_tr_b16 a[196:197], v26 offset:26624
    ds_read_b64_tr_b16 a[198:199], v27 offset:27136
    s_waitcnt vmcnt(22) lgkmcnt(0)
    s_barrier
    ds_read_b64_tr_b16 a[224:225], v26 offset:32768
    ds_read_b64_tr_b16 a[226:227], v27 offset:33280
    ds_read_b64_tr_b16 a[228:229], v26 offset:34816
    ds_read_b64_tr_b16 a[230:231], v27 offset:35328
    s_waitcnt vmcnt(20) lgkmcnt(0)
    s_barrier
    ds_read_b64_tr_b16 a[160:161], v26 offset:40960
    ds_read_b64_tr_b16 a[162:163], v27 offset:41472
    ds_read_b64_tr_b16 a[164:165], v26 offset:43008
    ds_read_b64_tr_b16 a[166:167], v27 offset:43520
    s_waitcnt vmcnt(18) lgkmcnt(0)
    s_barrier
    ds_read_b64_tr_b16 a[200:201], v26 offset:49152
    ds_read_b64_tr_b16 a[202:203], v27 offset:49664
    ds_read_b64_tr_b16 a[204:205], v26 offset:51200
    ds_read_b64_tr_b16 a[206:207], v27 offset:51712
    s_waitcnt vmcnt(16) lgkmcnt(0)
    s_barrier
    ds_read_b64_tr_b16 a[232:233], v26 offset:57344
    ds_read_b64_tr_b16 a[234:235], v27 offset:57856
    ds_read_b64_tr_b16 a[236:237], v26 offset:59392
    ds_read_b64_tr_b16 a[238:239], v27 offset:59904
    s_waitcnt vmcnt(14) lgkmcnt(0)
    s_barrier
    ds_read_b64_tr_b16 a[168:169], v30 offset:0
    ds_read_b64_tr_b16 a[170:171], v31 offset:512
    ds_read_b64_tr_b16 a[172:173], v30 offset:2048
    ds_read_b64_tr_b16 a[174:175], v31 offset:2560
    s_waitcnt vmcnt(12) lgkmcnt(0)
    s_barrier
    ds_read_b64_tr_b16 a[208:209], v30 offset:8192
    ds_read_b64_tr_b16 a[210:211], v31 offset:8704
    ds_read_b64_tr_b16 a[212:213], v30 offset:10240
    ds_read_b64_tr_b16 a[214:215], v31 offset:10752
    s_waitcnt vmcnt(10) lgkmcnt(0)
    s_barrier
    ds_read_b64_tr_b16 a[240:241], v30 offset:16384
    ds_read_b64_tr_b16 a[242:243], v31 offset:16896
    ds_read_b64_tr_b16 a[244:245], v30 offset:18432
    ds_read_b64_tr_b16 a[246:247], v31 offset:18944
    s_waitcnt vmcnt(8) lgkmcnt(0)
    s_barrier
    ds_read_b64_tr_b16 a[144:145], v30 offset:24576
    ds_read_b64_tr_b16 a[146:147], v31 offset:25088
    ds_read_b64_tr_b16 a[148:149], v30 offset:26624
    ds_read_b64_tr_b16 a[150:151], v31 offset:27136
    s_waitcnt vmcnt(6) lgkmcnt(0)
    s_barrier
    s_add_u32 m0, s79, 0
    s_add_u32 s30, s6, 262144
    buffer_load_dwordx4 v24, s[56:59], s30 offen lds
    s_add_u32 m0, m0, s28
    s_add_u32 s30, s30, s13
    buffer_load_dwordx4 v24, s[56:59], s30 offen lds
    s_add_u32 m0, m0, s28
    s_add_u32 s30, s6, 786432
    buffer_load_dwordx4 v24, s[56:59], s30 offen lds
    s_add_u32 m0, m0, s28
    s_add_u32 s30, s30, s13
    buffer_load_dwordx4 v24, s[56:59], s30 offen lds
    s_add_u32 m0, m0, s28
    s_add_u32 s30, s6, 1310720
    buffer_load_dwordx4 v24, s[56:59], s30 offen lds
    s_add_u32 m0, m0, s28
    s_add_u32 s30, s30, s13
    buffer_load_dwordx4 v24, s[56:59], s30 offen lds
    s_add_u32 m0, m0, s28
    s_add_u32 s30, s6, 1835008
    buffer_load_dwordx4 v24, s[56:59], s30 offen lds
    s_add_u32 m0, m0, s28
    s_add_u32 s30, s30, s13
    buffer_load_dwordx4 v24, s[56:59], s30 offen lds
    ds_read_b64_tr_b16 a[176:177], v28 offset:0
    ds_read_b64_tr_b16 a[178:179], v29 offset:512
    ds_read_b64_tr_b16 a[180:181], v28 offset:2048
    ds_read_b64_tr_b16 a[182:183], v29 offset:2560
    s_waitcnt vmcnt(12) lgkmcnt(0)
    s_barrier
    s_add_u32 m0, m0, s28
    s_add_u32 s30, s6, 2359296
    buffer_load_dwordx4 v24, s[56:59], s30 offen lds
    s_add_u32 m0, m0, s28
    s_add_u32 s30, s30, s13
    buffer_load_dwordx4 v24, s[56:59], s30 offen lds
    s_add_u32 m0, m0, s28
    s_add_u32 s30, s6, 2883584
    buffer_load_dwordx4 v24, s[56:59], s30 offen lds
    s_add_u32 m0, m0, s28
    s_add_u32 s30, s30, s13
    buffer_load_dwordx4 v24, s[56:59], s30 offen lds
    s_add_u32 m0, m0, s28
    s_add_u32 s30, s6, 3407872
    buffer_load_dwordx4 v24, s[56:59], s30 offen lds
    s_add_u32 m0, m0, s28
    s_add_u32 s30, s30, s13
    buffer_load_dwordx4 v24, s[56:59], s30 offen lds
    s_add_u32 m0, m0, s28
    s_add_u32 s30, s6, 3932160
    buffer_load_dwordx4 v24, s[56:59], s30 offen lds
    s_add_u32 m0, m0, s28
    s_add_u32 s30, s30, s13
    buffer_load_dwordx4 v24, s[56:59], s30 offen lds
    ds_read_b64_tr_b16 a[184:185], v28 offset:8192
    ds_read_b64_tr_b16 a[186:187], v29 offset:8704
    ds_read_b64_tr_b16 a[188:189], v28 offset:10240
    ds_read_b64_tr_b16 a[190:191], v29 offset:10752
    s_waitcnt vmcnt(18) lgkmcnt(0)
    s_barrier
    s_add_u32 m0, m0, s28
    s_add_u32 s30, s6, 4456448
    buffer_load_dwordx4 v24, s[56:59], s30 offen lds
    s_add_u32 m0, m0, s28
    s_add_u32 s30, s30, s13
    buffer_load_dwordx4 v24, s[56:59], s30 offen lds
    s_add_u32 m0, m0, s28
    s_add_u32 s30, s6, 4980736
    buffer_load_dwordx4 v24, s[56:59], s30 offen lds
    s_add_u32 m0, m0, s28
    s_add_u32 s30, s30, s13
    buffer_load_dwordx4 v24, s[56:59], s30 offen lds
    s_add_u32 m0, m0, s28
    s_add_u32 s30, s9, 0
    buffer_load_dwordx4 v25, s[60:63], s30 offen lds
    s_add_u32 m0, m0, s28
    s_add_u32 s30, s30, s81
    buffer_load_dwordx4 v25, s[60:63], s30 offen lds
    s_add_u32 m0, m0, s28
    s_add_u32 s30, s9, 40960
    buffer_load_dwordx4 v25, s[60:63], s30 offen lds
    s_add_u32 m0, m0, s28
    s_add_u32 s30, s30, s81
    buffer_load_dwordx4 v25, s[60:63], s30 offen lds
    ds_read_b64_tr_b16 a[216:217], v28 offset:16384
    ds_read_b64_tr_b16 a[218:219], v29 offset:16896
    ds_read_b64_tr_b16 a[220:221], v28 offset:18432
    ds_read_b64_tr_b16 a[222:223], v29 offset:18944
    s_waitcnt vmcnt(24) lgkmcnt(0)
    s_barrier
    s_add_u32 m0, m0, s28
    s_add_u32 s30, s9, 81920
    buffer_load_dwordx4 v25, s[60:63], s30 offen lds
    s_add_u32 m0, m0, s28
    s_add_u32 s30, s30, s81
    buffer_load_dwordx4 v25, s[60:63], s30 offen lds
    s_add_u32 m0, m0, s28
    s_add_u32 s30, s9, 128
    buffer_load_dwordx4 v25, s[60:63], s30 offen lds
    s_add_u32 m0, m0, s28
    s_add_u32 s30, s30, s81
    buffer_load_dwordx4 v25, s[60:63], s30 offen lds
    s_add_u32 m0, m0, s28
    s_add_u32 s30, s9, 41088
    buffer_load_dwordx4 v25, s[60:63], s30 offen lds
    s_add_u32 m0, m0, s28
    s_add_u32 s30, s30, s81
    buffer_load_dwordx4 v25, s[60:63], s30 offen lds
    s_add_u32 m0, m0, s28
    s_add_u32 s30, s9, 82048
    buffer_load_dwordx4 v25, s[60:63], s30 offen lds
    s_add_u32 m0, m0, s28
    s_add_u32 s30, s30, s81
    buffer_load_dwordx4 v25, s[60:63], s30 offen lds
    ds_read_b64_tr_b16 a[248:249], v28 offset:24576
    ds_read_b64_tr_b16 a[250:251], v29 offset:25088
    ds_read_b64_tr_b16 a[252:253], v28 offset:26624
    ds_read_b64_tr_b16 a[254:255], v29 offset:27136
    v_and_b32 v20, 1, v18
    v_lshrrev_b32 v21, 1, v18
    v_lshrrev_b32 v22, 2, v17
    v_and_b32 v23, 1, v22
    v_lshlrev_b32 v28, 4, v20
    v_lshl_add_u32 v28, v21, 2, v28
    v_add_u32 v28, v28, v23
    v_lshlrev_b32 v28, 8, v28
    v_sub_u32 v28, v26, v28
    v_sub_u32 v29, v27, v28
    v_sub_u32 v29, v27, v29
    v_lshlrev_b32 v30, 16, v20
    v_lshl_add_u32 v31, v21, 2, v23
    v_lshl_add_u32 v30, v31, 8, v30
    v_add_u32 v28, v28, v30
    v_xor_b32 v29, 0x80, v28
    v_mbcnt_lo_u32_b32 v49, -1, 0
    v_mbcnt_hi_u32_b32 v49, -1, v49
    v_lshlrev_b32 v49, 2, v49
    global_load_dword v48, v49, s[40:41] sc1
    v_mov_b32 v52, 0
    buffer_load_dwordx2 v[50:51], v52, s[44:47], s86 offen sc1
    s_waitcnt vmcnt(32) lgkmcnt(0)
    s_barrier
    ds_read_b64_tr_b16 v[32:33], v28 offset:0
    ds_read_b64_tr_b16 v[34:35], v29 offset:512
    ds_read_b64_tr_b16 v[36:37], v28 offset:32768
    ds_read_b64_tr_b16 v[38:39], v29 offset:33280
    s_waitcnt vmcnt(30) lgkmcnt(0)
    s_barrier
    ds_write_b128 v4, v[32:35] offset:0
    ds_write_b128 v4, v[36:39] offset:1024
    ds_read_b64_tr_b16 v[40:41], v28 offset:2048
    ds_read_b64_tr_b16 v[42:43], v29 offset:2560
    ds_read_b64_tr_b16 v[44:45], v28 offset:34816
    ds_read_b64_tr_b16 v[46:47], v29 offset:35328
    s_waitcnt vmcnt(28) lgkmcnt(0)
    s_barrier
    ds_write_b128 v4, v[40:43] offset:2048
    ds_write_b128 v4, v[44:47] offset:3072
    ds_read_b64_tr_b16 v[32:33], v28 offset:4096
    ds_read_b64_tr_b16 v[34:35], v29 offset:4608
    ds_read_b64_tr_b16 v[36:37], v28 offset:36864
    ds_read_b64_tr_b16 v[38:39], v29 offset:37376
    s_waitcnt vmcnt(26) lgkmcnt(0)
    s_barrier
    ds_write_b128 v4, v[32:35] offset:4096
    ds_write_b128 v4, v[36:39] offset:5120
    ds_read_b64_tr_b16 v[40:41], v28 offset:6144
    ds_read_b64_tr_b16 v[42:43], v29 offset:6656
    ds_read_b64_tr_b16 v[44:45], v28 offset:38912
    ds_read_b64_tr_b16 v[46:47], v29 offset:39424
    s_waitcnt vmcnt(24) lgkmcnt(0)
    s_barrier
    ds_write_b128 v4, v[40:43] offset:6144
    ds_write_b128 v4, v[44:47] offset:7168
    ds_read_b64_tr_b16 v[32:33], v28 offset:8192
    ds_read_b64_tr_b16 v[34:35], v29 offset:8704
    ds_read_b64_tr_b16 v[36:37], v28 offset:40960
    ds_read_b64_tr_b16 v[38:39], v29 offset:41472
    s_waitcnt vmcnt(22) lgkmcnt(0)
    s_barrier
    ds_write_b128 v4, v[32:35] offset:8192
    ds_write_b128 v4, v[36:39] offset:9216
    ds_read_b64_tr_b16 v[40:41], v28 offset:10240
    ds_read_b64_tr_b16 v[42:43], v29 offset:10752
    ds_read_b64_tr_b16 v[44:45], v28 offset:43008
    ds_read_b64_tr_b16 v[46:47], v29 offset:43520
    s_waitcnt vmcnt(20) lgkmcnt(0)
    s_barrier
    ds_write_b128 v4, v[40:43] offset:10240
    ds_write_b128 v4, v[44:47] offset:11264
    ds_read_b64_tr_b16 v[32:33], v28 offset:12288
    ds_read_b64_tr_b16 v[34:35], v29 offset:12800
    ds_read_b64_tr_b16 v[36:37], v28 offset:45056
    ds_read_b64_tr_b16 v[38:39], v29 offset:45568
    s_waitcnt vmcnt(18) lgkmcnt(0)
    s_barrier
    ds_write_b128 v4, v[32:35] offset:12288
    ds_write_b128 v4, v[36:39] offset:13312
    ds_read_b64_tr_b16 v[40:41], v28 offset:14336
    ds_read_b64_tr_b16 v[42:43], v29 offset:14848
    ds_read_b64_tr_b16 v[44:45], v28 offset:47104
    ds_read_b64_tr_b16 v[46:47], v29 offset:47616
    s_waitcnt vmcnt(16) lgkmcnt(0)
    s_barrier
    ds_write_b128 v4, v[40:43] offset:14336
    ds_write_b128 v4, v[44:47] offset:15360
    ds_read_b64_tr_b16 v[32:33], v28 offset:16384
    ds_read_b64_tr_b16 v[34:35], v29 offset:16896
    ds_read_b64_tr_b16 v[36:37], v28 offset:49152
    ds_read_b64_tr_b16 v[38:39], v29 offset:49664
    s_waitcnt vmcnt(14) lgkmcnt(0)
    s_barrier
    ds_write_b128 v4, v[32:35] offset:16384
    ds_write_b128 v4, v[36:39] offset:17408
    ds_read_b64_tr_b16 v[40:41], v28 offset:18432
    ds_read_b64_tr_b16 v[42:43], v29 offset:18944
    ds_read_b64_tr_b16 v[44:45], v28 offset:51200
    ds_read_b64_tr_b16 v[46:47], v29 offset:51712
    s_waitcnt vmcnt(12) lgkmcnt(0)
    s_barrier
    ds_write_b128 v4, v[40:43] offset:18432
    ds_write_b128 v4, v[44:47] offset:19456
    ds_read_b64_tr_b16 v[32:33], v28 offset:20480
    ds_read_b64_tr_b16 v[34:35], v29 offset:20992
    ds_read_b64_tr_b16 v[36:37], v28 offset:53248
    ds_read_b64_tr_b16 v[38:39], v29 offset:53760
    s_waitcnt vmcnt(10) lgkmcnt(0)
    s_barrier
    ds_write_b128 v4, v[32:35] offset:20480
    ds_write_b128 v4, v[36:39] offset:21504
    ds_read_b64_tr_b16 v[40:41], v28 offset:22528
    ds_read_b64_tr_b16 v[42:43], v29 offset:23040
    ds_read_b64_tr_b16 v[44:45], v28 offset:55296
    ds_read_b64_tr_b16 v[46:47], v29 offset:55808
    s_waitcnt vmcnt(8) lgkmcnt(0)
    s_barrier
    ds_write_b128 v4, v[40:43] offset:22528
    ds_write_b128 v4, v[44:47] offset:23552
    ds_read_b64_tr_b16 v[32:33], v28 offset:24576
    ds_read_b64_tr_b16 v[34:35], v29 offset:25088
    ds_read_b64_tr_b16 v[36:37], v28 offset:57344
    ds_read_b64_tr_b16 v[38:39], v29 offset:57856
    s_waitcnt vmcnt(6) lgkmcnt(0)
    s_barrier
    ds_write_b128 v4, v[32:35] offset:24576
    ds_write_b128 v4, v[36:39] offset:25600
    ds_read_b64_tr_b16 v[40:41], v28 offset:26624
    ds_read_b64_tr_b16 v[42:43], v29 offset:27136
    ds_read_b64_tr_b16 v[44:45], v28 offset:59392
    ds_read_b64_tr_b16 v[46:47], v29 offset:59904
    s_waitcnt vmcnt(4) lgkmcnt(0)
    s_barrier
    ds_write_b128 v4, v[40:43] offset:26624
    ds_write_b128 v4, v[44:47] offset:27648
    ds_read_b64_tr_b16 v[32:33], v28 offset:28672
    ds_read_b64_tr_b16 v[34:35], v29 offset:29184
    ds_read_b64_tr_b16 v[36:37], v28 offset:61440
    ds_read_b64_tr_b16 v[38:39], v29 offset:61952
    s_waitcnt vmcnt(2) lgkmcnt(0)
    s_barrier
    ds_write_b128 v4, v[32:35] offset:28672
    ds_write_b128 v4, v[36:39] offset:29696
    ds_read_b64_tr_b16 v[40:41], v28 offset:30720
    ds_read_b64_tr_b16 v[42:43], v29 offset:31232
    ds_read_b64_tr_b16 v[44:45], v28 offset:63488
    ds_read_b64_tr_b16 v[46:47], v29 offset:64000
    s_waitcnt lgkmcnt(0)
    s_barrier
    ds_write_b128 v4, v[40:43] offset:30720
    ds_write_b128 v4, v[44:47] offset:31744
    s_waitcnt vmcnt(0) lgkmcnt(0)
    s_barrier
    v_lshrrev_b32 v17, 4, v2
    v_and_b32 v17, 15, v17
    v_bfe_u32 v20, v17, 1, 2
    v_cmp_eq_u32 vcc, 0, v20
    s_nop 1
    s_mov_b64 s[48:49], vcc
    v_cmp_eq_u32 vcc, 1, v20
    s_nop 1
    s_mov_b64 s[50:51], vcc
    v_cmp_eq_u32 vcc, 2, v20
    s_nop 1
    s_mov_b64 s[52:53], vcc
    v_cmp_eq_u32 vcc, 3, v20
    s_nop 1
    s_mov_b64 s[54:55], vcc
    v_and_b32 v20, 1, v17
    v_cmp_eq_u32 vcc, 1, v20
    s_nop 1
    s_mov_b64 s[56:57], vcc
    s_mov_b32 s65, 0
    s_mov_b32 s74, 0
    v_min_u32 v50, v50, v51
    s_add_u32 s77, s11, 32
    v_cmp_ne_u32 vcc, 32, v48
    v_readlane_b32 s78, v48, s77
    v_readlane_b32 s79, v48, 36
    s_and_b32 s77, vcc_lo, 0xff
    v_readfirstlane_b32 s81, v50
    s_cmp_eq_u32 s11, 0
    s_cselect_b32 s77, s77, 0
    s_cmp_lg_u32 s77, 0
    s_cbranch_scc1 L_ch_slowchk
    s_cmp_lt_u32 s78, 256
    s_cbranch_scc1 L_ch_slowchk
    s_cmp_lt_u32 s79, 128
    s_cbranch_scc1 L_ch_slowchk
    s_cmp_eq_u32 s81, 0
    s_cbranch_scc1 L_ch_slowchk
    s_mov_b32 s74, s81
    s_branch L_ch_chkdone
L_ch_slowchk:
    s_lshl_b32 s6, s11, 2
    s_add_u32 s6, s6, 128
    v_mov_b32 v14, s6
    s_mov_b32 s12, 0
L_winit_21:
    global_load_dword v15, v14, s[40:41] sc1
    s_waitcnt vmcnt(0)
    v_readfirstlane_b32 s6, v15
    s_add_u32 s12, s12, 1
    s_cmp_ge_u32 s6, 256
    s_cbranch_scc1 L_winit_21_out
    s_sleep 4
    s_cmp_lt_u32 s12, 100000
    s_cbranch_scc1 L_winit_21
L_winit_21_out:
    s_cmp_lg_u32 s11, 0
    s_cbranch_scc1 L_winit_21_ok
    v_mbcnt_lo_u32_b32 v14, -1, 0
    v_mbcnt_hi_u32_b32 v14, -1, v14
    v_and_b32 v14, 7, v14
    v_lshlrev_b32 v14, 2, v14
    global_load_dword v15, v14, s[40:41] sc1
    s_waitcnt vmcnt(0)
    v_cmp_ne_u32 vcc, 32, v15
    s_nop 4
    s_cbranch_vccnz L_fallback
L_winit_21_ok:
    v_mov_b32 v14, 144
    s_mov_b32 s12, 0
L_wc_22:
    global_load_dword v15, v14, s[40:41] sc1
    s_waitcnt vmcnt(0)
    v_readfirstlane_b32 s6, v15
    s_add_u32 s12, s12, 1
    s_cmp_ge_u32 s6, 128
    s_cbranch_scc1 L_wc_22_out
    s_sleep 8
    s_cmp_lt_u32 s12, 100000
    s_cbranch_scc1 L_wc_22
L_wc_22_out:
    s_cmp_lt_u32 s65, s74
    s_cbranch_scc1 L_kvr_23_out
    s_mov_b32 s12, 0
L_kvr_23:
    v_mov_b32 v38, 0
    buffer_load_dwordx2 v[38:39], v38, s[44:47], s86 offen sc1
    s_waitcnt vmcnt(0)
    v_min_u32 v38, v38, v39
    s_nop 0
    v_readfirstlane_b32 s74, v38
    s_add_u32 s12, s12, 1
    s_cmp_lt_u32 s65, s74
    s_cbranch_scc1 L_kvr_23_out
    s_sleep 2
    s_cmp_lt_u32 s12, 100000
    s_cbranch_scc1 L_kvr_23
L_kvr_23_out:
L_ch_chkdone:
    s_lshl_b32 s77, s64, 13
    s_add_u32 s75, s77, 0x1fa0000
    s_add_u32 s76, s77, 0x2fa0000
    s_lshl_b32 s77, s3, 11
    s_add_u32 s9, s77, 147456
    s_lshl_b32 s77, s3, 10
    s_add_u32 s10, s77, 155648
    s_waitcnt vmcnt(0)
    s_add_u32 s79, s72, 0
    buffer_load_dwordx4 v[48:51], v2, s[44:47], s79 offen
    buffer_load_dwordx4 v[52:55], v2, s[44:47], s79 offen offset:1024
    s_add_u32 s79, s72, 2048
    buffer_load_dwordx4 v[56:59], v2, s[44:47], s79 offen
    buffer_load_dwordx4 v[60:63], v2, s[44:47], s79 offen offset:1024
    s_add_u32 s79, s72, 4096
    buffer_load_dwordx4 v[8:11], v2, s[44:47], s79 offen
    buffer_load_dwordx4 v[12:15], v2, s[44:47], s79 offen offset:1024
    s_waitcnt vmcnt(0)
    s_lshl_b32 s73, s64, 12
    s_add_u32 s73, s73, 0x5c0000
    s_mov_b32 s70, 0xc5000
    s_mov_b32 s61, 1
    s_mov_b32 s65, -1
    s_cmp_lg_u32 s11, 0
    s_cbranch_scc1 L_mode1_28
    s_mov_b32 s68, s67
    s_mov_b32 s62, s61
    s_mov_b32 s69, s70
    s_mov_b32 s59, s65
    s_add_u32 s65, s65, 1
    s_add_u32 s73, s73, 131072
    s_add_u32 s75, s75, 262144
    s_add_u32 s76, s76, 262144
    s_lshl_b32 s77, s3, 11
    s_add_u32 s13, s75, s77
    s_add_u32 s71, s76, s77
    s_mov_b32 s67, 0x20000
    s_mov_b32 s70, 0xc0000
    s_and_b32 s61, s65, 1
    s_xor_b32 s61, s61, 1
    s_add_u32 s81, s65, 1
    s_min_u32 s81, s81, 63
    s_cmp_ge_u32 s3, 2
    s_cselect_b32 s58, s76, s75
    s_and_b32 s78, s3, 1
    s_lshl_b32 s78, s78, 12
    s_add_u32 s58, s58, s78
    s_cmp_eq_u32 s65, 63
    s_cselect_b32 s78, 0, 262144
    s_add_u32 s58, s58, s78
    s_add_u32 s58, s58, 131072
    s_sub_u32 s60, s73, 131072
    s_cmp_eq_u32 s65, 0
    s_cselect_b32 s60, 0x7f000000, s60
    s_cmp_lt_u32 s81, s74
    s_cbranch_scc1 L_kvr_24_out
    s_mov_b32 s12, 0
L_kvr_24:
    v_mov_b32 v38, 0
    buffer_load_dwordx2 v[38:39], v38, s[44:47], s86 offen sc1
    s_waitcnt vmcnt(0)
    v_min_u32 v38, v38, v39
    s_nop 0
    v_readfirstlane_b32 s74, v38
    s_add_u32 s12, s12, 1
    s_cmp_lt_u32 s81, s74
    s_cbranch_scc1 L_kvr_24_out
    s_sleep 2
    s_cmp_lt_u32 s12, 100000
    s_cbranch_scc1 L_kvr_24
L_kvr_24_out:
    s_cmp_lt_u32 s3, 2
    s_cbranch_scc1 L_kv_25
    s_cmp_eq_u32 s3, 3
    s_cbranch_scc1 L_kv_25_v
    s_mov_b32 s77, s75
    s_mov_b32 m0, 147456
    s_nop 0
    buffer_load_dwordx4 v2, s[44:47], s77 offen nt lds
    s_add_u32 s77, s77, 1024
    s_mov_b32 m0, 148480
    s_nop 0
    buffer_load_dwordx4 v2, s[44:47], s77 offen nt lds
    s_add_u32 s77, s77, 1024
    s_mov_b32 m0, 149504
    s_nop 0
    buffer_load_dwordx4 v2, s[44:47], s77 offen nt lds
    s_add_u32 s77, s77, 1024
    s_mov_b32 m0, 150528
    s_nop 0
    buffer_load_dwordx4 v2, s[44:47], s77 offen nt lds
    s_add_u32 s77, s77, 1024
    s_mov_b32 m0, 151552
    s_nop 0
    buffer_load_dwordx4 v2, s[44:47], s77 offen nt lds
    s_add_u32 s77, s77, 1024
    s_mov_b32 m0, 152576
    s_nop 0
    buffer_load_dwordx4 v2, s[44:47], s77 offen nt lds
    s_add_u32 s77, s77, 1024
    s_mov_b32 m0, 153600
    s_nop 0
    buffer_load_dwordx4 v2, s[44:47], s77 offen nt lds
    s_add_u32 s77, s77, 1024
    s_mov_b32 m0, 154624
    s_nop 0
    buffer_load_dwordx4 v2, s[44:47], s77 offen nt lds
    s_branch L_kv_25
L_kv_25_v:
    s_mov_b32 s77, s76
    s_mov_b32 m0, 155648
    s_nop 0
    buffer_load_dwordx4 v2, s[44:47], s77 offen nt lds
    s_add_u32 s77, s77, 1024
    s_mov_b32 m0, 159744
    s_nop 0
    buffer_load_dwordx4 v2, s[44:47], s77 offen nt lds
    s_add_u32 s77, s77, 1024
    s_mov_b32 m0, 156672
    s_nop 0
    buffer_load_dwordx4 v2, s[44:47], s77 offen nt lds
    s_add_u32 s77, s77, 1024
    s_mov_b32 m0, 160768
    s_nop 0
    buffer_load_dwordx4 v2, s[44:47], s77 offen nt lds
    s_add_u32 s77, s77, 1024
    s_mov_b32 m0, 157696
    s_nop 0
    buffer_load_dwordx4 v2, s[44:47], s77 offen nt lds
    s_add_u32 s77, s77, 1024
    s_mov_b32 m0, 161792
    s_nop 0
    buffer_load_dwordx4 v2, s[44:47], s77 offen nt lds
    s_add_u32 s77, s77, 1024
    s_mov_b32 m0, 158720
    s_nop 0
    buffer_load_dwordx4 v2, s[44:47], s77 offen nt lds
    s_add_u32 s77, s77, 1024
    s_mov_b32 m0, 162816
    s_nop 0
    buffer_load_dwordx4 v2, s[44:47], s77 offen nt lds
L_kv_25:
    s_cmp_ge_u32 s3, 2
    s_cbranch_scc1 L_ch_join
    s_branch L_ch_hopA
L_ch_hop:
    s_mov_b32 s68, s67
    s_mov_b32 s62, s61
    s_mov_b32 s69, s70
    s_mov_b32 s59, s65
    s_add_u32 s65, s65, 1
    s_add_u32 s73, s73, 131072
    s_add_u32 s75, s75, 262144
    s_add_u32 s76, s76, 262144
    s_lshl_b32 s77, s3, 11
    s_add_u32 s13, s75, s77
    s_add_u32 s71, s76, s77
    s_mov_b32 s67, 0x20000
    s_mov_b32 s70, 0xc0000
    s_and_b32 s61, s65, 1
    s_xor_b32 s61, s61, 1
    s_add_u32 s81, s65, 1
    s_min_u32 s81, s81, 63
    s_cmp_ge_u32 s3, 2
    s_cselect_b32 s58, s76, s75
    s_and_b32 s78, s3, 1
    s_lshl_b32 s78, s78, 12
    s_add_u32 s58, s58, s78
    s_cmp_eq_u32 s65, 63
    s_cselect_b32 s78, 0, 262144
    s_add_u32 s58, s58, s78
    s_add_u32 s58, s58, 131072
    s_sub_u32 s60, s73, 131072
    s_cmp_eq_u32 s65, 0
    s_cselect_b32 s60, 0x7f000000, s60
    s_cmp_lt_u32 s81, s74
    s_cbranch_scc1 L_kvr_26_out
    s_mov_b32 s12, 0
L_kvr_26:
    v_mov_b32 v38, 0
    buffer_load_dwordx2 v[38:39], v38, s[44:47], s86 offen sc1
    s_waitcnt vmcnt(0)
    v_min_u32 v38, v38, v39
    s_nop 0
    v_readfirstlane_b32 s74, v38
    s_add_u32 s12, s12, 1
    s_cmp_lt_u32 s81, s74
    s_cbranch_scc1 L_kvr_26_out
    s_sleep 2
    s_cmp_lt_u32 s12, 100000
    s_cbranch_scc1 L_kvr_26
L_kvr_26_out:
    s_cmp_eq_u32 s66, -1
    s_cbranch_scc1 L_ch_notown
    s_add_u32 s78, s68, s7
    s_add_u32 s77, s78, 4096
    s_mov_b32 s12, 0
    v_mov_b32 v52, 0x3f80
    v_mov_b32 v53, 0x3f800000
    v_cndmask_b32 v52, v52, v53, s[56:57]
    v_cndmask_b32 v10, 0, v52, s[48:49]
    v_cndmask_b32 v11, 0, v52, s[50:51]
    v_cndmask_b32 v12, 0, v52, s[52:53]
    v_cndmask_b32 v13, 0, v52, s[54:55]
L_ch_pollB:
    buffer_load_dwordx4 v[16:19], v2, s[44:47], s78 offen offset:0 sc1
    buffer_load_dwordx4 v[20:23], v2, s[44:47], s78 offen offset:1024 sc1
    buffer_load_dwordx4 v[24:27], v2, s[44:47], s78 offen offset:2048 sc1
    buffer_load_dwordx4 v[28:31], v2, s[44:47], s78 offen offset:3072 sc1
    buffer_load_dwordx4 v[32:35], v2, s[44:47], s77 offen offset:0 sc1
    buffer_load_dwordx4 v[36:39], v2, s[44:47], s77 offen offset:1024 sc1
    buffer_load_dwordx4 v[40:43], v2, s[44:47], s77 offen offset:2048 sc1
    buffer_load_dwordx4 v[44:47], v2, s[44:47], s77 offen offset:3072 sc1
    s_add_u32 s12, s12, 1
    s_waitcnt vmcnt(7)
    v_mfma_f32_16x16x32_bf16 v[48:51], v[16:19], v[10:13], 0
    v_bitop3_b32 v52, v17, s62, 0 bitop3:0xbe
    v_bitop3_b32 v52, v19, s62, v52 bitop3:0xbe
    s_waitcnt vmcnt(6)
    v_mfma_f32_16x16x32_bf16 v[48:51], v[20:23], v[10:13], v[48:51]
    v_bitop3_b32 v52, v21, s62, v52 bitop3:0xbe
    v_bitop3_b32 v52, v23, s62, v52 bitop3:0xbe
    s_waitcnt vmcnt(5)
    v_mfma_f32_16x16x32_bf16 v[48:51], v[24:27], v[10:13], v[48:51]
    v_bitop3_b32 v52, v25, s62, v52 bitop3:0xbe
    v_bitop3_b32 v52, v27, s62, v52 bitop3:0xbe
    s_waitcnt vmcnt(4)
    v_mfma_f32_16x16x32_bf16 v[48:51], v[28:31], v[10:13], v[48:51]
    v_bitop3_b32 v52, v29, s62, v52 bitop3:0xbe
    v_bitop3_b32 v52, v31, s62, v52 bitop3:0xbe
    s_waitcnt vmcnt(3)
    v_mfma_f32_16x16x32_bf16 v[48:51], v[32:35], v[10:13], v[48:51]
    v_bitop3_b32 v52, v33, s62, v52 bitop3:0xbe
    v_bitop3_b32 v52, v35, s62, v52 bitop3:0xbe
    s_waitcnt vmcnt(2)
    v_mfma_f32_16x16x32_bf16 v[48:51], v[36:39], v[10:13], v[48:51]
    v_bitop3_b32 v52, v37, s62, v52 bitop3:0xbe
    v_bitop3_b32 v52, v39, s62, v52 bitop3:0xbe
    s_waitcnt vmcnt(1)
    v_mfma_f32_16x16x32_bf16 v[48:51], v[40:43], v[10:13], v[48:51]
    v_bitop3_b32 v52, v41, s62, v52 bitop3:0xbe
    v_bitop3_b32 v52, v43, s62, v52 bitop3:0xbe
    s_waitcnt vmcnt(0)
    v_mfma_f32_16x16x32_bf16 v[48:51], v[44:47], v[10:13], v[48:51]
    v_bitop3_b32 v52, v45, s62, v52 bitop3:0xbe
    v_bitop3_b32 v52, v47, s62, v52 bitop3:0xbe
    v_and_b32 v52, 1, v52
    v_cmp_ne_u32 vcc, 0, v52
    s_cmp_gt_u32 s12, 100000
    s_cbranch_scc1 L_ch_pollB_out
    s_cbranch_vccnz L_ch_pollB
L_ch_pollB_out:
    s_nop 0
    v_cvt_pk_bf16_f32 v15, v50, v51
    v_cvt_pk_bf16_f32 v14, v48, v49
    s_add_u32 s77, s69, s8
    v_bfi_b32 v15, 1, s62, v15
    s_mov_b64 exec, s[82:83]
    buffer_store_dwordx2 v[14:15], v1, s[44:47], s77 offen
    s_mov_b64 exec, -1
L_ch_hopA:
    s_mul_i32 s77, s3, 4096
    s_add_u32 s77, s77, s69
    s_sub_u32 s77, s77, 131072
    s_add_u32 s78, s77, 4096
    s_mov_b32 s12, 0
    s_sleep 5
    buffer_load_dwordx4 v[16:19], v3, s[44:47], s77 offen offset:0 sc1
    buffer_load_dwordx4 v[20:23], v3, s[44:47], s77 offen offset:1024 sc1
    buffer_load_dwordx4 v[24:27], v3, s[44:47], s77 offen offset:2048 sc1
    buffer_load_dwordx4 v[28:31], v3, s[44:47], s77 offen offset:3072 sc1
    buffer_load_dwordx4 v[32:35], v3, s[44:47], s78 offen offset:0 sc1
    s_add_u32 s12, s12, 1
    s_add_u32 s79, s72, 0
    buffer_load_dwordx4 v[48:51], v2, s[44:47], s79 offen
    buffer_load_dwordx4 v[52:55], v2, s[44:47], s79 offen offset:1024
    s_add_u32 s79, s72, 2048
    buffer_load_dwordx4 v[56:59], v2, s[44:47], s79 offen
    buffer_load_dwordx4 v[60:63], v2, s[44:47], s79 offen offset:1024
    s_add_u32 s79, s72, 4096
    buffer_load_dwordx4 v[8:11], v2, s[44:47], s79 offen
    buffer_load_dwordx4 v[12:15], v2, s[44:47], s79 offen offset:1024
    s_waitcnt vmcnt(10)
    v_bitop3_b32 v36, v17, s62, 0 bitop3:0xbe
    v_bitop3_b32 v36, v19, s62, v36 bitop3:0xbe
    s_waitcnt vmcnt(9)
    v_bitop3_b32 v36, v21, s62, v36 bitop3:0xbe
    v_bitop3_b32 v36, v23, s62, v36 bitop3:0xbe
    s_waitcnt vmcnt(8)
    v_bitop3_b32 v36, v25, s62, v36 bitop3:0xbe
    v_bitop3_b32 v36, v27, s62, v36 bitop3:0xbe
    s_waitcnt vmcnt(7)
    v_bitop3_b32 v36, v29, s62, v36 bitop3:0xbe
    v_bitop3_b32 v36, v31, s62, v36 bitop3:0xbe
    s_waitcnt vmcnt(6)
    v_bitop3_b32 v36, v33, s62, v36 bitop3:0xbe
    v_bitop3_b32 v36, v35, s62, v36 bitop3:0xbe
    v_and_b32 v36, 1, v36
    v_cmp_ne_u32 vcc, 0, v36
    s_cmp_eq_u32 s59, -1
    s_cbranch_scc1 L_ch_pollA_out
    s_cbranch_vccz L_ch_pollA_out
L_ch_pollA:
    buffer_load_dwordx4 v[16:19], v3, s[44:47], s77 offen offset:0 sc1
    buffer_load_dwordx4 v[20:23], v3, s[44:47], s77 offen offset:1024 sc1
    buffer_load_dwordx4 v[24:27], v3, s[44:47], s77 offen offset:2048 sc1
    buffer_load_dwordx4 v[28:31], v3, s[44:47], s77 offen offset:3072 sc1
    buffer_load_dwordx4 v[32:35], v3, s[44:47], s78 offen offset:0 sc1
    s_add_u32 s12, s12, 1
    s_waitcnt vmcnt(4)
    v_bitop3_b32 v36, v17, s62, 0 bitop3:0xbe
    v_bitop3_b32 v36, v19, s62, v36 bitop3:0xbe
    s_waitcnt vmcnt(3)
    v_bitop3_b32 v36, v21, s62, v36 bitop3:0xbe
    v_bitop3_b32 v36, v23, s62, v36 bitop3:0xbe
    s_waitcnt vmcnt(2)
    v_bitop3_b32 v36, v25, s62, v36 bitop3:0xbe
    v_bitop3_b32 v36, v27, s62, v36 bitop3:0xbe
    s_waitcnt vmcnt(1)
    v_bitop3_b32 v36, v29, s62, v36 bitop3:0xbe
    v_bitop3_b32 v36, v31, s62, v36 bitop3:0xbe
    s_waitcnt vmcnt(0)
    v_bitop3_b32 v36, v33, s62, v36 bitop3:0xbe
    v_bitop3_b32 v36, v35, s62, v36 bitop3:0xbe
    v_and_b32 v36, 1, v36
    v_cmp_ne_u32 vcc, 0, v36
    s_cmp_eq_u32 s59, -1
    s_cbranch_scc1 L_ch_pollA_out
    s_cmp_gt_u32 s12, 100000
    s_cbranch_scc1 L_ch_pollA_out
    s_cbranch_vccnz L_ch_pollA
L_ch_pollA_out:
    s_lshl_b32 s77, s3, 12
    v_add_u32 v37, s77, v3
    ds_write_b128 v37, v[16:19] offset:6144
    ds_write_b128 v37, v[20:23] offset:7168
    ds_write_b128 v37, v[24:27] offset:8192
    ds_write_b128 v37, v[28:31] offset:9216
    ds_write_b128 v37, v[32:35] offset:10240
L_ch_join:
    ds_read_b128 v[40:43], v4 offset:0
    ds_read_b128 v[44:47], v4 offset:1024
    v_mov_b64 v[28:29], 0
    v_mov_b64 v[30:31], 0
    v_mov_b64 v[32:33], 0
    v_mov_b64 v[34:35], 0
    v_mov_b64 v[36:37], 0
    v_mov_b64 v[38:39], 0
    s_waitcnt vmcnt(0) lgkmcnt(2)
    s_barrier
    ds_read_b128 v[16:19], v1 offset:6144
    ds_read_b128 v[20:23], v1 offset:6656
    ds_read_b128 v[24:27], v1 offset:7168
    s_waitcnt lgkmcnt(2)
    v_smfmac_f32_16x16x64_bf16 v[28:31], v[16:19], v[48:55], v0
    s_add_u32 s79, s72, 6144
    buffer_load_dwordx4 v[48:51], v2, s[44:47], s79 offen
    v_smfmac_f32_16x16x64_bf16 v[32:35], v[16:19], v[160:167], v0
    s_add_u32 s79, s72, 7168
    buffer_load_dwordx4 v[52:55], v2, s[44:47], s79 offen
    v_smfmac_f32_16x16x64_bf16 v[36:39], v[16:19], a[64:71], v0
    ds_read_b128 v[16:19], v1 offset:7680
    s_waitcnt lgkmcnt(2)
    v_smfmac_f32_16x16x64_bf16 v[28:31], v[20:23], v[56:63], v0
    s_add_u32 s79, s72, 8192
    buffer_load_dwordx4 v[56:59], v2, s[44:47], s79 offen
    v_smfmac_f32_16x16x64_bf16 v[32:35], v[20:23], v[168:175], v0
    s_add_u32 s79, s72, 9216
    buffer_load_dwordx4 v[60:63], v2, s[44:47], s79 offen
    v_smfmac_f32_16x16x64_bf16 v[36:39], v[20:23], v[40:47], v0
    ds_read_b128 v[40:43], v4 offset:2048
    s_waitcnt lgkmcnt(2)
    v_smfmac_f32_16x16x64_bf16 v[28:31], v[24:27], v[64:71], v0
    ds_read_b128 v[44:47], v4 offset:3072
    v_smfmac_f32_16x16x64_bf16 v[32:35], v[24:27], v[176:183], v0
    ds_read_b128 v[20:23], v1 offset:8192
    v_smfmac_f32_16x16x64_bf16 v[36:39], v[24:27], a[72:79], v0
    ds_read_b128 v[24:27], v1 offset:8704
    s_waitcnt lgkmcnt(4)
    v_smfmac_f32_16x16x64_bf16 v[28:31], v[16:19], v[72:79], v0
    v_smfmac_f32_16x16x64_bf16 v[32:35], v[16:19], v[184:191], v0
    s_waitcnt lgkmcnt(2)
    v_smfmac_f32_16x16x64_bf16 v[36:39], v[16:19], v[40:47], v0
    ds_read_b128 v[40:43], v4 offset:4096
    s_waitcnt lgkmcnt(2)
    v_smfmac_f32_16x16x64_bf16 v[28:31], v[20:23], v[8:15], v0
    ds_read_b128 v[44:47], v4 offset:5120
    v_smfmac_f32_16x16x64_bf16 v[32:35], v[20:23], v[192:199], v0
    ds_read_b128 v[16:19], v1 offset:9216
    v_smfmac_f32_16x16x64_bf16 v[36:39], v[20:23], a[80:87], v0
    s_add_u32 s79, s72, 10240
    buffer_load_dwordx4 v[8:11], v2, s[44:47], s79 offen
    s_waitcnt lgkmcnt(3)
    v_smfmac_f32_16x16x64_bf16 v[28:31], v[24:27], v[80:87], v0
    s_add_u32 s79, s72, 11264
    buffer_load_dwordx4 v[12:15], v2, s[44:47], s79 offen
    v_smfmac_f32_16x16x64_bf16 v[32:35], v[24:27], v[200:207], v0
    ds_read_b128 v[20:23], v1 offset:9728
    s_waitcnt lgkmcnt(2)
    v_smfmac_f32_16x16x64_bf16 v[36:39], v[24:27], v[40:47], v0
    ds_read_b128 v[40:43], v4 offset:6144
    s_waitcnt lgkmcnt(2)
    v_smfmac_f32_16x16x64_bf16 v[28:31], v[16:19], v[88:95], v0
    ds_read_b128 v[44:47], v4 offset:7168
    v_smfmac_f32_16x16x64_bf16 v[32:35], v[16:19], v[208:215], v0
    ds_read_b128 v[24:27], v1 offset:10240
    v_smfmac_f32_16x16x64_bf16 v[36:39], v[16:19], a[88:95], v0
    ds_read_b128 v[16:19], v1 offset:10752
    s_waitcnt lgkmcnt(4)
    v_smfmac_f32_16x16x64_bf16 v[28:31], v[20:23], v[96:103], v0
    v_smfmac_f32_16x16x64_bf16 v[32:35], v[20:23], v[216:223], v0
    s_waitcnt lgkmcnt(2)
    v_smfmac_f32_16x16x64_bf16 v[36:39], v[20:23], v[40:47], v0
    ds_read_b128 v[40:43], v4 offset:8192
    s_waitcnt lgkmcnt(2)
    v_smfmac_f32_16x16x64_bf16 v[28:31], v[24:27], v[104:111], v0
    ds_read_b128 v[44:47], v4 offset:9216
    v_smfmac_f32_16x16x64_bf16 v[32:35], v[24:27], v[224:231], v0
    ds_read_b128 v[20:23], v1 offset:11264
    v_smfmac_f32_16x16x64_bf16 v[36:39], v[24:27], a[96:103], v0
    ds_read_b128 v[24:27], v1 offset:11776
    s_waitcnt lgkmcnt(4)
    s_waitcnt vmcnt(4)
    v_smfmac_f32_16x16x64_bf16 v[28:31], v[16:19], v[48:55], v0
    s_add_u32 s79, s72, 12288
    buffer_load_dwordx4 v[48:51], v2, s[44:47], s79 offen
    v_smfmac_f32_16x16x64_bf16 v[32:35], v[16:19], v[232:239], v0
    s_add_u32 s79, s72, 13312
    buffer_load_dwordx4 v[52:55], v2, s[44:47], s79 offen
    s_waitcnt lgkmcnt(2)
    v_smfmac_f32_16x16x64_bf16 v[36:39], v[16:19], v[40:47], v0
    ds_read_b128 v[40:43], v4 offset:10240
    s_waitcnt lgkmcnt(2)
    s_waitcnt vmcnt(4)
    v_smfmac_f32_16x16x64_bf16 v[28:31], v[20:23], v[56:63], v0
    ds_read_b128 v[44:47], v4 offset:11264
    v_smfmac_f32_16x16x64_bf16 v[32:35], v[20:23], v[240:247], v0
    ds_read_b128 v[16:19], v1 offset:12288
    v_smfmac_f32_16x16x64_bf16 v[36:39], v[20:23], a[104:111], v0
    s_add_u32 s79, s72, 14336
    buffer_load_dwordx4 v[56:59], v2, s[44:47], s79 offen
    s_waitcnt lgkmcnt(3)
    v_smfmac_f32_16x16x64_bf16 v[28:31], v[24:27], v[112:119], v0
    s_add_u32 s79, s72, 15360
    buffer_load_dwordx4 v[60:63], v2, s[44:47], s79 offen
    v_smfmac_f32_16x16x64_bf16 v[32:35], v[24:27], v[248:255], v0
    ds_read_b128 v[20:23], v1 offset:12800
    s_waitcnt lgkmcnt(2)
    v_smfmac_f32_16x16x64_bf16 v[36:39], v[24:27], v[40:47], v0
    ds_read_b128 v[40:43], v4 offset:12288
    s_waitcnt lgkmcnt(2)
    v_smfmac_f32_16x16x64_bf16 v[28:31], v[16:19], v[120:127], v0
    ds_read_b128 v[44:47], v4 offset:13312
    v_smfmac_f32_16x16x64_bf16 v[32:35], v[16:19], a[0:7], v0
    ds_read_b128 v[24:27], v1 offset:13312
    v_smfmac_f32_16x16x64_bf16 v[36:39], v[16:19], a[112:119], v0
    ds_read_b128 v[16:19], v1 offset:13824
    s_waitcnt lgkmcnt(4)
    s_waitcnt vmcnt(4)
    v_smfmac_f32_16x16x64_bf16 v[28:31], v[20:23], v[8:15], v0
    v_smfmac_f32_16x16x64_bf16 v[32:35], v[20:23], a[8:15], v0
    s_waitcnt lgkmcnt(2)
    v_smfmac_f32_16x16x64_bf16 v[36:39], v[20:23], v[40:47], v0
    ds_read_b128 v[40:43], v4 offset:14336
    s_waitcnt lgkmcnt(2)
    v_smfmac_f32_16x16x64_bf16 v[28:31], v[24:27], v[128:135], v0
    ds_read_b128 v[44:47], v4 offset:15360
    v_smfmac_f32_16x16x64_bf16 v[32:35], v[24:27], a[16:23], v0
    ds_read_b128 v[20:23], v1 offset:14336
    v_smfmac_f32_16x16x64_bf16 v[36:39], v[24:27], a[120:127], v0
    ds_read_b64 v[10:11], v5 offset:2048
    s_waitcnt lgkmcnt(4)
    v_smfmac_f32_16x16x64_bf16 v[28:31], v[16:19], v[136:143], v0
    ds_read_b128 v[24:27], v1 offset:14848
    v_smfmac_f32_16x16x64_bf16 v[32:35], v[16:19], a[24:31], v0
    ds_read_b64 v[12:13], v5 offset:0
    s_waitcnt lgkmcnt(4)
    v_smfmac_f32_16x16x64_bf16 v[36:39], v[16:19], v[40:47], v0
    ds_read_b128 v[40:43], v4 offset:16384
    s_waitcnt lgkmcnt(4)
    v_smfmac_f32_16x16x64_bf16 v[28:31], v[20:23], v[144:151], v0
    ds_read_b128 v[44:47], v4 offset:17408
    v_smfmac_f32_16x16x64_bf16 v[32:35], v[20:23], a[32:39], v0
    ds_read_b128 v[16:19], v1 offset:15360
    v_smfmac_f32_16x16x64_bf16 v[36:39], v[20:23], a[128:135], v0
    ds_read_b128 v[20:23], v1 offset:15872
    s_waitcnt lgkmcnt(5)
    v_smfmac_f32_16x16x64_bf16 v[28:31], v[24:27], v[152:159], v0
    s_waitcnt lgkmcnt(4)
    buffer_store_dwordx2 v[10:11], v5, s[44:47], s60 offen offset:2048 sc1
    v_smfmac_f32_16x16x64_bf16 v[32:35], v[24:27], a[40:47], v0
    buffer_store_dwordx2 v[12:13], v5, s[44:47], s60 offen offset:0 sc1
    s_waitcnt lgkmcnt(2)
    v_smfmac_f32_16x16x64_bf16 v[36:39], v[24:27], v[40:47], v0
    ds_read_b128 v[40:43], v4 offset:18432
    s_waitcnt lgkmcnt(2)
    s_waitcnt vmcnt(4)
    v_smfmac_f32_16x16x64_bf16 v[28:31], v[16:19], v[48:55], v0
    ds_read_b128 v[44:47], v4 offset:19456
    v_smfmac_f32_16x16x64_bf16 v[32:35], v[16:19], a[48:55], v0
    v_smfmac_f32_16x16x64_bf16 v[36:39], v[16:19], a[136:143], v0
    s_waitcnt lgkmcnt(2)
    s_waitcnt vmcnt(2)
    v_smfmac_f32_16x16x64_bf16 v[28:31], v[20:23], v[56:63], v0
    v_smfmac_f32_16x16x64_bf16 v[32:35], v[20:23], a[56:63], v0
    s_waitcnt lgkmcnt(0)
    v_smfmac_f32_16x16x64_bf16 v[36:39], v[20:23], v[40:47], v0
    ds_read_b128 v[24:27], v2 offset:16384
    s_nop 5
    v_cvt_pk_bf16_f32 v14, v28, v29
    v_cvt_pk_bf16_f32 v15, v30, v31
    v_cvt_pk_bf16_f32 v16, v32, v33
    v_cvt_pk_bf16_f32 v17, v34, v35
    ds_write_b64 v5, v[14:15]
    ds_write_b64 v5, v[16:17] offset:2048
    v_cvt_pk_bf16_f32 v12, v36, v37
    v_cvt_pk_bf16_f32 v13, v38, v39
    ds_read_b128 v[28:31], v2 offset:17408
    ds_read_b128 v[44:47], v2 offset:18432
    ds_read_b128 v[48:51], v2 offset:19456
    s_cmp_eq_u32 s65, 63
    s_cbranch_scc1 L_ch_last
    s_cmp_eq_u32 s65, 59
    s_cbranch_scc1 L_ch_kmx
L_ch_kmx_ret:
    s_waitcnt lgkmcnt(3)
    s_barrier
    ds_read_b64_tr_b16 v[16:17], v6 offset:0
    ds_read_b64_tr_b16 v[18:19], v6 offset:128
    ds_read_b64_tr_b16 v[32:33], v6 offset:512
    ds_read_b64_tr_b16 v[34:35], v6 offset:640
    ds_read_b64_tr_b16 v[20:21], v6 offset:2048
    ds_read_b64_tr_b16 v[22:23], v6 offset:2176
    ds_read_b64_tr_b16 v[36:37], v6 offset:2560
    ds_read_b64_tr_b16 v[38:39], v6 offset:2688
    v_lshlrev_b32 v14, 2, v2
    v_and_b32 v14, 0xfff, v14
    buffer_load_dword v8, v14, s[44:47], s58 offen
    s_waitcnt lgkmcnt(6)
    v_mfma_f32_16x16x32_bf16 v[52:55], v[24:27], v[16:19], 0
    ds_read_b128 v[24:27], v2 offset:20480
    v_mfma_f32_16x16x32_bf16 v[56:59], v[28:31], v[16:19], 0
    ds_read_b128 v[28:31], v2 offset:21504
    s_waitcnt lgkmcnt(4)
    v_mfma_f32_16x16x32_bf16 v[60:63], v[20:23], v[16:19], 0
    ds_read_b64_tr_b16 v[16:17], v6 offset:1024
    ds_read_b64_tr_b16 v[18:19], v6 offset:1152
    ds_read_b64_tr_b16 v[20:21], v6 offset:3072
    ds_read_b64_tr_b16 v[22:23], v6 offset:3200
    v_mfma_f32_16x16x32_bf16 v[52:55], v[44:47], v[32:35], v[52:55]
    ds_read_b128 v[44:47], v2 offset:22528
    v_mfma_f32_16x16x32_bf16 v[56:59], v[48:51], v[32:35], v[56:59]
    ds_read_b128 v[48:51], v2 offset:23552
    s_waitcnt lgkmcnt(8)
    v_mfma_f32_16x16x32_bf16 v[60:63], v[36:39], v[32:35], v[60:63]
    ds_read_b64_tr_b16 v[32:33], v6 offset:1536
    ds_read_b64_tr_b16 v[34:35], v6 offset:1664
    ds_read_b64_tr_b16 v[36:37], v6 offset:3584
    ds_read_b64_tr_b16 v[38:39], v6 offset:3712
    s_waitcnt lgkmcnt(8)
    v_mfma_f32_16x16x32_bf16 v[52:55], v[24:27], v[16:19], v[52:55]
    v_mfma_f32_16x16x32_bf16 v[56:59], v[28:31], v[16:19], v[56:59]
    s_waitcnt lgkmcnt(6)
    v_mfma_f32_16x16x32_bf16 v[60:63], v[20:23], v[16:19], v[60:63]
    s_waitcnt lgkmcnt(2)
    v_mfma_f32_16x16x32_bf16 v[52:55], v[44:47], v[32:35], v[52:55]
    v_mfma_f32_16x16x32_bf16 v[56:59], v[48:51], v[32:35], v[56:59]
    s_waitcnt lgkmcnt(0)
    v_mfma_f32_16x16x32_bf16 v[60:63], v[36:39], v[32:35], v[60:63]
    ds_read_b128 v[24:27], v3 offset:24576
    ds_read_b128 v[28:31], v3 offset:28672
    v_mov_b32 v42, 0x3f803f80
    v_mov_b32 v43, 0x3f803f80
    s_nop 2
    v_max3_f32 v32, v52, v53, v54
    v_max3_f32 v33, v55, v56, v57
    v_max3_f32 v32, v32, v58, v59
    v_max3_f32 v33, v33, v60, v61
    v_max3_f32 v33, v33, v62, v63
    v_max_f32 v32, v32, v33
    v_max_f32 v33, v32, v33
    v_mov_b32 v44, 0x3f803f80
    v_mov_b32 v45, 0x3f803f80
    v_permlane16_swap_b32 v32, v33
    v_max_f32 v32, v32, v33
    v_mov_b32 v33, v32
    s_nop 1
    v_permlane32_swap_b32 v32, v33
    v_max_f32 v32, v32, v33
    v_mul_f32 v33, s14, v32
    v_pk_fma_f32 v[52:53], v[52:53], s[14:15], v[32:33] op_sel:[0,0,1] op_sel_hi:[1,1,1] neg_lo:[0,0,1] neg_hi:[0,0,1]
    v_pk_fma_f32 v[54:55], v[54:55], s[14:15], v[32:33] op_sel:[0,0,1] op_sel_hi:[1,1,1] neg_lo:[0,0,1] neg_hi:[0,0,1]
    v_pk_fma_f32 v[56:57], v[56:57], s[14:15], v[32:33] op_sel:[0,0,1] op_sel_hi:[1,1,1] neg_lo:[0,0,1] neg_hi:[0,0,1]
    v_pk_fma_f32 v[58:59], v[58:59], s[14:15], v[32:33] op_sel:[0,0,1] op_sel_hi:[1,1,1] neg_lo:[0,0,1] neg_hi:[0,0,1]
    v_pk_fma_f32 v[60:61], v[60:61], s[14:15], v[32:33] op_sel:[0,0,1] op_sel_hi:[1,1,1] neg_lo:[0,0,1] neg_hi:[0,0,1]
    v_pk_fma_f32 v[62:63], v[62:63], s[14:15], v[32:33] op_sel:[0,0,1] op_sel_hi:[1,1,1] neg_lo:[0,0,1] neg_hi:[0,0,1]
    v_exp_f32 v52, v52
    v_exp_f32 v53, v53
    v_exp_f32 v54, v54
    v_exp_f32 v55, v55
    v_exp_f32 v56, v56
    v_exp_f32 v57, v57
    v_exp_f32 v58, v58
    v_exp_f32 v59, v59
    v_exp_f32 v60, v60
    v_cvt_pk_bf16_f32 v16, v52, v53
    v_cvt_pk_bf16_f32 v17, v54, v55
    v_cvt_pk_bf16_f32 v18, v56, v57
    v_cvt_pk_bf16_f32 v19, v58, v59
    v_exp_f32 v61, v61
    s_waitcnt lgkmcnt(0)
    v_mfma_f32_16x16x32_bf16 v[32:35], v[24:27], v[16:19], 0
    v_exp_f32 v62, v62
    v_mfma_f32_16x16x32_bf16 v[36:39], v[28:31], v[16:19], 0
    v_exp_f32 v63, v63
    v_mfma_f32_16x16x32_bf16 v[48:51], v[42:45], v[16:19], 0
    v_cvt_pk_bf16_f32 v14, v60, v61
    v_cvt_pk_bf16_f32 v15, v62, v63
    v_cndmask_b32 v20, 0, v14, s[84:85]
    v_cndmask_b32 v21, 0, v15, s[84:85]
    v_cndmask_b32 v22, v14, 0, s[84:85]
    v_cndmask_b32 v23, v15, 0, s[84:85]
    s_nop 0
    v_mfma_f32_16x16x16_bf16 v[48:51], v[42:43], v[20:21], v[48:51]
    v_mfma_f32_16x16x16_bf16 v[32:35], v[12:13], v[20:21], v[32:35]
    v_mfma_f32_16x16x16_bf16 v[36:39], v[12:13], v[22:23], v[36:39]
    ds_read_b128 v[56:59], v4 offset:20480
    ds_read_b128 v[60:63], v4 offset:21504
    s_lshl_b32 s77, s3, 9
    v_add_u32 v14, s77, v1
    s_nop 2
    v_rcp_f32 v42, v48
    ds_read_b128 v[48:51], v4 offset:22528
    ds_read_b128 v[52:55], v4 offset:23552
    v_pk_mul_f32 v[32:33], v[32:33], v[42:43] op_sel_hi:[1,0]
    v_pk_mul_f32 v[34:35], v[34:35], v[42:43] op_sel_hi:[1,0]
    v_pk_mul_f32 v[36:37], v[36:37], v[42:43] op_sel_hi:[1,0]
    v_pk_mul_f32 v[38:39], v[38:39], v[42:43] op_sel_hi:[1,0]
    v_cvt_pk_bf16_f32 v16, v32, v33
    v_cvt_pk_bf16_f32 v17, v34, v35
    v_cvt_pk_bf16_f32 v18, v36, v37
    v_cvt_pk_bf16_f32 v19, v38, v39
    s_mov_b64 exec, s[82:83]
    ds_write_b128 v14, v[16:19] offset:4096
    s_mov_b64 exec, -1
    ds_read_b128 v[40:43], v4 offset:24576
    ds_read_b128 v[44:47], v4 offset:25600
    v_mov_b64 v[32:33], 0
    v_mov_b64 v[34:35], 0
    v_mov_b64 v[36:37], 0
    v_mov_b64 v[38:39], 0
    v_mov_b64 v[10:11], 0
    s_waitcnt lgkmcnt(2)
    s_barrier
    ds_read_b128 v[16:19], v1 offset:4096
    ds_read_b128 v[20:23], v1 offset:4608
    ds_read_b128 v[24:27], v1 offset:5120
    ds_read_b128 v[28:31], v1 offset:5632
    ds_write_b64 v5, v[12:13]
    v_mov_b64 v[12:13], 0
    s_waitcnt lgkmcnt(4)
    v_smfmac_f32_16x16x64_bf16 v[32:35], v[16:19], v[56:63], v0
    ds_read_b128 v[56:59], v4 offset:26624
    s_waitcnt lgkmcnt(4)
    v_smfmac_f32_16x16x64_bf16 v[32:35], v[20:23], v[48:55], v0
    ds_read_b128 v[60:63], v4 offset:27648
    s_waitcnt lgkmcnt(4)
    v_smfmac_f32_16x16x64_bf16 v[32:35], v[24:27], v[40:47], v0
    ds_read_b128 v[48:51], v4 offset:28672
    s_waitcnt lgkmcnt(4)
    v_smfmac_f32_16x16x64_bf16 v[32:35], v[28:31], a[144:151], v0
    ds_read_b128 v[52:55], v4 offset:29696
    v_smfmac_f32_16x16x64_bf16 v[36:39], v[16:19], a[152:159], v0
    ds_read_b128 v[40:43], v4 offset:30720
    v_smfmac_f32_16x16x64_bf16 v[36:39], v[20:23], a[160:167], v0
    ds_read_b128 v[44:47], v4 offset:31744
    v_smfmac_f32_16x16x64_bf16 v[36:39], v[24:27], a[168:175], v0
    v_smfmac_f32_16x16x64_bf16 v[36:39], v[28:31], a[176:183], v0
    s_nop 0
    v_cvt_pk_bf16_f32 v14, v32, v33
    s_waitcnt lgkmcnt(4)
    v_smfmac_f32_16x16x64_bf16 v[10:13], v[16:19], v[56:63], v0
    v_cvt_pk_bf16_f32 v15, v34, v35
    s_add_u32 s77, s67, 0
    v_bfi_b32 v15, 1, s61, v15
    buffer_store_dwordx2 v[14:15], v7, s[44:47], s77 offen
    s_waitcnt lgkmcnt(2)
    v_smfmac_f32_16x16x64_bf16 v[10:13], v[20:23], v[48:55], v0
    v_mov_b64 v[32:33], 0
    s_waitcnt lgkmcnt(0)
    v_smfmac_f32_16x16x64_bf16 v[10:13], v[24:27], v[40:47], v0
    v_mov_b64 v[34:35], 0
    v_smfmac_f32_16x16x64_bf16 v[10:13], v[28:31], a[184:191], v0
    v_cvt_pk_bf16_f32 v14, v36, v37
    v_smfmac_f32_16x16x64_bf16 v[32:35], v[16:19], a[192:199], v0
    v_cvt_pk_bf16_f32 v15, v38, v39
    s_add_u32 s77, s67, 16384
    v_bfi_b32 v15, 1, s61, v15
    buffer_store_dwordx2 v[14:15], v7, s[44:47], s77 offen
    v_smfmac_f32_16x16x64_bf16 v[32:35], v[20:23], a[200:207], v0
    v_mov_b64 v[36:37], 0
    v_smfmac_f32_16x16x64_bf16 v[32:35], v[24:27], a[208:215], v0
    v_mov_b64 v[38:39], 0
    v_smfmac_f32_16x16x64_bf16 v[32:35], v[28:31], a[216:223], v0
    v_cvt_pk_bf16_f32 v14, v10, v11
    v_smfmac_f32_16x16x64_bf16 v[36:39], v[16:19], a[224:231], v0
    v_cvt_pk_bf16_f32 v15, v12, v13
    s_add_u32 s77, s67, 32768
    v_bfi_b32 v15, 1, s61, v15
    buffer_store_dwordx2 v[14:15], v7, s[44:47], s77 offen
    v_smfmac_f32_16x16x64_bf16 v[36:39], v[20:23], a[232:239], v0
    v_smfmac_f32_16x16x64_bf16 v[36:39], v[24:27], a[240:247], v0
    v_cvt_pk_bf16_f32 v14, v32, v33
    v_smfmac_f32_16x16x64_bf16 v[36:39], v[28:31], a[248:255], v0
    v_cvt_pk_bf16_f32 v15, v34, v35
    s_add_u32 s77, s67, 49152
    v_bfi_b32 v15, 1, s61, v15
    buffer_store_dwordx2 v[14:15], v7, s[44:47], s77 offen
    s_nop 3
    v_cvt_pk_bf16_f32 v14, v36, v37
    v_cvt_pk_bf16_f32 v15, v38, v39
    s_add_u32 s77, s67, 65536
    v_bfi_b32 v15, 1, s61, v15
    buffer_store_dwordx2 v[14:15], v7, s[44:47], s77 offen
    s_branch L_ch_hop
L_ch_kmx:
    buffer_store_dwordx2 v[16:17], v5, s[44:47], s73 offen offset:2048 sc1
    buffer_store_dwordx2 v[12:13], v5, s[44:47], s73 offen sc1
    s_branch L_ch_kmx_ret
L_ch_notown:
    s_cmp_lt_u32 s3, 2
    s_cbranch_scc0 L_ch_w23
    s_sleep 12
    s_branch L_ch_hopA
L_ch_w23:
    s_cmp_lt_u32 s3, 2
    s_cbranch_scc1 L_kv_27
    s_cmp_eq_u32 s3, 3
    s_cbranch_scc1 L_kv_27_v
    s_mov_b32 s77, s75
    s_mov_b32 m0, 147456
    s_nop 0
    buffer_load_dwordx4 v2, s[44:47], s77 offen nt lds
    s_add_u32 s77, s77, 1024
    s_mov_b32 m0, 148480
    s_nop 0
    buffer_load_dwordx4 v2, s[44:47], s77 offen nt lds
    s_add_u32 s77, s77, 1024
    s_mov_b32 m0, 149504
    s_nop 0
    buffer_load_dwordx4 v2, s[44:47], s77 offen nt lds
    s_add_u32 s77, s77, 1024
    s_mov_b32 m0, 150528
    s_nop 0
    buffer_load_dwordx4 v2, s[44:47], s77 offen nt lds
    s_add_u32 s77, s77, 1024
    s_mov_b32 m0, 151552
    s_nop 0
    buffer_load_dwordx4 v2, s[44:47], s77 offen nt lds
    s_add_u32 s77, s77, 1024
    s_mov_b32 m0, 152576
    s_nop 0
    buffer_load_dwordx4 v2, s[44:47], s77 offen nt lds
    s_add_u32 s77, s77, 1024
    s_mov_b32 m0, 153600
    s_nop 0
    buffer_load_dwordx4 v2, s[44:47], s77 offen nt lds
    s_add_u32 s77, s77, 1024
    s_mov_b32 m0, 154624
    s_nop 0
    buffer_load_dwordx4 v2, s[44:47], s77 offen nt lds
    s_branch L_kv_27
L_kv_27_v:
    s_mov_b32 s77, s76
    s_mov_b32 m0, 155648
    s_nop 0
    buffer_load_dwordx4 v2, s[44:47], s77 offen nt lds
    s_add_u32 s77, s77, 1024
    s_mov_b32 m0, 159744
    s_nop 0
    buffer_load_dwordx4 v2, s[44:47], s77 offen nt lds
    s_add_u32 s77, s77, 1024
    s_mov_b32 m0, 156672
    s_nop 0
    buffer_load_dwordx4 v2, s[44:47], s77 offen nt lds
    s_add_u32 s77, s77, 1024
    s_mov_b32 m0, 160768
    s_nop 0
    buffer_load_dwordx4 v2, s[44:47], s77 offen nt lds
    s_add_u32 s77, s77, 1024
    s_mov_b32 m0, 157696
    s_nop 0
    buffer_load_dwordx4 v2, s[44:47], s77 offen nt lds
    s_add_u32 s77, s77, 1024
    s_mov_b32 m0, 161792
    s_nop 0
    buffer_load_dwordx4 v2, s[44:47], s77 offen nt lds
    s_add_u32 s77, s77, 1024
    s_mov_b32 m0, 158720
    s_nop 0
    buffer_load_dwordx4 v2, s[44:47], s77 offen nt lds
    s_add_u32 s77, s77, 1024
    s_mov_b32 m0, 162816
    s_nop 0
    buffer_load_dwordx4 v2, s[44:47], s77 offen nt lds
L_kv_27:
    s_sleep 5
    s_add_u32 s79, s72, 0
    buffer_load_dwordx4 v[48:51], v2, s[44:47], s79 offen
    buffer_load_dwordx4 v[52:55], v2, s[44:47], s79 offen offset:1024
    s_add_u32 s79, s72, 2048
    buffer_load_dwordx4 v[56:59], v2, s[44:47], s79 offen
    buffer_load_dwordx4 v[60:63], v2, s[44:47], s79 offen offset:1024
    s_add_u32 s79, s72, 4096
    buffer_load_dwordx4 v[8:11], v2, s[44:47], s79 offen
    buffer_load_dwordx4 v[12:15], v2, s[44:47], s79 offen offset:1024
    s_branch L_ch_join
L_ch_last:
    buffer_store_dwordx2 v[16:17], v5, s[44:47], s73 offen offset:2048 sc1
    buffer_store_dwordx2 v[12:13], v5, s[44:47], s73 offen sc1
L_ch_done:
    s_waitcnt vmcnt(0) lgkmcnt(0)
    s_branch L_ch_fin
L_mode1_28:
    s_mov_b32 s68, s67
    s_mov_b32 s62, s61
    s_mov_b32 s69, s70
    s_mov_b32 s59, s65
    s_add_u32 s65, s65, 1
    s_add_u32 s73, s73, 131072
    s_add_u32 s75, s75, 262144
    s_add_u32 s76, s76, 262144
    s_lshl_b32 s77, s3, 11
    s_add_u32 s13, s75, s77
    s_add_u32 s71, s76, s77
    s_mov_b32 s67, 0x20000
    s_mov_b32 s70, 0xc0000
    s_and_b32 s61, s65, 1
    s_xor_b32 s61, s61, 1
    s_add_u32 s81, s65, 1
    s_min_u32 s81, s81, 63
    s_cmp_ge_u32 s3, 2
    s_cselect_b32 s58, s76, s75
    s_and_b32 s78, s3, 1
    s_lshl_b32 s78, s78, 12
    s_add_u32 s58, s58, s78
    s_cmp_eq_u32 s65, 63
    s_cselect_b32 s78, 0, 262144
    s_add_u32 s58, s58, s78
    s_add_u32 s58, s58, 131072
    s_sub_u32 s60, s73, 131072
    s_cmp_eq_u32 s65, 0
    s_cselect_b32 s60, 0x7f000000, s60
    s_cmp_lt_u32 s81, s74
    s_cbranch_scc1 L_kvr_24_out_f
    s_mov_b32 s12, 0
L_kvr_24_f:
    v_mov_b32 v38, 0
    buffer_load_dwordx2 v[38:39], v38, s[44:47], s86 offen sc1
    s_waitcnt vmcnt(0)
    v_min_u32 v38, v38, v39
    s_nop 0
    v_readfirstlane_b32 s74, v38
    s_add_u32 s12, s12, 1
    s_cmp_lt_u32 s81, s74
    s_cbranch_scc1 L_kvr_24_out_f
    s_sleep 2
    s_cmp_lt_u32 s12, 100000
    s_cbranch_scc1 L_kvr_24_f
L_kvr_24_out_f:
    s_cmp_lt_u32 s3, 2
    s_cbranch_scc1 L_kv_25_f
    s_cmp_eq_u32 s3, 3
    s_cbranch_scc1 L_kv_25_v_f
    s_mov_b32 s77, s75
    s_mov_b32 m0, 147456
    s_nop 0
    buffer_load_dwordx4 v2, s[44:47], s77 offen nt lds
    s_add_u32 s77, s77, 1024
    s_mov_b32 m0, 148480
    s_nop 0
    buffer_load_dwordx4 v2, s[44:47], s77 offen nt lds
    s_add_u32 s77, s77, 1024
    s_mov_b32 m0, 149504
    s_nop 0
    buffer_load_dwordx4 v2, s[44:47], s77 offen nt lds
    s_add_u32 s77, s77, 1024
    s_mov_b32 m0, 150528
    s_nop 0
    buffer_load_dwordx4 v2, s[44:47], s77 offen nt lds
    s_add_u32 s77, s77, 1024
    s_mov_b32 m0, 151552
    s_nop 0
    buffer_load_dwordx4 v2, s[44:47], s77 offen nt lds
    s_add_u32 s77, s77, 1024
    s_mov_b32 m0, 152576
    s_nop 0
    buffer_load_dwordx4 v2, s[44:47], s77 offen nt lds
    s_add_u32 s77, s77, 1024
    s_mov_b32 m0, 153600
    s_nop 0
    buffer_load_dwordx4 v2, s[44:47], s77 offen nt lds
    s_add_u32 s77, s77, 1024
    s_mov_b32 m0, 154624
    s_nop 0
    buffer_load_dwordx4 v2, s[44:47], s77 offen nt lds
    s_branch L_kv_25_f
L_kv_25_v_f:
    s_mov_b32 s77, s76
    s_mov_b32 m0, 155648
    s_nop 0
    buffer_load_dwordx4 v2, s[44:47], s77 offen nt lds
    s_add_u32 s77, s77, 1024
    s_mov_b32 m0, 159744
    s_nop 0
    buffer_load_dwordx4 v2, s[44:47], s77 offen nt lds
    s_add_u32 s77, s77, 1024
    s_mov_b32 m0, 156672
    s_nop 0
    buffer_load_dwordx4 v2, s[44:47], s77 offen nt lds
    s_add_u32 s77, s77, 1024
    s_mov_b32 m0, 160768
    s_nop 0
    buffer_load_dwordx4 v2, s[44:47], s77 offen nt lds
    s_add_u32 s77, s77, 1024
    s_mov_b32 m0, 157696
    s_nop 0
    buffer_load_dwordx4 v2, s[44:47], s77 offen nt lds
    s_add_u32 s77, s77, 1024
    s_mov_b32 m0, 161792
    s_nop 0
    buffer_load_dwordx4 v2, s[44:47], s77 offen nt lds
    s_add_u32 s77, s77, 1024
    s_mov_b32 m0, 158720
    s_nop 0
    buffer_load_dwordx4 v2, s[44:47], s77 offen nt lds
    s_add_u32 s77, s77, 1024
    s_mov_b32 m0, 162816
    s_nop 0
    buffer_load_dwordx4 v2, s[44:47], s77 offen nt lds
L_kv_25_f:
    s_cmp_ge_u32 s3, 2
    s_cbranch_scc1 L_ch_join_f
    s_branch L_ch_hopA_f
L_ch_hop_f:
    s_mov_b32 s68, s67
    s_mov_b32 s62, s61
    s_mov_b32 s69, s70
    s_mov_b32 s59, s65
    s_add_u32 s65, s65, 1
    s_add_u32 s73, s73, 131072
    s_add_u32 s75, s75, 262144
    s_add_u32 s76, s76, 262144
    s_lshl_b32 s77, s3, 11
    s_add_u32 s13, s75, s77
    s_add_u32 s71, s76, s77
    s_mov_b32 s67, 0x20000
    s_mov_b32 s70, 0xc0000
    s_and_b32 s61, s65, 1
    s_xor_b32 s61, s61, 1
    s_add_u32 s81, s65, 1
    s_min_u32 s81, s81, 63
    s_cmp_ge_u32 s3, 2
    s_cselect_b32 s58, s76, s75
    s_and_b32 s78, s3, 1
    s_lshl_b32 s78, s78, 12
    s_add_u32 s58, s58, s78
    s_cmp_eq_u32 s65, 63
    s_cselect_b32 s78, 0, 262144
    s_add_u32 s58, s58, s78
    s_add_u32 s58, s58, 131072
    s_sub_u32 s60, s73, 131072
    s_cmp_eq_u32 s65, 0
    s_cselect_b32 s60, 0x7f000000, s60
    s_cmp_lt_u32 s81, s74
    s_cbranch_scc1 L_kvr_26_out_f
    s_mov_b32 s12, 0
L_kvr_26_f:
    v_mov_b32 v38, 0
    buffer_load_dwordx2 v[38:39], v38, s[44:47], s86 offen sc1
    s_waitcnt vmcnt(0)
    v_min_u32 v38, v38, v39
    s_nop 0
    v_readfirstlane_b32 s74, v38
    s_add_u32 s12, s12, 1
    s_cmp_lt_u32 s81, s74
    s_cbranch_scc1 L_kvr_26_out_f
    s_sleep 2
    s_cmp_lt_u32 s12, 100000
    s_cbranch_scc1 L_kvr_26_f
L_kvr_26_out_f:
    s_cmp_eq_u32 s66, -1
    s_cbranch_scc1 L_ch_notown_f
    s_add_u32 s78, s68, s7
    s_add_u32 s77, s78, 4096
    s_mov_b32 s12, 0
    v_mov_b32 v52, 0x3f80
    v_mov_b32 v53, 0x3f800000
    v_cndmask_b32 v52, v52, v53, s[56:57]
    v_cndmask_b32 v10, 0, v52, s[48:49]
    v_cndmask_b32 v11, 0, v52, s[50:51]
    v_cndmask_b32 v12, 0, v52, s[52:53]
    v_cndmask_b32 v13, 0, v52, s[54:55]
L_ch_pollB_f:
    buffer_load_dwordx4 v[16:19], v2, s[44:47], s78 offen offset:0 sc1
    buffer_load_dwordx4 v[20:23], v2, s[44:47], s78 offen offset:1024 sc1
    buffer_load_dwordx4 v[24:27], v2, s[44:47], s78 offen offset:2048 sc1
    buffer_load_dwordx4 v[28:31], v2, s[44:47], s78 offen offset:3072 sc1
    buffer_load_dwordx4 v[32:35], v2, s[44:47], s77 offen offset:0 sc1
    buffer_load_dwordx4 v[36:39], v2, s[44:47], s77 offen offset:1024 sc1
    buffer_load_dwordx4 v[40:43], v2, s[44:47], s77 offen offset:2048 sc1
    buffer_load_dwordx4 v[44:47], v2, s[44:47], s77 offen offset:3072 sc1
    s_add_u32 s12, s12, 1
    s_waitcnt vmcnt(7)
    v_mfma_f32_16x16x32_bf16 v[48:51], v[16:19], v[10:13], 0
    v_bitop3_b32 v52, v17, s62, 0 bitop3:0xbe
    v_bitop3_b32 v52, v19, s62, v52 bitop3:0xbe
    s_waitcnt vmcnt(6)
    v_mfma_f32_16x16x32_bf16 v[48:51], v[20:23], v[10:13], v[48:51]
    v_bitop3_b32 v52, v21, s62, v52 bitop3:0xbe
    v_bitop3_b32 v52, v23, s62, v52 bitop3:0xbe
    s_waitcnt vmcnt(5)
    v_mfma_f32_16x16x32_bf16 v[48:51], v[24:27], v[10:13], v[48:51]
    v_bitop3_b32 v52, v25, s62, v52 bitop3:0xbe
    v_bitop3_b32 v52, v27, s62, v52 bitop3:0xbe
    s_waitcnt vmcnt(4)
    v_mfma_f32_16x16x32_bf16 v[48:51], v[28:31], v[10:13], v[48:51]
    v_bitop3_b32 v52, v29, s62, v52 bitop3:0xbe
    v_bitop3_b32 v52, v31, s62, v52 bitop3:0xbe
    s_waitcnt vmcnt(3)
    v_mfma_f32_16x16x32_bf16 v[48:51], v[32:35], v[10:13], v[48:51]
    v_bitop3_b32 v52, v33, s62, v52 bitop3:0xbe
    v_bitop3_b32 v52, v35, s62, v52 bitop3:0xbe
    s_waitcnt vmcnt(2)
    v_mfma_f32_16x16x32_bf16 v[48:51], v[36:39], v[10:13], v[48:51]
    v_bitop3_b32 v52, v37, s62, v52 bitop3:0xbe
    v_bitop3_b32 v52, v39, s62, v52 bitop3:0xbe
    s_waitcnt vmcnt(1)
    v_mfma_f32_16x16x32_bf16 v[48:51], v[40:43], v[10:13], v[48:51]
    v_bitop3_b32 v52, v41, s62, v52 bitop3:0xbe
    v_bitop3_b32 v52, v43, s62, v52 bitop3:0xbe
    s_waitcnt vmcnt(0)
    v_mfma_f32_16x16x32_bf16 v[48:51], v[44:47], v[10:13], v[48:51]
    v_bitop3_b32 v52, v45, s62, v52 bitop3:0xbe
    v_bitop3_b32 v52, v47, s62, v52 bitop3:0xbe
    v_and_b32 v52, 1, v52
    v_cmp_ne_u32 vcc, 0, v52
    s_cmp_gt_u32 s12, 100000
    s_cbranch_scc1 L_ch_pollB_out_f
    s_cbranch_vccnz L_ch_pollB_f
L_ch_pollB_out_f:
    s_nop 0
    v_cvt_pk_bf16_f32 v15, v50, v51
    v_cvt_pk_bf16_f32 v14, v48, v49
    s_add_u32 s77, s69, s8
    v_bfi_b32 v15, 1, s62, v15
    s_mov_b64 exec, s[82:83]
    buffer_store_dwordx2 v[14:15], v1, s[44:47], s77 offen sc1
    s_mov_b64 exec, -1
L_ch_hopA_f:
    s_mul_i32 s77, s3, 4096
    s_add_u32 s77, s77, s69
    s_sub_u32 s77, s77, 131072
    s_add_u32 s78, s77, 4096
    s_mov_b32 s12, 0
    s_sleep 5
    buffer_load_dwordx4 v[16:19], v3, s[44:47], s77 offen offset:0 sc1
    buffer_load_dwordx4 v[20:23], v3, s[44:47], s77 offen offset:1024 sc1
    buffer_load_dwordx4 v[24:27], v3, s[44:47], s77 offen offset:2048 sc1
    buffer_load_dwordx4 v[28:31], v3, s[44:47], s77 offen offset:3072 sc1
    buffer_load_dwordx4 v[32:35], v3, s[44:47], s78 offen offset:0 sc1
    s_add_u32 s12, s12, 1
    s_add_u32 s79, s72, 0
    buffer_load_dwordx4 v[48:51], v2, s[44:47], s79 offen
    buffer_load_dwordx4 v[52:55], v2, s[44:47], s79 offen offset:1024
    s_add_u32 s79, s72, 2048
    buffer_load_dwordx4 v[56:59], v2, s[44:47], s79 offen
    buffer_load_dwordx4 v[60:63], v2, s[44:47], s79 offen offset:1024
    s_add_u32 s79, s72, 4096
    buffer_load_dwordx4 v[8:11], v2, s[44:47], s79 offen
    buffer_load_dwordx4 v[12:15], v2, s[44:47], s79 offen offset:1024
    s_waitcnt vmcnt(10)
    v_bitop3_b32 v36, v17, s62, 0 bitop3:0xbe
    v_bitop3_b32 v36, v19, s62, v36 bitop3:0xbe
    s_waitcnt vmcnt(9)
    v_bitop3_b32 v36, v21, s62, v36 bitop3:0xbe
    v_bitop3_b32 v36, v23, s62, v36 bitop3:0xbe
    s_waitcnt vmcnt(8)
    v_bitop3_b32 v36, v25, s62, v36 bitop3:0xbe
    v_bitop3_b32 v36, v27, s62, v36 bitop3:0xbe
    s_waitcnt vmcnt(7)
    v_bitop3_b32 v36, v29, s62, v36 bitop3:0xbe
    v_bitop3_b32 v36, v31, s62, v36 bitop3:0xbe
    s_waitcnt vmcnt(6)
    v_bitop3_b32 v36, v33, s62, v36 bitop3:0xbe
    v_bitop3_b32 v36, v35, s62, v36 bitop3:0xbe
    v_and_b32 v36, 1, v36
    v_cmp_ne_u32 vcc, 0, v36
    s_cmp_eq_u32 s59, -1
    s_cbranch_scc1 L_ch_pollA_out_f
    s_cbranch_vccz L_ch_pollA_out_f
L_ch_pollA_f:
    buffer_load_dwordx4 v[16:19], v3, s[44:47], s77 offen offset:0 sc1
    buffer_load_dwordx4 v[20:23], v3, s[44:47], s77 offen offset:1024 sc1
    buffer_load_dwordx4 v[24:27], v3, s[44:47], s77 offen offset:2048 sc1
    buffer_load_dwordx4 v[28:31], v3, s[44:47], s77 offen offset:3072 sc1
    buffer_load_dwordx4 v[32:35], v3, s[44:47], s78 offen offset:0 sc1
    s_add_u32 s12, s12, 1
    s_waitcnt vmcnt(4)
    v_bitop3_b32 v36, v17, s62, 0 bitop3:0xbe
    v_bitop3_b32 v36, v19, s62, v36 bitop3:0xbe
    s_waitcnt vmcnt(3)
    v_bitop3_b32 v36, v21, s62, v36 bitop3:0xbe
    v_bitop3_b32 v36, v23, s62, v36 bitop3:0xbe
    s_waitcnt vmcnt(2)
    v_bitop3_b32 v36, v25, s62, v36 bitop3:0xbe
    v_bitop3_b32 v36, v27, s62, v36 bitop3:0xbe
    s_waitcnt vmcnt(1)
    v_bitop3_b32 v36, v29, s62, v36 bitop3:0xbe
    v_bitop3_b32 v36, v31, s62, v36 bitop3:0xbe
    s_waitcnt vmcnt(0)
    v_bitop3_b32 v36, v33, s62, v36 bitop3:0xbe
    v_bitop3_b32 v36, v35, s62, v36 bitop3:0xbe
    v_and_b32 v36, 1, v36
    v_cmp_ne_u32 vcc, 0, v36
    s_cmp_eq_u32 s59, -1
    s_cbranch_scc1 L_ch_pollA_out_f
    s_cmp_gt_u32 s12, 100000
    s_cbranch_scc1 L_ch_pollA_out_f
    s_cbranch_vccnz L_ch_pollA_f
L_ch_pollA_out_f:
    s_lshl_b32 s77, s3, 12
    v_add_u32 v37, s77, v3
    ds_write_b128 v37, v[16:19] offset:6144
    ds_write_b128 v37, v[20:23] offset:7168
    ds_write_b128 v37, v[24:27] offset:8192
    ds_write_b128 v37, v[28:31] offset:9216
    ds_write_b128 v37, v[32:35] offset:10240
L_ch_join_f:
    ds_read_b128 v[40:43], v4 offset:0
    ds_read_b128 v[44:47], v4 offset:1024
    v_mov_b64 v[28:29], 0
    v_mov_b64 v[30:31], 0
    v_mov_b64 v[32:33], 0
    v_mov_b64 v[34:35], 0
    v_mov_b64 v[36:37], 0
    v_mov_b64 v[38:39], 0
    s_waitcnt vmcnt(0) lgkmcnt(2)
    s_barrier
    ds_read_b128 v[16:19], v1 offset:6144
    ds_read_b128 v[20:23], v1 offset:6656
    ds_read_b128 v[24:27], v1 offset:7168
    s_waitcnt lgkmcnt(2)
    v_smfmac_f32_16x16x64_bf16 v[28:31], v[16:19], v[48:55], v0
    s_add_u32 s79, s72, 6144
    buffer_load_dwordx4 v[48:51], v2, s[44:47], s79 offen
    v_smfmac_f32_16x16x64_bf16 v[32:35], v[16:19], v[160:167], v0
    s_add_u32 s79, s72, 7168
    buffer_load_dwordx4 v[52:55], v2, s[44:47], s79 offen
    v_smfmac_f32_16x16x64_bf16 v[36:39], v[16:19], a[64:71], v0
    ds_read_b128 v[16:19], v1 offset:7680
    s_waitcnt lgkmcnt(2)
    v_smfmac_f32_16x16x64_bf16 v[28:31], v[20:23], v[56:63], v0
    s_add_u32 s79, s72, 8192
    buffer_load_dwordx4 v[56:59], v2, s[44:47], s79 offen
    v_smfmac_f32_16x16x64_bf16 v[32:35], v[20:23], v[168:175], v0
    s_add_u32 s79, s72, 9216
    buffer_load_dwordx4 v[60:63], v2, s[44:47], s79 offen
    v_smfmac_f32_16x16x64_bf16 v[36:39], v[20:23], v[40:47], v0
    ds_read_b128 v[40:43], v4 offset:2048
    s_waitcnt lgkmcnt(2)
    v_smfmac_f32_16x16x64_bf16 v[28:31], v[24:27], v[64:71], v0
    ds_read_b128 v[44:47], v4 offset:3072
    v_smfmac_f32_16x16x64_bf16 v[32:35], v[24:27], v[176:183], v0
    ds_read_b128 v[20:23], v1 offset:8192
    v_smfmac_f32_16x16x64_bf16 v[36:39], v[24:27], a[72:79], v0
    ds_read_b128 v[24:27], v1 offset:8704
    s_waitcnt lgkmcnt(4)
    v_smfmac_f32_16x16x64_bf16 v[28:31], v[16:19], v[72:79], v0
    v_smfmac_f32_16x16x64_bf16 v[32:35], v[16:19], v[184:191], v0
    s_waitcnt lgkmcnt(2)
    v_smfmac_f32_16x16x64_bf16 v[36:39], v[16:19], v[40:47], v0
    ds_read_b128 v[40:43], v4 offset:4096
    s_waitcnt lgkmcnt(2)
    v_smfmac_f32_16x16x64_bf16 v[28:31], v[20:23], v[8:15], v0
    ds_read_b128 v[44:47], v4 offset:5120
    v_smfmac_f32_16x16x64_bf16 v[32:35], v[20:23], v[192:199], v0
    ds_read_b128 v[16:19], v1 offset:9216
    v_smfmac_f32_16x16x64_bf16 v[36:39], v[20:23], a[80:87], v0
    s_add_u32 s79, s72, 10240
    buffer_load_dwordx4 v[8:11], v2, s[44:47], s79 offen
    s_waitcnt lgkmcnt(3)
    v_smfmac_f32_16x16x64_bf16 v[28:31], v[24:27], v[80:87], v0
    s_add_u32 s79, s72, 11264
    buffer_load_dwordx4 v[12:15], v2, s[44:47], s79 offen
    v_smfmac_f32_16x16x64_bf16 v[32:35], v[24:27], v[200:207], v0
    ds_read_b128 v[20:23], v1 offset:9728
    s_waitcnt lgkmcnt(2)
    v_smfmac_f32_16x16x64_bf16 v[36:39], v[24:27], v[40:47], v0
    ds_read_b128 v[40:43], v4 offset:6144
    s_waitcnt lgkmcnt(2)
    v_smfmac_f32_16x16x64_bf16 v[28:31], v[16:19], v[88:95], v0
    ds_read_b128 v[44:47], v4 offset:7168
    v_smfmac_f32_16x16x64_bf16 v[32:35], v[16:19], v[208:215], v0
    ds_read_b128 v[24:27], v1 offset:10240
    v_smfmac_f32_16x16x64_bf16 v[36:39], v[16:19], a[88:95], v0
    ds_read_b128 v[16:19], v1 offset:10752
    s_waitcnt lgkmcnt(4)
    v_smfmac_f32_16x16x64_bf16 v[28:31], v[20:23], v[96:103], v0
    v_smfmac_f32_16x16x64_bf16 v[32:35], v[20:23], v[216:223], v0
    s_waitcnt lgkmcnt(2)
    v_smfmac_f32_16x16x64_bf16 v[36:39], v[20:23], v[40:47], v0
    ds_read_b128 v[40:43], v4 offset:8192
    s_waitcnt lgkmcnt(2)
    v_smfmac_f32_16x16x64_bf16 v[28:31], v[24:27], v[104:111], v0
    ds_read_b128 v[44:47], v4 offset:9216
    v_smfmac_f32_16x16x64_bf16 v[32:35], v[24:27], v[224:231], v0
    ds_read_b128 v[20:23], v1 offset:11264
    v_smfmac_f32_16x16x64_bf16 v[36:39], v[24:27], a[96:103], v0
    ds_read_b128 v[24:27], v1 offset:11776
    s_waitcnt lgkmcnt(4)
    s_waitcnt vmcnt(4)
    v_smfmac_f32_16x16x64_bf16 v[28:31], v[16:19], v[48:55], v0
    s_add_u32 s79, s72, 12288
    buffer_load_dwordx4 v[48:51], v2, s[44:47], s79 offen
    v_smfmac_f32_16x16x64_bf16 v[32:35], v[16:19], v[232:239], v0
    s_add_u32 s79, s72, 13312
    buffer_load_dwordx4 v[52:55], v2, s[44:47], s79 offen
    s_waitcnt lgkmcnt(2)
    v_smfmac_f32_16x16x64_bf16 v[36:39], v[16:19], v[40:47], v0
    ds_read_b128 v[40:43], v4 offset:10240
    s_waitcnt lgkmcnt(2)
    s_waitcnt vmcnt(4)
    v_smfmac_f32_16x16x64_bf16 v[28:31], v[20:23], v[56:63], v0
    ds_read_b128 v[44:47], v4 offset:11264
    v_smfmac_f32_16x16x64_bf16 v[32:35], v[20:23], v[240:247], v0
    ds_read_b128 v[16:19], v1 offset:12288
    v_smfmac_f32_16x16x64_bf16 v[36:39], v[20:23], a[104:111], v0
    s_add_u32 s79, s72, 14336
    buffer_load_dwordx4 v[56:59], v2, s[44:47], s79 offen
    s_waitcnt lgkmcnt(3)
    v_smfmac_f32_16x16x64_bf16 v[28:31], v[24:27], v[112:119], v0
    s_add_u32 s79, s72, 15360
    buffer_load_dwordx4 v[60:63], v2, s[44:47], s79 offen
    v_smfmac_f32_16x16x64_bf16 v[32:35], v[24:27], v[248:255], v0
    ds_read_b128 v[20:23], v1 offset:12800
    s_waitcnt lgkmcnt(2)
    v_smfmac_f32_16x16x64_bf16 v[36:39], v[24:27], v[40:47], v0
    ds_read_b128 v[40:43], v4 offset:12288
    s_waitcnt lgkmcnt(2)
    v_smfmac_f32_16x16x64_bf16 v[28:31], v[16:19], v[120:127], v0
    ds_read_b128 v[44:47], v4 offset:13312
    v_smfmac_f32_16x16x64_bf16 v[32:35], v[16:19], a[0:7], v0
    ds_read_b128 v[24:27], v1 offset:13312
    v_smfmac_f32_16x16x64_bf16 v[36:39], v[16:19], a[112:119], v0
    ds_read_b128 v[16:19], v1 offset:13824
    s_waitcnt lgkmcnt(4)
    s_waitcnt vmcnt(4)
    v_smfmac_f32_16x16x64_bf16 v[28:31], v[20:23], v[8:15], v0
    v_smfmac_f32_16x16x64_bf16 v[32:35], v[20:23], a[8:15], v0
    s_waitcnt lgkmcnt(2)
    v_smfmac_f32_16x16x64_bf16 v[36:39], v[20:23], v[40:47], v0
    ds_read_b128 v[40:43], v4 offset:14336
    s_waitcnt lgkmcnt(2)
    v_smfmac_f32_16x16x64_bf16 v[28:31], v[24:27], v[128:135], v0
    ds_read_b128 v[44:47], v4 offset:15360
    v_smfmac_f32_16x16x64_bf16 v[32:35], v[24:27], a[16:23], v0
    ds_read_b128 v[20:23], v1 offset:14336
    v_smfmac_f32_16x16x64_bf16 v[36:39], v[24:27], a[120:127], v0
    ds_read_b64 v[10:11], v5 offset:2048
    s_waitcnt lgkmcnt(4)
    v_smfmac_f32_16x16x64_bf16 v[28:31], v[16:19], v[136:143], v0
    ds_read_b128 v[24:27], v1 offset:14848
    v_smfmac_f32_16x16x64_bf16 v[32:35], v[16:19], a[24:31], v0
    ds_read_b64 v[12:13], v5 offset:0
    s_waitcnt lgkmcnt(4)
    v_smfmac_f32_16x16x64_bf16 v[36:39], v[16:19], v[40:47], v0
    ds_read_b128 v[40:43], v4 offset:16384
    s_waitcnt lgkmcnt(4)
    v_smfmac_f32_16x16x64_bf16 v[28:31], v[20:23], v[144:151], v0
    ds_read_b128 v[44:47], v4 offset:17408
    v_smfmac_f32_16x16x64_bf16 v[32:35], v[20:23], a[32:39], v0
    ds_read_b128 v[16:19], v1 offset:15360
    v_smfmac_f32_16x16x64_bf16 v[36:39], v[20:23], a[128:135], v0
    ds_read_b128 v[20:23], v1 offset:15872
    s_waitcnt lgkmcnt(5)
    v_smfmac_f32_16x16x64_bf16 v[28:31], v[24:27], v[152:159], v0
    s_waitcnt lgkmcnt(4)
    buffer_store_dwordx2 v[10:11], v5, s[44:47], s60 offen offset:2048 sc1
    v_smfmac_f32_16x16x64_bf16 v[32:35], v[24:27], a[40:47], v0
    buffer_store_dwordx2 v[12:13], v5, s[44:47], s60 offen offset:0 sc1
    s_waitcnt lgkmcnt(2)
    v_smfmac_f32_16x16x64_bf16 v[36:39], v[24:27], v[40:47], v0
    ds_read_b128 v[40:43], v4 offset:18432
    s_waitcnt lgkmcnt(2)
    s_waitcnt vmcnt(4)
    v_smfmac_f32_16x16x64_bf16 v[28:31], v[16:19], v[48:55], v0
    ds_read_b128 v[44:47], v4 offset:19456
    v_smfmac_f32_16x16x64_bf16 v[32:35], v[16:19], a[48:55], v0
    v_smfmac_f32_16x16x64_bf16 v[36:39], v[16:19], a[136:143], v0
    s_waitcnt lgkmcnt(2)
    s_waitcnt vmcnt(2)
    v_smfmac_f32_16x16x64_bf16 v[28:31], v[20:23], v[56:63], v0
    v_smfmac_f32_16x16x64_bf16 v[32:35], v[20:23], a[56:63], v0
    s_waitcnt lgkmcnt(0)
    v_smfmac_f32_16x16x64_bf16 v[36:39], v[20:23], v[40:47], v0
    ds_read_b128 v[24:27], v2 offset:16384
    s_nop 5
    v_cvt_pk_bf16_f32 v14, v28, v29
    v_cvt_pk_bf16_f32 v15, v30, v31
    v_cvt_pk_bf16_f32 v16, v32, v33
    v_cvt_pk_bf16_f32 v17, v34, v35
    ds_write_b64 v5, v[14:15]
    ds_write_b64 v5, v[16:17] offset:2048
    v_cvt_pk_bf16_f32 v12, v36, v37
    v_cvt_pk_bf16_f32 v13, v38, v39
    ds_read_b128 v[28:31], v2 offset:17408
    ds_read_b128 v[44:47], v2 offset:18432
    ds_read_b128 v[48:51], v2 offset:19456
    s_cmp_eq_u32 s65, 63
    s_cbranch_scc1 L_ch_last_f
    s_cmp_eq_u32 s65, 59
    s_cbranch_scc1 L_ch_kmx_f
L_ch_kmx_ret_f:
    s_waitcnt lgkmcnt(3)
    s_barrier
    ds_read_b64_tr_b16 v[16:17], v6 offset:0
    ds_read_b64_tr_b16 v[18:19], v6 offset:128
    ds_read_b64_tr_b16 v[32:33], v6 offset:512
    ds_read_b64_tr_b16 v[34:35], v6 offset:640
    ds_read_b64_tr_b16 v[20:21], v6 offset:2048
    ds_read_b64_tr_b16 v[22:23], v6 offset:2176
    ds_read_b64_tr_b16 v[36:37], v6 offset:2560
    ds_read_b64_tr_b16 v[38:39], v6 offset:2688
    v_lshlrev_b32 v14, 2, v2
    v_and_b32 v14, 0xfff, v14
    buffer_load_dword v8, v14, s[44:47], s58 offen
    s_waitcnt lgkmcnt(6)
    v_mfma_f32_16x16x32_bf16 v[52:55], v[24:27], v[16:19], 0
    ds_read_b128 v[24:27], v2 offset:20480
    v_mfma_f32_16x16x32_bf16 v[56:59], v[28:31], v[16:19], 0
    ds_read_b128 v[28:31], v2 offset:21504
    s_waitcnt lgkmcnt(4)
    v_mfma_f32_16x16x32_bf16 v[60:63], v[20:23], v[16:19], 0
    ds_read_b64_tr_b16 v[16:17], v6 offset:1024
    ds_read_b64_tr_b16 v[18:19], v6 offset:1152
    ds_read_b64_tr_b16 v[20:21], v6 offset:3072
    ds_read_b64_tr_b16 v[22:23], v6 offset:3200
    v_mfma_f32_16x16x32_bf16 v[52:55], v[44:47], v[32:35], v[52:55]
    ds_read_b128 v[44:47], v2 offset:22528
    v_mfma_f32_16x16x32_bf16 v[56:59], v[48:51], v[32:35], v[56:59]
    ds_read_b128 v[48:51], v2 offset:23552
    s_waitcnt lgkmcnt(8)
    v_mfma_f32_16x16x32_bf16 v[60:63], v[36:39], v[32:35], v[60:63]
    ds_read_b64_tr_b16 v[32:33], v6 offset:1536
    ds_read_b64_tr_b16 v[34:35], v6 offset:1664
    ds_read_b64_tr_b16 v[36:37], v6 offset:3584
    ds_read_b64_tr_b16 v[38:39], v6 offset:3712
    s_waitcnt lgkmcnt(8)
    v_mfma_f32_16x16x32_bf16 v[52:55], v[24:27], v[16:19], v[52:55]
    v_mfma_f32_16x16x32_bf16 v[56:59], v[28:31], v[16:19], v[56:59]
    s_waitcnt lgkmcnt(6)
    v_mfma_f32_16x16x32_bf16 v[60:63], v[20:23], v[16:19], v[60:63]
    s_waitcnt lgkmcnt(2)
    v_mfma_f32_16x16x32_bf16 v[52:55], v[44:47], v[32:35], v[52:55]
    v_mfma_f32_16x16x32_bf16 v[56:59], v[48:51], v[32:35], v[56:59]
    s_waitcnt lgkmcnt(0)
    v_mfma_f32_16x16x32_bf16 v[60:63], v[36:39], v[32:35], v[60:63]
    ds_read_b128 v[24:27], v3 offset:24576
    ds_read_b128 v[28:31], v3 offset:28672
    v_mov_b32 v42, 0x3f803f80
    v_mov_b32 v43, 0x3f803f80
    s_nop 2
    v_max3_f32 v32, v52, v53, v54
    v_max3_f32 v33, v55, v56, v57
    v_max3_f32 v32, v32, v58, v59
    v_max3_f32 v33, v33, v60, v61
    v_max3_f32 v33, v33, v62, v63
    v_max_f32 v32, v32, v33
    v_max_f32 v33, v32, v33
    v_mov_b32 v44, 0x3f803f80
    v_mov_b32 v45, 0x3f803f80
    v_permlane16_swap_b32 v32, v33
    v_max_f32 v32, v32, v33
    v_mov_b32 v33, v32
    s_nop 1
    v_permlane32_swap_b32 v32, v33
    v_max_f32 v32, v32, v33
    v_mul_f32 v33, s14, v32
    v_pk_fma_f32 v[52:53], v[52:53], s[14:15], v[32:33] op_sel:[0,0,1] op_sel_hi:[1,1,1] neg_lo:[0,0,1] neg_hi:[0,0,1]
    v_pk_fma_f32 v[54:55], v[54:55], s[14:15], v[32:33] op_sel:[0,0,1] op_sel_hi:[1,1,1] neg_lo:[0,0,1] neg_hi:[0,0,1]
    v_pk_fma_f32 v[56:57], v[56:57], s[14:15], v[32:33] op_sel:[0,0,1] op_sel_hi:[1,1,1] neg_lo:[0,0,1] neg_hi:[0,0,1]
    v_pk_fma_f32 v[58:59], v[58:59], s[14:15], v[32:33] op_sel:[0,0,1] op_sel_hi:[1,1,1] neg_lo:[0,0,1] neg_hi:[0,0,1]
    v_pk_fma_f32 v[60:61], v[60:61], s[14:15], v[32:33] op_sel:[0,0,1] op_sel_hi:[1,1,1] neg_lo:[0,0,1] neg_hi:[0,0,1]
    v_pk_fma_f32 v[62:63], v[62:63], s[14:15], v[32:33] op_sel:[0,0,1] op_sel_hi:[1,1,1] neg_lo:[0,0,1] neg_hi:[0,0,1]
    v_exp_f32 v52, v52
    v_exp_f32 v53, v53
    v_exp_f32 v54, v54
    v_exp_f32 v55, v55
    v_exp_f32 v56, v56
    v_exp_f32 v57, v57
    v_exp_f32 v58, v58
    v_exp_f32 v59, v59
    v_exp_f32 v60, v60
    v_cvt_pk_bf16_f32 v16, v52, v53
    v_cvt_pk_bf16_f32 v17, v54, v55
    v_cvt_pk_bf16_f32 v18, v56, v57
    v_cvt_pk_bf16_f32 v19, v58, v59
    v_exp_f32 v61, v61
    s_waitcnt lgkmcnt(0)
    v_mfma_f32_16x16x32_bf16 v[32:35], v[24:27], v[16:19], 0
    v_exp_f32 v62, v62
    v_mfma_f32_16x16x32_bf16 v[36:39], v[28:31], v[16:19], 0
    v_exp_f32 v63, v63
    v_mfma_f32_16x16x32_bf16 v[48:51], v[42:45], v[16:19], 0
    v_cvt_pk_bf16_f32 v14, v60, v61
    v_cvt_pk_bf16_f32 v15, v62, v63
    v_cndmask_b32 v20, 0, v14, s[84:85]
    v_cndmask_b32 v21, 0, v15, s[84:85]
    v_cndmask_b32 v22, v14, 0, s[84:85]
    v_cndmask_b32 v23, v15, 0, s[84:85]
    s_nop 0
    v_mfma_f32_16x16x16_bf16 v[48:51], v[42:43], v[20:21], v[48:51]
    v_mfma_f32_16x16x16_bf16 v[32:35], v[12:13], v[20:21], v[32:35]
    v_mfma_f32_16x16x16_bf16 v[36:39], v[12:13], v[22:23], v[36:39]
    ds_read_b128 v[56:59], v4 offset:20480
    ds_read_b128 v[60:63], v4 offset:21504
    s_lshl_b32 s77, s3, 9
    v_add_u32 v14, s77, v1
    s_nop 2
    v_rcp_f32 v42, v48
    ds_read_b128 v[48:51], v4 offset:22528
    ds_read_b128 v[52:55], v4 offset:23552
    v_pk_mul_f32 v[32:33], v[32:33], v[42:43] op_sel_hi:[1,0]
    v_pk_mul_f32 v[34:35], v[34:35], v[42:43] op_sel_hi:[1,0]
    v_pk_mul_f32 v[36:37], v[36:37], v[42:43] op_sel_hi:[1,0]
    v_pk_mul_f32 v[38:39], v[38:39], v[42:43] op_sel_hi:[1,0]
    v_cvt_pk_bf16_f32 v16, v32, v33
    v_cvt_pk_bf16_f32 v17, v34, v35
    v_cvt_pk_bf16_f32 v18, v36, v37
    v_cvt_pk_bf16_f32 v19, v38, v39
    s_mov_b64 exec, s[82:83]
    ds_write_b128 v14, v[16:19] offset:4096
    s_mov_b64 exec, -1
    ds_read_b128 v[40:43], v4 offset:24576
    ds_read_b128 v[44:47], v4 offset:25600
    v_mov_b64 v[32:33], 0
    v_mov_b64 v[34:35], 0
    v_mov_b64 v[36:37], 0
    v_mov_b64 v[38:39], 0
    v_mov_b64 v[10:11], 0
    s_waitcnt lgkmcnt(2)
    s_barrier
    ds_read_b128 v[16:19], v1 offset:4096
    ds_read_b128 v[20:23], v1 offset:4608
    ds_read_b128 v[24:27], v1 offset:5120
    ds_read_b128 v[28:31], v1 offset:5632
    ds_write_b64 v5, v[12:13]
    v_mov_b64 v[12:13], 0
    s_waitcnt lgkmcnt(4)
    v_smfmac_f32_16x16x64_bf16 v[32:35], v[16:19], v[56:63], v0
    ds_read_b128 v[56:59], v4 offset:26624
    s_waitcnt lgkmcnt(4)
    v_smfmac_f32_16x16x64_bf16 v[32:35], v[20:23], v[48:55], v0
    ds_read_b128 v[60:63], v4 offset:27648
    s_waitcnt lgkmcnt(4)
    v_smfmac_f32_16x16x64_bf16 v[32:35], v[24:27], v[40:47], v0
    ds_read_b128 v[48:51], v4 offset:28672
    s_waitcnt lgkmcnt(4)
    v_smfmac_f32_16x16x64_bf16 v[32:35], v[28:31], a[144:151], v0
    ds_read_b128 v[52:55], v4 offset:29696
    v_smfmac_f32_16x16x64_bf16 v[36:39], v[16:19], a[152:159], v0
    ds_read_b128 v[40:43], v4 offset:30720
    v_smfmac_f32_16x16x64_bf16 v[36:39], v[20:23], a[160:167], v0
    ds_read_b128 v[44:47], v4 offset:31744
    v_smfmac_f32_16x16x64_bf16 v[36:39], v[24:27], a[168:175], v0
    v_smfmac_f32_16x16x64_bf16 v[36:39], v[28:31], a[176:183], v0
    s_nop 0
    v_cvt_pk_bf16_f32 v14, v32, v33
    s_waitcnt lgkmcnt(4)
    v_smfmac_f32_16x16x64_bf16 v[10:13], v[16:19], v[56:63], v0
    v_cvt_pk_bf16_f32 v15, v34, v35
    s_add_u32 s77, s67, 0
    v_bfi_b32 v15, 1, s61, v15
    buffer_store_dwordx2 v[14:15], v7, s[44:47], s77 offen sc1
    s_waitcnt lgkmcnt(2)
    v_smfmac_f32_16x16x64_bf16 v[10:13], v[20:23], v[48:55], v0
    v_mov_b64 v[32:33], 0
    s_waitcnt lgkmcnt(0)
    v_smfmac_f32_16x16x64_bf16 v[10:13], v[24:27], v[40:47], v0
    v_mov_b64 v[34:35], 0
    v_smfmac_f32_16x16x64_bf16 v[10:13], v[28:31], a[184:191], v0
    v_cvt_pk_bf16_f32 v14, v36, v37
    v_smfmac_f32_16x16x64_bf16 v[32:35], v[16:19], a[192:199], v0
    v_cvt_pk_bf16_f32 v15, v38, v39
    s_add_u32 s77, s67, 16384
    v_bfi_b32 v15, 1, s61, v15
    buffer_store_dwordx2 v[14:15], v7, s[44:47], s77 offen sc1
    v_smfmac_f32_16x16x64_bf16 v[32:35], v[20:23], a[200:207], v0
    v_mov_b64 v[36:37], 0
    v_smfmac_f32_16x16x64_bf16 v[32:35], v[24:27], a[208:215], v0
    v_mov_b64 v[38:39], 0
    v_smfmac_f32_16x16x64_bf16 v[32:35], v[28:31], a[216:223], v0
    v_cvt_pk_bf16_f32 v14, v10, v11
    v_smfmac_f32_16x16x64_bf16 v[36:39], v[16:19], a[224:231], v0
    v_cvt_pk_bf16_f32 v15, v12, v13
    s_add_u32 s77, s67, 32768
    v_bfi_b32 v15, 1, s61, v15
    buffer_store_dwordx2 v[14:15], v7, s[44:47], s77 offen sc1
    v_smfmac_f32_16x16x64_bf16 v[36:39], v[20:23], a[232:239], v0
    v_smfmac_f32_16x16x64_bf16 v[36:39], v[24:27], a[240:247], v0
    v_cvt_pk_bf16_f32 v14, v32, v33
    v_smfmac_f32_16x16x64_bf16 v[36:39], v[28:31], a[248:255], v0
    v_cvt_pk_bf16_f32 v15, v34, v35
    s_add_u32 s77, s67, 49152
    v_bfi_b32 v15, 1, s61, v15
    buffer_store_dwordx2 v[14:15], v7, s[44:47], s77 offen sc1
    s_nop 3
    v_cvt_pk_bf16_f32 v14, v36, v37
    v_cvt_pk_bf16_f32 v15, v38, v39
    s_add_u32 s77, s67, 65536
    v_bfi_b32 v15, 1, s61, v15
    buffer_store_dwordx2 v[14:15], v7, s[44:47], s77 offen sc1
    s_branch L_ch_hop_f
L_ch_kmx_f:
    buffer_store_dwordx2 v[16:17], v5, s[44:47], s73 offen offset:2048 sc1
    buffer_store_dwordx2 v[12:13], v5, s[44:47], s73 offen sc1
    s_branch L_ch_kmx_ret_f
L_ch_notown_f:
    s_cmp_lt_u32 s3, 2
    s_cbranch_scc0 L_ch_w23_f
    s_sleep 12
    s_branch L_ch_hopA_f
L_ch_w23_f:
    s_cmp_lt_u32 s3, 2
    s_cbranch_scc1 L_kv_27_f
    s_cmp_eq_u32 s3, 3
    s_cbranch_scc1 L_kv_27_v_f
    s_mov_b32 s77, s75
    s_mov_b32 m0, 147456
    s_nop 0
    buffer_load_dwordx4 v2, s[44:47], s77 offen nt lds
    s_add_u32 s77, s77, 1024
    s_mov_b32 m0, 148480
    s_nop 0
    buffer_load_dwordx4 v2, s[44:47], s77 offen nt lds
    s_add_u32 s77, s77, 1024
    s_mov_b32 m0, 149504
    s_nop 0
    buffer_load_dwordx4 v2, s[44:47], s77 offen nt lds
    s_add_u32 s77, s77, 1024
    s_mov_b32 m0, 150528
    s_nop 0
    buffer_load_dwordx4 v2, s[44:47], s77 offen nt lds
    s_add_u32 s77, s77, 1024
    s_mov_b32 m0, 151552
    s_nop 0
    buffer_load_dwordx4 v2, s[44:47], s77 offen nt lds
    s_add_u32 s77, s77, 1024
    s_mov_b32 m0, 152576
    s_nop 0
    buffer_load_dwordx4 v2, s[44:47], s77 offen nt lds
    s_add_u32 s77, s77, 1024
    s_mov_b32 m0, 153600
    s_nop 0
    buffer_load_dwordx4 v2, s[44:47], s77 offen nt lds
    s_add_u32 s77, s77, 1024
    s_mov_b32 m0, 154624
    s_nop 0
    buffer_load_dwordx4 v2, s[44:47], s77 offen nt lds
    s_branch L_kv_27_f
L_kv_27_v_f:
    s_mov_b32 s77, s76
    s_mov_b32 m0, 155648
    s_nop 0
    buffer_load_dwordx4 v2, s[44:47], s77 offen nt lds
    s_add_u32 s77, s77, 1024
    s_mov_b32 m0, 159744
    s_nop 0
    buffer_load_dwordx4 v2, s[44:47], s77 offen nt lds
    s_add_u32 s77, s77, 1024
    s_mov_b32 m0, 156672
    s_nop 0
    buffer_load_dwordx4 v2, s[44:47], s77 offen nt lds
    s_add_u32 s77, s77, 1024
    s_mov_b32 m0, 160768
    s_nop 0
    buffer_load_dwordx4 v2, s[44:47], s77 offen nt lds
    s_add_u32 s77, s77, 1024
    s_mov_b32 m0, 157696
    s_nop 0
    buffer_load_dwordx4 v2, s[44:47], s77 offen nt lds
    s_add_u32 s77, s77, 1024
    s_mov_b32 m0, 161792
    s_nop 0
    buffer_load_dwordx4 v2, s[44:47], s77 offen nt lds
    s_add_u32 s77, s77, 1024
    s_mov_b32 m0, 158720
    s_nop 0
    buffer_load_dwordx4 v2, s[44:47], s77 offen nt lds
    s_add_u32 s77, s77, 1024
    s_mov_b32 m0, 162816
    s_nop 0
    buffer_load_dwordx4 v2, s[44:47], s77 offen nt lds
L_kv_27_f:
    s_sleep 5
    s_add_u32 s79, s72, 0
    buffer_load_dwordx4 v[48:51], v2, s[44:47], s79 offen
    buffer_load_dwordx4 v[52:55], v2, s[44:47], s79 offen offset:1024
    s_add_u32 s79, s72, 2048
    buffer_load_dwordx4 v[56:59], v2, s[44:47], s79 offen
    buffer_load_dwordx4 v[60:63], v2, s[44:47], s79 offen offset:1024
    s_add_u32 s79, s72, 4096
    buffer_load_dwordx4 v[8:11], v2, s[44:47], s79 offen
    buffer_load_dwordx4 v[12:15], v2, s[44:47], s79 offen offset:1024
    s_branch L_ch_join_f
L_ch_last_f:
    buffer_store_dwordx2 v[16:17], v5, s[44:47], s73 offen offset:2048 sc1
    buffer_store_dwordx2 v[12:13], v5, s[44:47], s73 offen sc1
L_ch_done_f:
    s_waitcnt vmcnt(0) lgkmcnt(0)
    s_branch L_ch_fin
L_ch_fin:
    s_branch L_end
L_norole:
    s_cmp_lg_u32 s3, 0
    s_cbranch_scc1 L_cnt_29
    s_lshl_b32 s6, s11, 2
    s_add_u32 s6, s6, 128
    v_mov_b32 v2, s6
    v_mov_b32 v3, 1
    s_mov_b64 exec, 1
    global_atomic_add v2, v3, s[40:41] sc1
    s_mov_b64 exec, -1
L_cnt_29:
    s_lshl_b32 s6, s11, 2
    s_add_u32 s6, s6, 128
    v_mov_b32 v2, s6
    s_mov_b32 s12, 0
L_winit_30:
    global_load_dword v3, v2, s[40:41] sc1
    s_waitcnt vmcnt(0)
    v_readfirstlane_b32 s6, v3
    s_add_u32 s12, s12, 1
    s_cmp_ge_u32 s6, 256
    s_cbranch_scc1 L_winit_30_out
    s_sleep 4
    s_cmp_lt_u32 s12, 100000
    s_cbranch_scc1 L_winit_30
L_winit_30_out:
    s_cmp_lg_u32 s11, 0
    s_cbranch_scc1 L_winit_30_ok
    v_mbcnt_lo_u32_b32 v2, -1, 0
    v_mbcnt_hi_u32_b32 v2, -1, v2
    v_and_b32 v2, 7, v2
    v_lshlrev_b32 v2, 2, v2
    global_load_dword v3, v2, s[40:41] sc1
    s_waitcnt vmcnt(0)
    v_cmp_ne_u32 vcc, 32, v3
    s_nop 4
    s_cbranch_vccnz L_fallback
L_winit_30_ok:
    s_branch L_end
L_fallback:
    s_waitcnt vmcnt(0) lgkmcnt(0)
    s_barrier
    v_mbcnt_lo_u32_b32 v1, -1, 0
    v_mbcnt_hi_u32_b32 v1, -1, v1
    s_lshl_b32 s6, s3, 6
    v_add_u32 v0, s6, v1
    s_cmp_lg_u32 s3, 0
    s_cbranch_scc1 L_fb_b
    v_mov_b32 v2, 136
    v_mov_b32 v3, 1
    s_mov_b64 exec, 1
    global_atomic_add v4, v2, v3, s[40:41] sc0 sc1
    s_waitcnt vmcnt(0)
    v_mov_b32 v2, 0
    ds_write_b32 v2, v4
    s_mov_b64 exec, -1
    s_waitcnt lgkmcnt(0)
L_fb_b:
    s_barrier
    v_mov_b32 v2, 0
    ds_read_b32 v4, v2
    s_waitcnt lgkmcnt(0)
    s_nop 0
    v_readfirstlane_b32 s6, v4
    s_nop 1
    s_barrier
    s_lshr_b32 s4, s6, 5
    s_and_b32 s5, s6, 31
    s_mov_b32 s11, 1
    s_cmp_ge_u32 s4, 8
    s_cbranch_scc1 L_end
    s_branch L_dispatch
L_end:
    s_endpgm
.section .rodata,"a"
.p2align 6
.amdhsa_kernel sequential_preLN__memory_aug_recurrent_mem_tr__glu_gated_glu__prompt_kernel
  .amdhsa_next_free_vgpr 512
  .amdhsa_next_free_sgpr 102
  .amdhsa_accum_offset 256
  .amdhsa_group_segment_fixed_size 0
  .amdhsa_kernarg_size 112
  .amdhsa_user_sgpr_count 2
  .amdhsa_user_sgpr_kernarg_segment_ptr 1
  .amdhsa_system_sgpr_workgroup_id_x 1
.end_amdhsa_kernel
```
